```python
import torch

def _softmax(x, axis=-1):
    return torch.softmax(x, dim=axis)

def _gelu(x):
    return torch.nn.functional.gelu(x, approximate='tanh')

def _silu(x):
    return torch.nn.functional.silu(x)

def _sigmoid(x):
    return torch.sigmoid(x)

def _layernorm(x, axis=-1, eps=1e-05):
    m = x.mean(dim=axis, keepdim=True)
    v = x.var(dim=axis, keepdim=True, unbiased=False)
    return (x - m) / torch.sqrt(v + eps)

def _scatter_add(tgt, idx, src, axis=0):
    return tgt.clone().index_add_(axis, idx, src)

def _segment_sum(src, seg, n):
    out = torch.zeros((n,) + src.shape[1:], dtype=src.dtype)
    return out.index_add_(0, seg, src)

def _pad(x, pw):
    flat = tuple((v for pair in reversed(pw) for v in pair))
    return torch.nn.functional.pad(x, flat)
kernel_name = 'sequential_preLN__ssm_conv_s4__mixer_gmlp__prompt'

def setup_inputs():

    _w = lambda a: (lambda t: t.to(torch.bfloat16) if t.is_floating_point() else t)(torch.as_tensor(a))

    def _A_setup():
        B, L, D, N = (1, 2048, 448, 256)
        A_re = -(lambda _x: torch.exp(torch.as_tensor(_x)))((lambda *s: torch.randn(*s, dtype=torch.bfloat16) * 3.2)(D, N))
        A_im = torch.pi * (lambda *s: torch.randn(*s, dtype=torch.bfloat16) * 0.05)(D, N)
        B_re = (lambda *s: torch.randn(*s, dtype=torch.bfloat16) * 0.05)(D, N)
        B_im = (lambda *s: torch.randn(*s, dtype=torch.bfloat16) * 0.05)(D, N)
        C_re = (lambda *s: torch.randn(*s, dtype=torch.bfloat16) * 0.05)(D, N)
        C_im = (lambda *s: torch.randn(*s, dtype=torch.bfloat16) * 0.05)(D, N)
        log_dt = (lambda *s: torch.randn(*s, dtype=torch.bfloat16) * 0.05)(D) * 0.5 - 4.0
        Dskip = (lambda *s: torch.randn(*s, dtype=torch.bfloat16) * 0.05)(D)
        return {'u': _w((lambda *s: torch.randn(*s, dtype=torch.bfloat16) * 0.05)(B, L, D)), 'A_re': _w(A_re), 'A_im': _w(A_im), 'B_re': _w(B_re), 'B_im': _w(B_im), 'C_re': _w(C_re), 'C_im': _w(C_im), 'log_dt': _w(log_dt), 'Dskip': _w(Dskip)}
    _A_in = _A_setup()

    def _B_setup():
        B, S, D, F = (1, 2048, 448, 1792)
        Fh = F // 2
        return {'x': _w((lambda *s: torch.randn(*s, dtype=torch.bfloat16) * 0.05)(B, S, D)), 'w_in': _w((lambda *s: torch.randn(*s, dtype=torch.bfloat16) * 0.4)(D, 2 * Fh)), 'w_sp': _w(0.01 * (lambda *s: torch.randn(*s, dtype=torch.bfloat16) * 0.4)(S, S)), 'b_sp': _w(1.0 + 0.01 * (lambda *s: torch.randn(*s, dtype=torch.bfloat16) * 0.05)(S)), 'w_out': _w((lambda *s: torch.randn(*s, dtype=torch.bfloat16) * 0.05)(Fh, D))}
    _B_in = _B_setup()
    return {'A_u': _A_in['u'], 'A_A_re': _A_in['A_re'], 'A_A_im': _A_in['A_im'], 'A_B_re': _A_in['B_re'], 'A_B_im': _A_in['B_im'], 'A_C_re': _A_in['C_re'], 'A_C_im': _A_in['C_im'], 'A_log_dt': _A_in['log_dt'], 'A_Dskip': _A_in['Dskip'], 'B_x': _B_in['x'], 'B_w_in': _B_in['w_in'], 'B_w_sp': _B_in['w_sp'], 'B_b_sp': _B_in['b_sp'], 'B_w_out': _B_in['w_out']}

def reference(A_u, A_A_re, A_A_im, A_B_re, A_B_im, A_C_re, A_C_im, A_log_dt, A_Dskip, B_x, B_w_in, B_w_sp, B_b_sp, B_w_out):

    def _A_ref(u, A_re, A_im, B_re, B_im, C_re, C_im, log_dt, Dskip):
        Bsz, L, D = u.shape
        dt = torch.exp(log_dt)[:, None]
        A = A_re + 1j * A_im
        Bc = B_re + 1j * B_im
        Cc = C_re + 1j * C_im
        logdA = dt * A
        dB = dt * Bc
        l = (lambda x, dt: x.to(dt))(torch.arange(L), A_re.dtype)
        P = torch.exp(logdA[:, :, None] * l[None, None, :])
        K = torch.einsum('dn,dnl,dn->dl', Cc, P, dB).real
        L2 = 2 * L
        Kp = _pad(K, ((0, 0), (0, L)))
        up = (lambda x, *d: x.permute(*d))(u, 0, 2, 1)
        up = _pad(up, ((0, 0), (0, 0), (0, L)))
        Kf = (lambda x, axes=(-2, -1): torch.fft.rfft2(x.float(), dim=axes))(Kp[:, None, :], axes=(-2, -1))
        Uf = (lambda x, axes=(-2, -1): torch.fft.rfft2(x.float(), dim=axes))(up[:, :, None, :], axes=(-2, -1))
        Yf = Uf * Kf[None, :, :, :]
        y = (lambda x, s, axes=(-2, -1): torch.fft.irfft2(x, s=s, dim=axes).to(torch.bfloat16))(Yf, (1, L2), axes=(-2, -1))[:, :, 0, :L]
        y = (lambda x, *d: x.permute(*d))(y, 0, 2, 1) + u * Dskip[None, None, :]
        return y

    def _B_ref(x, w_in, w_sp, b_sp, w_out):
        B, S, D = x.shape
        F = w_in.shape[-1]
        Fh = F // 2
        z = _gelu(torch.einsum('bsd,df->bsf', x, w_in))
        z1 = z[..., :Fh].clone()
        z2 = _layernorm(z[..., Fh:], axis=-1)
        g = torch.einsum('ts,bsf->btf', w_sp, z2) + b_sp[None, :, None]
        return torch.einsum('bsf,fd->bsd', z1 * g, w_out)
    x = A_u
    h = x + _A_ref(_layernorm(x, axis=-1), A_A_re, A_A_im, A_B_re, A_B_im, A_C_re, A_C_im, A_log_dt, A_Dskip)
    h2 = h + _B_ref(_layernorm(h, axis=-1), B_w_in, B_w_sp, B_b_sp, B_w_out)
    return h2
```

```asm
; @launch grid=(256,1,1) block=(256,1,1) lds=163840
.amdgcn_target "amdgcn-amd-amdhsa--gfx950"
.text
.globl sequential_preLN__ssm_conv_s4__mixer_gmlp__prompt_kernel
.p2align 8
.type sequential_preLN__ssm_conv_s4__mixer_gmlp__prompt_kernel,@function
sequential_preLN__ssm_conv_s4__mixer_gmlp__prompt_kernel:
    s_cmp_ge_u32 s2, 256
    s_cbranch_scc1 L_END
    s_load_dwordx16 s[4:19], s[0:1], 0
    s_load_dwordx16 s[20:35], s[0:1], 64
    s_load_dwordx2 s[36:37], s[0:1], 128
    s_getpc_b64 s[38:39]
L_PC0:
    s_lshr_b32 s56, s2, 3
    s_and_b32 s57, s2, 7
    v_lshlrev_b32 v1, 4, v0
    s_lshl_b32 s59, s56, 12
    v_add_u32 v10, s59, v1
    v_min_u32 v10, L_TBL-L_PC0-16+28672, v10
    global_load_dwordx4 v[252:255], v10, s[38:39]
    v_lshrrev_b32 v11, 6, v0
    s_mov_b32 s58, 0x3f803f80
    v_readfirstlane_b32 s3, v11
    v_and_b32 v58, 63, v0
    v_lshrrev_b32 v57, 3, v58
    v_and_b32 v56, 7, v58
    v_xor_b32 v56, v56, v57
    v_mul_u32_u24 v57, 896, v57
    v_lshl_add_u32 v56, v56, 4, v57
    s_lshl_b32 s62, s56, 2
    s_add_u32 s62, s62, s3
    s_and_b32 s69, s62, 15
    s_lshl_b32 s63, s57, 4
    s_add_u32 s69, s69, s63
    s_mul_i32 s69, s69, 14336
    s_lshr_b32 s63, s62, 4
    s_lshl_b32 s63, s63, 7
    s_add_u32 s69, s69, s63
    v_add_u32 v56, s69, v56
    v_add_u32 v54, 7168, v56
    s_mul_i32 s69, s3, 8320
    s_add_u32 m0, s69, 130528
    v_lshlrev_b32 v59, 4, v58
    v_cmp_lt_u32 vcc, 55, v58
    v_mov_b32 v55, 0x80000000
    s_nop 0
    v_cndmask_b32 v59, v59, v55, vcc
    s_lshl_b32 s59, s57, 7
    s_add_u32 s59, s59, s62
    s_mul_i32 s71, s59, 1792
    s_mov_b32 s42, 18874368
    s_mov_b32 s43, 0x20000
    s_mov_b32 s46, 1835008
    s_mov_b32 s47, 0x20000
    s_cmp_ge_u32 s56, 28
    s_cbranch_scc1 L_AUX
    s_mul_i32 s53, s57, 28
    s_add_u32 s53, s53, s56
    s_lshl_b32 s59, s53, 10
    v_lshl_add_u32 v58, v0, 2, s59
    s_lshr_b32 s62, s3, 1
    s_lshl_b32 s63, s53, 1
    s_add_u32 s62, s62, s63
    s_lshl_b32 s62, s62, 1
    v_mov_b32 v19, s62
    s_lshl_b32 s63, s53, 2
    v_mov_b32 v17, s63
    v_and_b32 v1, 63, v0
    s_mul_i32 s59, s3, 11424
    v_lshl_add_u32 v24, v1, 3, s59
    v_lshrrev_b32 v69, 5, v1
    v_and_b32 v68, 31, v1
    v_mul_u32_u24 v68, 528, v68
    v_lshl_add_u32 v68, v69, 4, v68
    v_add_u32 v66, s59, v68
    s_mul_i32 s59, s3, 17408
    s_add_u32 s59, s59, 45696
    v_add_u32_e64 v67, s59, v68
    v_lshl_add_u32 v25, v1, 3, s59
    s_add_u32 s60, s38, L_TBL-L_PC0
    s_addc_u32 s61, s39, 0
    s_waitcnt lgkmcnt(0)
    global_load_dword v10, v58, s[6:7]
    global_load_dword v11, v58, s[8:9]
    global_load_dword v12, v58, s[10:11]
    global_load_dword v13, v58, s[12:13]
    global_load_dword v14, v58, s[14:15]
    global_load_dword v15, v58, s[16:17]
    global_load_ushort v16, v19, s[18:19]
    global_load_dword v18, v17, s[20:21]
    s_mov_b32 s40, s36
    s_mov_b32 s41, s37
    s_mov_b32 s44, s4
    s_mov_b32 s45, s5
    buffer_load_dword v20, off, s[40:43], 0 sc1
    s_lshl_b32 s65, s57, 4
    s_lshr_b32 s62, s56, 1
    s_add_u32 s65, s65, s62
    s_mul_i32 s65, s65, 2176
    s_and_b32 s62, s56, 1
    s_lshl_b32 s62, s62, 6
    s_add_u32 s65, s65, s62
    s_add_u32 s65, s65, 1572864
    v_and_b32 v55, 15, v0
    v_bfe_u32 v23, v0, 4, 2
    v_lshlrev_b32 v21, 3, v55
    v_lshl_add_u32 v21, v23, 16, v21
    v_and_b32 v22, 7, v55
    v_xor_b32 v22, v22, v23
    v_lshlrev_b32 v22, 4, v22
    v_lshl_add_u32 v22, v55, 7, v22
    s_mul_i32 s70, s3, 8320
    s_add_u32 s70, s70, 130528
    v_xor_b32 v23, 64, v22
    v_add_u32 v22, s70, v22
    v_add_u32 v23, s70, v23
    s_lshl_b32 s70, s56, 2
    s_add_u32 s70, s70, s3
    s_lshr_b32 s63, s70, 4
    s_lshl_b32 s63, s63, 19
    s_and_b32 s70, s70, 15
    s_lshl_b32 s70, s70, 7
    s_add_u32 s70, s70, s63
    s_lshl_b32 s63, s57, 11
    s_add_u32 s70, s70, s63
    s_add_u32 s70, s70, 14680064
    s_and_b32 s59, s57, 1
    s_lshl_b32 s59, s59, 2
    s_lshr_b32 s55, s56, 3
    s_add_u32 s55, s55, s59
    s_lshr_b32 s59, s57, 1
    s_lshl_b32 s59, s59, 3
    s_and_b32 s54, s56, 7
    s_add_u32 s54, s54, s59
    s_lshl_b32 s59, s57, 2
    s_and_b32 s62, s56, 3
    s_add_u32 s59, s59, s62
    s_cmp_ge_u32 s56, 24
    s_cselect_b32 s55, 3, s55
    s_cselect_b32 s54, s59, s54
    v_mov_b32 v61, 0
    v_mov_b32 v62, 0
    v_mov_b32 v63, 0
    v_min_u32 v64, 154, v0
    v_lshlrev_b32 v64, 4, v64
    v_add_u32 v64, 115328, v64
    v_bfe_u32 v65, v0, 2, 3
    v_mul_u32_u24 v65, 4160, v65
    v_and_b32 v60, 3, v0
    v_lshl_add_u32 v65, v60, 4, v65
    v_mov_b32 v60, 0
    v_add_u32 v65, 134624, v65
    ds_write_b128 v64, v[60:63]
    ds_write_b128 v64, v[60:63] offset:7600
    ds_write_b128 v65, v[60:63]
    v_mov_b32 v9, -1
    s_mov_b32 s52, 0
    buffer_load_dwordx4 v56, s[44:47], 0 offen lds
    s_add_u32 m0, m0, 1024
    s_nop 0
    buffer_load_dwordx4 v54, s[44:47], 0 offen lds
    buffer_load_dwordx4 v[2:5], v59, s[44:47], s71 offen
    buffer_load_dwordx4 v[6:9], v59, s[44:47], s71 offen offset:896
    s_mov_b32 s44, s26
    s_mov_b32 s45, s27
    s_mov_b32 s46, 8388608
    v_lshlrev_b32_e64 v59, 4, v0
    v_add_u32 v17, 4096, v59
    v_add_u32 v19, 12288, v59
    v_add_u32 v58, 20480, v59
    v_add_u32 v59, 24576, v59
    s_mul_i32 s100, s3, 12288
    s_add_u32 s100, s100, 61440
    s_lshl_b32 s23, s3, 12
    s_add_u32 s23, s23, 49152
    v_lshl_add_u32 v70, v1, 3, s100
    v_add_u32 v70, 12288, v70
    v_lshlrev_b32 v71, 4, v1
    s_lshl_b32 s67, s3, 12
    s_lshl_b32 s64, s53, 14
    s_add_u32 s64, s64, s67
    s_add_u32 s64, s64, 14680064
    v_lshrrev_b32 v80, 3, v1
    v_mul_u32_u24 v80, 2176, v80
    v_and_b32 v68, 7, v1
    v_lshl_add_u32 v80, v68, 4, v80
    s_mul_i32 s67, s3, 69632
    s_add_u32 s67, s67, 1572864
    v_lshrrev_b32 v72, 4, v1
    v_lshl_add_u32 v72, s3, 4, v72
    v_mul_u32_u24 v72, 80, v72
    v_and_b32 v68, 15, v0
    v_lshl_add_u32 v72, v68, 2, v72
    v_add_u32 v72, 117808, v72
    v_lshrrev_b32 v78, 4, v1
    v_and_b32 v68, 15, v1
    v_xor_b32 v68, v68, v78
    v_lshlrev_b32 v68, 4, v68
    v_lshl_add_u32 v73, v78, 12, v68
    v_xor_b32 v74, 16448, v73
    v_xor_b32 v75, 32896, v73
    v_xor_b32 v76, 49344, v73
    s_lshl_b32 s59, s55, 2
    s_add_u32 s59, s59, s3
    s_lshr_b32 s63, s59, 1
    v_and_b32 v68, 1, v1
    v_mul_u32_u24 v68, 14, v68
    v_add_lshl_u32 v77, v68, s63, 7
    v_add_u32 v77, 147456, v77
    s_mul_i32 s99, s59, 28672
    s_add_u32 s99, s99, 2883584
    s_lshl_b32 s62, s54, 18
    s_lshl_b32 s63, s3, 10
    s_add_u32 s62, s62, s63
    s_add_u32 s63, s3, 0
    s_and_b32 s63, s63, 3
    s_lshl_b32 s95, s63, 16
    s_add_u32 s95, s95, s62
    s_add_u32 s63, s63, s56
    s_and_b32 s63, s63, 3
    s_mul_i32 s48, s63, 7168
    s_add_u32 s63, s3, 1
    s_and_b32 s63, s63, 3
    s_lshl_b32 s96, s63, 16
    s_add_u32 s96, s96, s62
    s_add_u32 s63, s63, s56
    s_and_b32 s63, s63, 3
    s_mul_i32 s49, s63, 7168
    s_add_u32 s63, s3, 2
    s_and_b32 s63, s63, 3
    s_lshl_b32 s97, s63, 16
    s_add_u32 s97, s97, s62
    s_add_u32 s63, s63, s56
    s_and_b32 s63, s63, 3
    s_mul_i32 s50, s63, 7168
    s_add_u32 s63, s3, 3
    s_and_b32 s63, s63, 3
    s_lshl_b32 s98, s63, 16
    s_add_u32 s98, s98, s62
    s_add_u32 s63, s63, s56
    s_and_b32 s63, s63, 3
    s_mul_i32 s51, s63, 7168
    s_mul_i32 s101, s3, 12288
    v_bfe_u32 v30, v0, 2, 2
    v_mul_u32_u24 v30, 3584, v30
    v_and_b32 v31, 3, v0
    v_lshl_add_u32 v30, v31, 7, v30
    s_lshl_b32 s63, s56, 2
    s_add_u32 s63, s63, s3
    s_mul_i32 s59, s63, 14336
    s_min_u32 s62, s57, 6
    s_lshl_b32 s62, s62, 9
    s_add_u32 s59, s59, s62
    v_add_u32 v30, s59, v30
    v_and_b32 v32, 7, v0
    s_lshl_b32 s59, s63, 10
    s_mul_i32 s62, s62, 224
    s_add_u32 s59, s59, s62
    v_lshl_add_u32 v32, v32, 7, s59
    s_mov_b64 exec, 0xffff
    global_load_dword v31, v30, s[24:25]
    s_mov_b64 exec, 0xff
    global_load_dword v31, v32, s[30:31]
    s_mov_b64 exec, -1
    s_lshr_b32 s69, s56, 3
    s_add_u32 s69, s69, s56
    s_add_u32 s63, s69, 0
    s_and_b32 s63, s63, 3
    s_lshl_b32 s24, s63, 8
    s_add_u32 s63, s69, 1
    s_and_b32 s63, s63, 3
    s_lshl_b32 s25, s63, 8
    s_add_u32 s63, s69, 2
    s_and_b32 s63, s63, 3
    s_lshl_b32 s30, s63, 8
    s_add_u32 s63, s69, 3
    s_and_b32 s63, s63, 3
    s_lshl_b32 s31, s63, 8
    s_mul_i32 s59, s3, 224
    s_add_u32 s59, s59, s53
    s_lshl_b32 s59, s59, 6
    s_add_u32 s59, s59, 32768
    v_mov_b32 v33, s59
    s_add_u32 s59, s59, 1015808
    v_writelane_b32 v33, s59, 1
    s_lshl_b32 s62, s55, 5
    s_add_u32 s62, s62, s54
    s_lshl_b32 s59, s62, 2
    s_add_u32 s59, s59, s3
    s_lshl_b32 s59, s59, 7
    s_add_u32 s59, s59, 163840
    v_writelane_b32 v33, s59, 2
    s_lshl_b32 s59, s3, 8
    s_add_u32 s59, s59, s62
    s_lshl_b32 s59, s59, 7
    s_add_u32 s59, s59, 1179648
    v_writelane_b32 v33, s59, 3
    v_writelane_b32 v33, s65, 4
    s_mov_b64 exec, 31
    buffer_load_dword v31, v33, s[40:43], 0 offen sc1
    s_mov_b64 exec, -1
    s_waitcnt vmcnt(8)
    v_lshlrev_b32 v16, 16, v16
    s_mov_b32 s62, 0x3fb8aa3b
    v_mul_f32 v181, s62, v16
    v_fma_f32 v182, v16, s62, -v181
    v_fmac_f32 v182, 0x32a57060, v16
    v_exp_f32 v180, v181
    v_mul_f32 v182, 0x3f317218, v182
    v_fmac_f32 v180, v180, v182
    v_cvt_pk_bf16_f32 v180, v180, v180
    v_and_b32 v232, 0xffff0000, v180
    v_lshlrev_b32 v184, 16, v10
    v_lshlrev_b32 v185, 16, v11
    v_lshlrev_b32_e64 v188, 16, v12
    v_lshlrev_b32_e64 v189, 16, v13
    v_lshlrev_b32_e64 v186, 16, v14
    v_lshlrev_b32 v187, 16, v15
    v_and_b32 v208, 0xffff0000, v10
    v_and_b32 v209, 0xffff0000, v11
    v_and_b32 v212, 0xffff0000, v12
    v_and_b32 v213, 0xffff0000, v13
    v_and_b32 v210, 0xffff0000, v14
    v_and_b32 v211, 0xffff0000, v15
    s_mov_b32 s62, 0x3fb8aa3b
    s_mov_b32 s63, 0x3e22f983
    v_pk_mul_f32 v[184:185], v[184:185], v[232:233] op_sel_hi:[1,0]
    v_pk_mul_f32 v[188:189], v[188:189], v[232:233] op_sel_hi:[1,0]
    v_pk_mul_f32 v[208:209], v[208:209], v[232:233] op_sel_hi:[1,0]
    v_pk_mul_f32 v[212:213], v[212:213], v[232:233] op_sel_hi:[1,0]
    v_pk_mul_f32 v[184:185], v[184:185], s[62:63]
    v_pk_mul_f32 v[82:83], v[186:187], v[188:189] op_sel:[0,0] op_sel_hi:[0,1]
    v_pk_mul_f32 v[208:209], v[208:209], s[62:63]
    v_pk_mul_f32 v[88:89], v[210:211], v[212:213] op_sel:[0,0] op_sel_hi:[0,1]
    v_pk_fma_f32 v[82:83], v[186:187], v[188:189], v[82:83] op_sel:[1,1,0] op_sel_hi:[1,0,1] neg_lo:[1,0,0] neg_hi:[1,0,1]
    v_pk_fma_f32 v[88:89], v[210:211], v[212:213], v[88:89] op_sel:[1,1,0] op_sel_hi:[1,0,1] neg_lo:[1,0,0] neg_hi:[1,0,1]
    v_exp_f32 v186, v184
    v_fract_f32 v187, v185
    v_exp_f32 v210, v208
    v_fract_f32 v211, v209
    v_cos_f32 v190, v187
    v_sin_f32 v191, v187
    v_cos_f32 v214, v211
    v_sin_f32 v215, v211
    v_pk_mul_f32 v[190:191], v[190:191], v[186:187] op_sel:[0,0] op_sel_hi:[1,0]
    v_pk_mul_f32 v[214:215], v[214:215], v[210:211] op_sel:[0,0] op_sel_hi:[1,0]
    v_mul_f32 v186, 0x41000000, v184
    v_mul_f32 v187, 0xc1000000, v185
    v_exp_f32 v186, v186
    v_fract_f32 v187, v187
    v_mul_f32 v210, 0x41000000, v208
    v_mul_f32 v211, 0xc1000000, v209
    v_exp_f32 v210, v210
    v_fract_f32 v211, v211
    v_cos_f32 v86, v187
    v_sin_f32 v87, v187
    v_cos_f32 v92, v211
    v_sin_f32 v93, v211
    v_pk_mul_f32 v[86:87], v[86:87], v[186:187] op_sel:[0,0] op_sel_hi:[1,0]
    v_pk_mul_f32 v[92:93], v[92:93], v[210:211] op_sel:[0,0] op_sel_hi:[1,0]
    v_mul_f32 v186, 0x43800000, v184
    v_mul_f32 v187, 0x43800000, v185
    v_exp_f32 v186, v186
    v_fract_f32 v187, v187
    v_mul_f32 v210, 0x43800000, v208
    v_mul_f32 v211, 0x43800000, v209
    v_exp_f32 v210, v210
    v_fract_f32 v211, v211
    v_cos_f32 v200, v187
    v_sin_f32 v201, v187
    v_cos_f32 v224, v211
    v_sin_f32 v225, v211
    v_pk_mul_f32 v[200:201], v[200:201], v[186:187] op_sel:[0,0] op_sel_hi:[1,0]
    v_pk_mul_f32 v[224:225], v[224:225], v[210:211] op_sel:[0,0] op_sel_hi:[1,0]
    v_mov_b32 v94, 0x3f80
    v_mov_b32 v95, 0x3f80
    v_cvt_pk_bf16_f32 v96, v190, v191
    v_cvt_pk_bf16_f32 v97, v214, v215
    ds_write_b64 v24, v[94:95] offset:0
    ds_write_b64 v24, v[96:97] offset:528
    v_cvt_pk_bf16_f32 v98, v200, v201
    v_cvt_pk_bf16_f32 v99, v224, v225
    v_pk_mul_f32 v[192:193], v[190:191], v[190:191] op_sel:[0,0] op_sel_hi:[0,1]
    v_pk_mul_f32 v[216:217], v[214:215], v[214:215] op_sel:[0,0] op_sel_hi:[0,1]
    v_pk_fma_f32 v[192:193], v[190:191], v[190:191], v[192:193] op_sel:[1,1,0] op_sel_hi:[1,0,1] neg_lo:[1,0,0]
    v_pk_fma_f32 v[216:217], v[214:215], v[214:215], v[216:217] op_sel:[1,1,0] op_sel_hi:[1,0,1] neg_lo:[1,0,0]
    v_cvt_pk_bf16_f32 v100, v192, v193
    v_cvt_pk_bf16_f32 v101, v216, v217
    ds_write_b64 v24, v[98:99] offset:4224
    ds_write_b64 v24, v[100:101] offset:1056
    v_pk_mul_f32 v[194:195], v[192:193], v[190:191] op_sel:[0,0] op_sel_hi:[0,1]
    v_pk_mul_f32 v[218:219], v[216:217], v[214:215] op_sel:[0,0] op_sel_hi:[0,1]
    v_pk_fma_f32 v[194:195], v[192:193], v[190:191], v[194:195] op_sel:[1,1,0] op_sel_hi:[1,0,1] neg_lo:[1,0,0]
    v_pk_fma_f32 v[218:219], v[216:217], v[214:215], v[218:219] op_sel:[1,1,0] op_sel_hi:[1,0,1] neg_lo:[1,0,0]
    v_cvt_pk_bf16_f32 v102, v194, v195
    v_cvt_pk_bf16_f32 v103, v218, v219
    v_pk_mul_f32 v[196:197], v[192:193], v[192:193] op_sel:[0,0] op_sel_hi:[0,1]
    v_pk_mul_f32 v[220:221], v[216:217], v[216:217] op_sel:[0,0] op_sel_hi:[0,1]
    v_pk_fma_f32 v[196:197], v[192:193], v[192:193], v[196:197] op_sel:[1,1,0] op_sel_hi:[1,0,1] neg_lo:[1,0,0]
    v_pk_fma_f32 v[220:221], v[216:217], v[216:217], v[220:221] op_sel:[1,1,0] op_sel_hi:[1,0,1] neg_lo:[1,0,0]
    v_cvt_pk_bf16_f32 v104, v196, v197
    v_cvt_pk_bf16_f32 v105, v220, v221
    ds_write_b64 v24, v[102:103] offset:1584
    ds_write_b64 v24, v[104:105] offset:2112
    v_pk_mul_f32 v[84:85], v[196:197], v[190:191] op_sel:[0,0] op_sel_hi:[0,1]
    v_pk_mul_f32 v[90:91], v[220:221], v[214:215] op_sel:[0,0] op_sel_hi:[0,1]
    v_pk_fma_f32 v[84:85], v[196:197], v[190:191], v[84:85] op_sel:[1,1,0] op_sel_hi:[1,0,1] neg_lo:[1,0,0]
    v_pk_fma_f32 v[90:91], v[220:221], v[214:215], v[90:91] op_sel:[1,1,0] op_sel_hi:[1,0,1] neg_lo:[1,0,0]
    v_cvt_pk_bf16_f32 v106, v84, v85
    v_cvt_pk_bf16_f32 v107, v90, v91
    v_pk_mul_f32 v[198:199], v[196:197], v[192:193] op_sel:[0,0] op_sel_hi:[0,1]
    v_pk_mul_f32 v[222:223], v[220:221], v[216:217] op_sel:[0,0] op_sel_hi:[0,1]
    v_pk_fma_f32 v[198:199], v[196:197], v[192:193], v[198:199] op_sel:[1,1,0] op_sel_hi:[1,0,1] neg_lo:[1,0,0]
    v_pk_fma_f32 v[222:223], v[220:221], v[216:217], v[222:223] op_sel:[1,1,0] op_sel_hi:[1,0,1] neg_lo:[1,0,0]
    v_cvt_pk_bf16_f32 v108, v198, v199
    v_cvt_pk_bf16_f32 v109, v222, v223
    ds_write_b64 v24, v[106:107] offset:2640
    ds_write_b64 v24, v[108:109] offset:3168
    v_pk_mul_f32 v[84:85], v[196:197], v[194:195] op_sel:[0,0] op_sel_hi:[0,1]
    v_pk_mul_f32 v[90:91], v[220:221], v[218:219] op_sel:[0,0] op_sel_hi:[0,1]
    v_pk_fma_f32 v[84:85], v[196:197], v[194:195], v[84:85] op_sel:[1,1,0] op_sel_hi:[1,0,1] neg_lo:[1,0,0]
    v_pk_fma_f32 v[90:91], v[220:221], v[218:219], v[90:91] op_sel:[1,1,0] op_sel_hi:[1,0,1] neg_lo:[1,0,0]
    v_cvt_pk_bf16_f32 v94, v84, v85
    v_cvt_pk_bf16_f32 v95, v90, v91
    v_pk_mul_f32 v[84:85], v[200:201], v[192:193] op_sel:[0,0] op_sel_hi:[0,1]
    v_pk_mul_f32 v[90:91], v[224:225], v[216:217] op_sel:[0,0] op_sel_hi:[0,1]
    v_pk_fma_f32 v[84:85], v[200:201], v[192:193], v[84:85] op_sel:[1,1,0] op_sel_hi:[1,0,1] neg_lo:[1,0,0]
    v_pk_fma_f32 v[90:91], v[224:225], v[216:217], v[90:91] op_sel:[1,1,0] op_sel_hi:[1,0,1] neg_lo:[1,0,0]
    v_cvt_pk_bf16_f32 v96, v84, v85
    v_cvt_pk_bf16_f32 v97, v90, v91
    ds_write_b64 v24, v[94:95] offset:3696
    ds_write_b64 v24, v[96:97] offset:4752
    v_pk_mul_f32 v[194:195], v[200:201], v[196:197] op_sel:[0,0] op_sel_hi:[0,1]
    v_pk_mul_f32 v[218:219], v[224:225], v[220:221] op_sel:[0,0] op_sel_hi:[0,1]
    v_pk_fma_f32 v[194:195], v[200:201], v[196:197], v[194:195] op_sel:[1,1,0] op_sel_hi:[1,0,1] neg_lo:[1,0,0]
    v_pk_fma_f32 v[218:219], v[224:225], v[220:221], v[218:219] op_sel:[1,1,0] op_sel_hi:[1,0,1] neg_lo:[1,0,0]
    v_cvt_pk_bf16_f32 v98, v194, v195
    v_cvt_pk_bf16_f32 v99, v218, v219
    ds_write_b64 v24, v[98:99] offset:5280
    v_readlane_b32 s59, v9, 63
    s_nop 0
    s_cmp_eq_u32 s59, 0
    s_cbranch_scc0 L_XS1
    s_waitcnt vmcnt(5)
    ds_read_b32 v240, v22 offset:0
    ds_read_b32 v242, v22 offset:4
    ds_read_b32 v244, v22 offset:8
    ds_read_b32 v246, v22 offset:12
    ds_read_b32 v248, v23 offset:0
    ds_read_b32 v250, v23 offset:4
    ds_read_b32 v252, v23 offset:8
    ds_read_b32 v254, v23 offset:12
    v_readfirstlane_b32 s52, v20
    s_nop 0
    s_add_u32 s52, s52, 1
    s_or_b32 s52, s52, 0xffc00000
    v_mov_b32 v241, s52
    v_mov_b32 v243, s52
    v_mov_b32 v245, s52
    v_mov_b32 v247, s52
    v_mov_b32 v249, s52
    v_mov_b32 v251, s52
    v_mov_b32 v253, s52
    v_mov_b32 v255, s52
    s_waitcnt lgkmcnt(4)
    buffer_store_dwordx2 v[240:241], v21, s[40:43], s70 offen sc1
    s_add_u32 s70, s70, 16384
    buffer_store_dwordx2 v[242:243], v21, s[40:43], s70 offen sc1
    s_add_u32 s70, s70, 16384
    buffer_store_dwordx2 v[244:245], v21, s[40:43], s70 offen sc1
    s_add_u32 s70, s70, 16384
    buffer_store_dwordx2 v[246:247], v21, s[40:43], s70 offen sc1
    s_add_u32 s70, s70, 16384
    s_add_u32 s70, s70, 196608
    s_waitcnt lgkmcnt(0)
    buffer_store_dwordx2 v[248:249], v21, s[40:43], s70 offen sc1
    s_add_u32 s70, s70, 16384
    buffer_store_dwordx2 v[250:251], v21, s[40:43], s70 offen sc1
    s_add_u32 s70, s70, 16384
    buffer_store_dwordx2 v[252:253], v21, s[40:43], s70 offen sc1
    s_add_u32 s70, s70, 16384
    buffer_store_dwordx2 v[254:255], v21, s[40:43], s70 offen sc1
    s_waitcnt vmcnt(11)
    v_dot2_f32_bf16 v176, v2, s58, 0
    v_dot2_f32_bf16 v177, v2, v2, 0
    v_dot2_f32_bf16 v178, v6, s58, 0
    v_dot2_f32_bf16 v179, v6, v6, 0
    v_dot2_f32_bf16 v176, v3, s58, v176
    v_dot2_f32_bf16 v177, v3, v3, v177
    v_dot2_f32_bf16 v178, v7, s58, v178
    v_dot2_f32_bf16 v179, v7, v7, v179
    v_dot2_f32_bf16 v176, v4, s58, v176
    v_dot2_f32_bf16 v177, v4, v4, v177
    v_dot2_f32_bf16 v178, v8, s58, v178
    v_dot2_f32_bf16 v179, v8, v8, v179
    v_dot2_f32_bf16 v176, v5, s58, v176
    v_dot2_f32_bf16 v177, v5, v5, v177
    v_dot2_f32_bf16 v178, v9, s58, v178
    v_dot2_f32_bf16 v179, v9, v9, v179
    s_nop 1
    v_permlane32_swap_b32 v176, v178
    v_permlane32_swap_b32 v177, v179
    v_add_f32 v176, v176, v178
    v_add_f32 v177, v177, v179
    s_nop 0
    v_add_f32_dpp v176, v176, v176 row_shr:1 row_mask:0xf bank_mask:0xf bound_ctrl:0
    v_add_f32_dpp v177, v177, v177 row_shr:1 row_mask:0xf bank_mask:0xf bound_ctrl:0
    s_nop 0
    v_add_f32_dpp v176, v176, v176 row_shr:2 row_mask:0xf bank_mask:0xf bound_ctrl:0
    v_add_f32_dpp v177, v177, v177 row_shr:2 row_mask:0xf bank_mask:0xf bound_ctrl:0
    s_nop 0
    v_add_f32_dpp v176, v176, v176 row_shr:4 row_mask:0xf bank_mask:0xf bound_ctrl:0
    v_add_f32_dpp v177, v177, v177 row_shr:4 row_mask:0xf bank_mask:0xf bound_ctrl:0
    s_nop 0
    v_add_f32_dpp v176, v176, v176 row_shr:8 row_mask:0xf bank_mask:0xf bound_ctrl:0
    v_add_f32_dpp v177, v177, v177 row_shr:8 row_mask:0xf bank_mask:0xf bound_ctrl:0
    s_nop 0
    v_add_f32_dpp v176, v176, v176 row_bcast:15 row_mask:0xa bank_mask:0xf
    v_add_f32_dpp v177, v177, v177 row_bcast:15 row_mask:0xa bank_mask:0xf
    v_mul_f32 v176, 0x3b124925, v176
    v_mul_f32 v177, 0x3b124925, v177
    v_fma_f32 v177, -v176, v176, v177
    v_max_f32 v177, 0, v177
    v_cvt_pk_bf16_f32 v177, v177, v177
    v_and_b32 v177, 0xffff0000, v177
    v_add_f32 v177, 0x3727c5ac, v177
    v_cvt_pk_bf16_f32 v177, v177, v177
    v_and_b32 v177, 0xffff0000, v177
    v_sqrt_f32 v177, v177
    v_lshrrev_b32 v20, 5, v0
    v_lshlrev_b32 v20, 3, v20
    v_cvt_pk_bf16_f32 v178, v176, v177
    v_mov_b32 v179, s52
    s_mov_b32 exec_lo, 0x80000000
    s_mov_b32 exec_hi, 0x80000000
    buffer_store_dwordx2 v[178:179], v20, s[40:43], s65 offen sc1
    s_mov_b64 exec, -1
L_XS1:
    v_pk_mul_f32 v[84:85], v[200:201], v[198:199] op_sel:[0,0] op_sel_hi:[0,1]
    v_pk_mul_f32 v[90:91], v[224:225], v[222:223] op_sel:[0,0] op_sel_hi:[0,1]
    v_pk_fma_f32 v[84:85], v[200:201], v[198:199], v[84:85] op_sel:[1,1,0] op_sel_hi:[1,0,1] neg_lo:[1,0,0]
    v_pk_fma_f32 v[90:91], v[224:225], v[222:223], v[90:91] op_sel:[1,1,0] op_sel_hi:[1,0,1] neg_lo:[1,0,0]
    v_cvt_pk_bf16_f32 v100, v84, v85
    v_cvt_pk_bf16_f32 v101, v90, v91
    v_pk_mul_f32 v[202:203], v[200:201], v[200:201] op_sel:[0,0] op_sel_hi:[0,1]
    v_pk_mul_f32 v[226:227], v[224:225], v[224:225] op_sel:[0,0] op_sel_hi:[0,1]
    v_pk_fma_f32 v[202:203], v[200:201], v[200:201], v[202:203] op_sel:[1,1,0] op_sel_hi:[1,0,1] neg_lo:[1,0,0]
    v_pk_fma_f32 v[226:227], v[224:225], v[224:225], v[226:227] op_sel:[1,1,0] op_sel_hi:[1,0,1] neg_lo:[1,0,0]
    v_cvt_pk_bf16_f32 v102, v202, v203
    v_cvt_pk_bf16_f32 v103, v226, v227
    ds_write_b64 v24, v[100:101] offset:5808
    ds_write_b64 v24, v[102:103] offset:6336
    v_pk_mul_f32 v[84:85], v[202:203], v[196:197] op_sel:[0,0] op_sel_hi:[0,1]
    v_pk_mul_f32 v[90:91], v[226:227], v[220:221] op_sel:[0,0] op_sel_hi:[0,1]
    v_pk_fma_f32 v[84:85], v[202:203], v[196:197], v[84:85] op_sel:[1,1,0] op_sel_hi:[1,0,1] neg_lo:[1,0,0]
    v_pk_fma_f32 v[90:91], v[226:227], v[220:221], v[90:91] op_sel:[1,1,0] op_sel_hi:[1,0,1] neg_lo:[1,0,0]
    v_cvt_pk_bf16_f32 v104, v84, v85
    v_cvt_pk_bf16_f32 v105, v90, v91
    v_pk_mul_f32 v[204:205], v[202:203], v[200:201] op_sel:[0,0] op_sel_hi:[0,1]
    v_pk_mul_f32 v[228:229], v[226:227], v[224:225] op_sel:[0,0] op_sel_hi:[0,1]
    v_pk_fma_f32 v[204:205], v[202:203], v[200:201], v[204:205] op_sel:[1,1,0] op_sel_hi:[1,0,1] neg_lo:[1,0,0]
    v_pk_fma_f32 v[228:229], v[226:227], v[224:225], v[228:229] op_sel:[1,1,0] op_sel_hi:[1,0,1] neg_lo:[1,0,0]
    v_cvt_pk_bf16_f32 v106, v204, v205
    v_cvt_pk_bf16_f32 v107, v228, v229
    ds_write_b64 v24, v[104:105] offset:6864
    ds_write_b64 v24, v[106:107] offset:7392
    v_pk_mul_f32 v[84:85], v[204:205], v[196:197] op_sel:[0,0] op_sel_hi:[0,1]
    v_pk_mul_f32 v[90:91], v[228:229], v[220:221] op_sel:[0,0] op_sel_hi:[0,1]
    v_pk_fma_f32 v[84:85], v[204:205], v[196:197], v[84:85] op_sel:[1,1,0] op_sel_hi:[1,0,1] neg_lo:[1,0,0]
    v_pk_fma_f32 v[90:91], v[228:229], v[220:221], v[90:91] op_sel:[1,1,0] op_sel_hi:[1,0,1] neg_lo:[1,0,0]
    v_cvt_pk_bf16_f32 v108, v84, v85
    v_cvt_pk_bf16_f32 v109, v90, v91
    v_pk_mul_f32 v[206:207], v[202:203], v[202:203] op_sel:[0,0] op_sel_hi:[0,1]
    v_pk_mul_f32 v[230:231], v[226:227], v[226:227] op_sel:[0,0] op_sel_hi:[0,1]
    v_pk_fma_f32 v[206:207], v[202:203], v[202:203], v[206:207] op_sel:[1,1,0] op_sel_hi:[1,0,1] neg_lo:[1,0,0]
    v_pk_fma_f32 v[230:231], v[226:227], v[226:227], v[230:231] op_sel:[1,1,0] op_sel_hi:[1,0,1] neg_lo:[1,0,0]
    v_cvt_pk_bf16_f32 v94, v206, v207
    v_cvt_pk_bf16_f32 v95, v230, v231
    ds_write_b64 v24, v[108:109] offset:7920
    ds_write_b64 v24, v[94:95] offset:8448
    v_pk_mul_f32 v[84:85], v[206:207], v[200:201] op_sel:[0,0] op_sel_hi:[0,1]
    v_pk_mul_f32 v[90:91], v[230:231], v[224:225] op_sel:[0,0] op_sel_hi:[0,1]
    v_pk_fma_f32 v[84:85], v[206:207], v[200:201], v[84:85] op_sel:[1,1,0] op_sel_hi:[1,0,1] neg_lo:[1,0,0]
    v_pk_fma_f32 v[90:91], v[230:231], v[224:225], v[90:91] op_sel:[1,1,0] op_sel_hi:[1,0,1] neg_lo:[1,0,0]
    v_cvt_pk_bf16_f32 v96, v84, v85
    v_cvt_pk_bf16_f32 v97, v90, v91
    v_pk_mul_f32 v[194:195], v[206:207], v[202:203] op_sel:[0,0] op_sel_hi:[0,1]
    v_pk_mul_f32 v[218:219], v[230:231], v[226:227] op_sel:[0,0] op_sel_hi:[0,1]
    v_pk_fma_f32 v[194:195], v[206:207], v[202:203], v[194:195] op_sel:[1,1,0] op_sel_hi:[1,0,1] neg_lo:[1,0,0]
    v_pk_fma_f32 v[218:219], v[230:231], v[226:227], v[218:219] op_sel:[1,1,0] op_sel_hi:[1,0,1] neg_lo:[1,0,0]
    v_cvt_pk_bf16_f32 v98, v194, v195
    v_cvt_pk_bf16_f32 v99, v218, v219
    ds_write_b64 v24, v[96:97] offset:8976
    ds_write_b64 v24, v[98:99] offset:9504
    v_pk_mul_f32 v[84:85], v[206:207], v[204:205] op_sel:[0,0] op_sel_hi:[0,1]
    v_pk_mul_f32 v[90:91], v[230:231], v[228:229] op_sel:[0,0] op_sel_hi:[0,1]
    v_pk_fma_f32 v[84:85], v[206:207], v[204:205], v[84:85] op_sel:[1,1,0] op_sel_hi:[1,0,1] neg_lo:[1,0,0]
    v_pk_fma_f32 v[90:91], v[230:231], v[228:229], v[90:91] op_sel:[1,1,0] op_sel_hi:[1,0,1] neg_lo:[1,0,0]
    v_cvt_pk_bf16_f32 v100, v84, v85
    v_cvt_pk_bf16_f32 v101, v90, v91
    v_pk_mul_f32 v[194:195], v[206:207], v[206:207] op_sel:[0,0] op_sel_hi:[0,1]
    v_pk_mul_f32 v[218:219], v[230:231], v[230:231] op_sel:[0,0] op_sel_hi:[0,1]
    v_pk_fma_f32 v[194:195], v[206:207], v[206:207], v[194:195] op_sel:[1,1,0] op_sel_hi:[1,0,1] neg_lo:[1,0,0]
    v_pk_fma_f32 v[218:219], v[230:231], v[230:231], v[218:219] op_sel:[1,1,0] op_sel_hi:[1,0,1] neg_lo:[1,0,0]
    v_cvt_pk_bf16_f32 v102, v194, v195
    v_cvt_pk_bf16_f32 v103, v218, v219
    ds_write_b64 v24, v[100:101] offset:10032
    ds_write_b64 v24, v[102:103] offset:10560
    s_cmp_eq_u32 s52, 0
    s_cbranch_scc1 L_XS2
L_XS2R:
    ds_read_b128 v[112:115], v66 offset:0
    ds_read_b128 v[116:119], v66 offset:32
    ds_read_b128 v[120:123], v66 offset:64
    ds_read_b128 v[124:127], v66 offset:96
    ds_read_b128 v[128:131], v66 offset:128
    ds_read_b128 v[132:135], v66 offset:160
    ds_read_b128 v[136:139], v66 offset:192
    ds_read_b128 v[140:143], v66 offset:224
    ds_read_b128 v[144:147], v66 offset:256
    ds_read_b128 v[148:151], v66 offset:288
    ds_read_b128 v[152:155], v66 offset:320
    ds_read_b128 v[156:159], v66 offset:352
    ds_read_b128 v[160:163], v66 offset:384
    ds_read_b128 v[164:167], v66 offset:416
    ds_read_b128 v[168:171], v66 offset:448
    ds_read_b128 v[172:175], v66 offset:480
    v_cvt_pk_bf16_f32 v104, v82, v83
    v_cvt_pk_bf16_f32 v105, v88, v89
    global_load_dwordx4 v[28:31], v17, s[60:61] offset:-4096
    v_pk_mul_f32 v[84:85], v[82:83], v[86:87] op_sel:[0,0] op_sel_hi:[0,1]
    v_pk_mul_f32 v[90:91], v[88:89], v[92:93] op_sel:[0,0] op_sel_hi:[0,1]
    v_pk_fma_f32 v[84:85], v[82:83], v[86:87], v[84:85] op_sel:[1,1,0] op_sel_hi:[1,0,1] neg_lo:[1,0,0]
    v_pk_fma_f32 v[90:91], v[88:89], v[92:93], v[90:91] op_sel:[1,1,0] op_sel_hi:[1,0,1] neg_lo:[1,0,0]
    v_cvt_pk_bf16_f32 v106, v84, v85
    v_cvt_pk_bf16_f32 v107, v90, v91
    ds_write_b64 v25, v[104:105] offset:0
    ds_write_b64 v25, v[106:107] offset:528
    v_pk_mul_f32 v[82:83], v[84:85], v[86:87] op_sel:[0,0] op_sel_hi:[0,1]
    v_pk_mul_f32 v[88:89], v[90:91], v[92:93] op_sel:[0,0] op_sel_hi:[0,1]
    v_pk_fma_f32 v[82:83], v[84:85], v[86:87], v[82:83] op_sel:[1,1,0] op_sel_hi:[1,0,1] neg_lo:[1,0,0]
    v_pk_fma_f32 v[88:89], v[90:91], v[92:93], v[88:89] op_sel:[1,1,0] op_sel_hi:[1,0,1] neg_lo:[1,0,0]
    v_cvt_pk_bf16_f32 v108, v82, v83
    v_cvt_pk_bf16_f32 v109, v88, v89
    global_load_dwordx4 v[32:35], v17, s[60:61] offset:0
    v_pk_mul_f32 v[84:85], v[82:83], v[86:87] op_sel:[0,0] op_sel_hi:[0,1]
    v_pk_mul_f32 v[90:91], v[88:89], v[92:93] op_sel:[0,0] op_sel_hi:[0,1]
    v_pk_fma_f32 v[84:85], v[82:83], v[86:87], v[84:85] op_sel:[1,1,0] op_sel_hi:[1,0,1] neg_lo:[1,0,0]
    v_pk_fma_f32 v[90:91], v[88:89], v[92:93], v[90:91] op_sel:[1,1,0] op_sel_hi:[1,0,1] neg_lo:[1,0,0]
    v_cvt_pk_bf16_f32 v94, v84, v85
    v_cvt_pk_bf16_f32 v95, v90, v91
    ds_write_b64 v25, v[108:109] offset:1056
    ds_write_b64 v25, v[94:95] offset:1584
    v_pk_mul_f32 v[82:83], v[84:85], v[86:87] op_sel:[0,0] op_sel_hi:[0,1]
    v_pk_mul_f32 v[88:89], v[90:91], v[92:93] op_sel:[0,0] op_sel_hi:[0,1]
    v_pk_fma_f32 v[82:83], v[84:85], v[86:87], v[82:83] op_sel:[1,1,0] op_sel_hi:[1,0,1] neg_lo:[1,0,0]
    v_pk_fma_f32 v[88:89], v[90:91], v[92:93], v[88:89] op_sel:[1,1,0] op_sel_hi:[1,0,1] neg_lo:[1,0,0]
    v_cvt_pk_bf16_f32 v96, v82, v83
    v_cvt_pk_bf16_f32 v97, v88, v89
    global_load_dwordx4 v[36:39], v19, s[60:61] offset:-4096
    v_pk_mul_f32 v[84:85], v[82:83], v[86:87] op_sel:[0,0] op_sel_hi:[0,1]
    v_pk_mul_f32 v[90:91], v[88:89], v[92:93] op_sel:[0,0] op_sel_hi:[0,1]
    v_pk_fma_f32 v[84:85], v[82:83], v[86:87], v[84:85] op_sel:[1,1,0] op_sel_hi:[1,0,1] neg_lo:[1,0,0]
    v_pk_fma_f32 v[90:91], v[88:89], v[92:93], v[90:91] op_sel:[1,1,0] op_sel_hi:[1,0,1] neg_lo:[1,0,0]
    v_cvt_pk_bf16_f32 v98, v84, v85
    v_cvt_pk_bf16_f32 v99, v90, v91
    ds_write_b64 v25, v[96:97] offset:2112
    ds_write_b64 v25, v[98:99] offset:2640
    v_pk_mul_f32 v[82:83], v[84:85], v[86:87] op_sel:[0,0] op_sel_hi:[0,1]
    v_pk_mul_f32 v[88:89], v[90:91], v[92:93] op_sel:[0,0] op_sel_hi:[0,1]
    v_pk_fma_f32 v[82:83], v[84:85], v[86:87], v[82:83] op_sel:[1,1,0] op_sel_hi:[1,0,1] neg_lo:[1,0,0]
    v_pk_fma_f32 v[88:89], v[90:91], v[92:93], v[88:89] op_sel:[1,1,0] op_sel_hi:[1,0,1] neg_lo:[1,0,0]
    v_cvt_pk_bf16_f32 v100, v82, v83
    v_cvt_pk_bf16_f32 v101, v88, v89
    global_load_dwordx4 v[40:43], v19, s[60:61] offset:0
    v_pk_mul_f32 v[84:85], v[82:83], v[86:87] op_sel:[0,0] op_sel_hi:[0,1]
    v_pk_mul_f32 v[90:91], v[88:89], v[92:93] op_sel:[0,0] op_sel_hi:[0,1]
    v_pk_fma_f32 v[84:85], v[82:83], v[86:87], v[84:85] op_sel:[1,1,0] op_sel_hi:[1,0,1] neg_lo:[1,0,0]
    v_pk_fma_f32 v[90:91], v[88:89], v[92:93], v[90:91] op_sel:[1,1,0] op_sel_hi:[1,0,1] neg_lo:[1,0,0]
    v_cvt_pk_bf16_f32 v102, v84, v85
    v_cvt_pk_bf16_f32 v103, v90, v91
    ds_write_b64 v25, v[100:101] offset:3168
    ds_write_b64 v25, v[102:103] offset:3696
    v_pk_mul_f32 v[82:83], v[84:85], v[86:87] op_sel:[0,0] op_sel_hi:[0,1]
    v_pk_mul_f32 v[88:89], v[90:91], v[92:93] op_sel:[0,0] op_sel_hi:[0,1]
    v_pk_fma_f32 v[82:83], v[84:85], v[86:87], v[82:83] op_sel:[1,1,0] op_sel_hi:[1,0,1] neg_lo:[1,0,0]
    v_pk_fma_f32 v[88:89], v[90:91], v[92:93], v[88:89] op_sel:[1,1,0] op_sel_hi:[1,0,1] neg_lo:[1,0,0]
    v_cvt_pk_bf16_f32 v104, v82, v83
    v_cvt_pk_bf16_f32 v105, v88, v89
    global_load_dwordx4 v[44:47], v58, s[60:61] offset:-4096
    v_pk_mul_f32 v[84:85], v[82:83], v[86:87] op_sel:[0,0] op_sel_hi:[0,1]
    v_pk_mul_f32 v[90:91], v[88:89], v[92:93] op_sel:[0,0] op_sel_hi:[0,1]
    v_pk_fma_f32 v[84:85], v[82:83], v[86:87], v[84:85] op_sel:[1,1,0] op_sel_hi:[1,0,1] neg_lo:[1,0,0]
    v_pk_fma_f32 v[90:91], v[88:89], v[92:93], v[90:91] op_sel:[1,1,0] op_sel_hi:[1,0,1] neg_lo:[1,0,0]
    v_cvt_pk_bf16_f32 v106, v84, v85
    v_cvt_pk_bf16_f32 v107, v90, v91
    ds_write_b64 v25, v[104:105] offset:4224
    ds_write_b64 v25, v[106:107] offset:4752
    v_pk_mul_f32 v[82:83], v[84:85], v[86:87] op_sel:[0,0] op_sel_hi:[0,1]
    v_pk_mul_f32 v[88:89], v[90:91], v[92:93] op_sel:[0,0] op_sel_hi:[0,1]
    v_pk_fma_f32 v[82:83], v[84:85], v[86:87], v[82:83] op_sel:[1,1,0] op_sel_hi:[1,0,1] neg_lo:[1,0,0]
    v_pk_fma_f32 v[88:89], v[90:91], v[92:93], v[88:89] op_sel:[1,1,0] op_sel_hi:[1,0,1] neg_lo:[1,0,0]
    v_cvt_pk_bf16_f32 v108, v82, v83
    v_cvt_pk_bf16_f32 v109, v88, v89
    global_load_dwordx4 v[48:51], v58, s[60:61] offset:0
    v_pk_mul_f32 v[84:85], v[82:83], v[86:87] op_sel:[0,0] op_sel_hi:[0,1]
    v_pk_mul_f32 v[90:91], v[88:89], v[92:93] op_sel:[0,0] op_sel_hi:[0,1]
    v_pk_fma_f32 v[84:85], v[82:83], v[86:87], v[84:85] op_sel:[1,1,0] op_sel_hi:[1,0,1] neg_lo:[1,0,0]
    v_pk_fma_f32 v[90:91], v[88:89], v[92:93], v[90:91] op_sel:[1,1,0] op_sel_hi:[1,0,1] neg_lo:[1,0,0]
    v_cvt_pk_bf16_f32 v94, v84, v85
    v_cvt_pk_bf16_f32 v95, v90, v91
    ds_write_b64 v25, v[108:109] offset:5280
    ds_write_b64 v25, v[94:95] offset:5808
    v_pk_mul_f32 v[82:83], v[84:85], v[86:87] op_sel:[0,0] op_sel_hi:[0,1]
    v_pk_mul_f32 v[88:89], v[90:91], v[92:93] op_sel:[0,0] op_sel_hi:[0,1]
    v_pk_fma_f32 v[82:83], v[84:85], v[86:87], v[82:83] op_sel:[1,1,0] op_sel_hi:[1,0,1] neg_lo:[1,0,0]
    v_pk_fma_f32 v[88:89], v[90:91], v[92:93], v[88:89] op_sel:[1,1,0] op_sel_hi:[1,0,1] neg_lo:[1,0,0]
    v_cvt_pk_bf16_f32 v96, v82, v83
    v_cvt_pk_bf16_f32 v97, v88, v89
    global_load_dwordx4 v[52:55], v59, s[60:61] offset:0
    v_pk_mul_f32 v[84:85], v[82:83], v[86:87] op_sel:[0,0] op_sel_hi:[0,1]
    v_pk_mul_f32 v[90:91], v[88:89], v[92:93] op_sel:[0,0] op_sel_hi:[0,1]
    v_pk_fma_f32 v[84:85], v[82:83], v[86:87], v[84:85] op_sel:[1,1,0] op_sel_hi:[1,0,1] neg_lo:[1,0,0]
    v_pk_fma_f32 v[90:91], v[88:89], v[92:93], v[90:91] op_sel:[1,1,0] op_sel_hi:[1,0,1] neg_lo:[1,0,0]
    v_cvt_pk_bf16_f32 v98, v84, v85
    v_cvt_pk_bf16_f32 v99, v90, v91
    ds_write_b64 v25, v[96:97] offset:6336
    ds_write_b64 v25, v[98:99] offset:6864
    v_pk_mul_f32 v[82:83], v[84:85], v[86:87] op_sel:[0,0] op_sel_hi:[0,1]
    v_pk_mul_f32 v[88:89], v[90:91], v[92:93] op_sel:[0,0] op_sel_hi:[0,1]
    v_pk_fma_f32 v[82:83], v[84:85], v[86:87], v[82:83] op_sel:[1,1,0] op_sel_hi:[1,0,1] neg_lo:[1,0,0]
    v_pk_fma_f32 v[88:89], v[90:91], v[92:93], v[88:89] op_sel:[1,1,0] op_sel_hi:[1,0,1] neg_lo:[1,0,0]
    v_cvt_pk_bf16_f32 v100, v82, v83
    v_cvt_pk_bf16_f32 v101, v88, v89
    buffer_load_dword v79, off, s[44:47], s95
    v_pk_mul_f32 v[84:85], v[82:83], v[86:87] op_sel:[0,0] op_sel_hi:[0,1]
    v_pk_mul_f32 v[90:91], v[88:89], v[92:93] op_sel:[0,0] op_sel_hi:[0,1]
    v_pk_fma_f32 v[84:85], v[82:83], v[86:87], v[84:85] op_sel:[1,1,0] op_sel_hi:[1,0,1] neg_lo:[1,0,0]
    v_pk_fma_f32 v[90:91], v[88:89], v[92:93], v[90:91] op_sel:[1,1,0] op_sel_hi:[1,0,1] neg_lo:[1,0,0]
    v_cvt_pk_bf16_f32 v102, v84, v85
    v_cvt_pk_bf16_f32 v103, v90, v91
    ds_write_b64 v25, v[100:101] offset:7392
    ds_write_b64 v25, v[102:103] offset:7920
    v_pk_mul_f32 v[82:83], v[84:85], v[86:87] op_sel:[0,0] op_sel_hi:[0,1]
    v_pk_mul_f32 v[88:89], v[90:91], v[92:93] op_sel:[0,0] op_sel_hi:[0,1]
    v_pk_fma_f32 v[82:83], v[84:85], v[86:87], v[82:83] op_sel:[1,1,0] op_sel_hi:[1,0,1] neg_lo:[1,0,0]
    v_pk_fma_f32 v[88:89], v[90:91], v[92:93], v[88:89] op_sel:[1,1,0] op_sel_hi:[1,0,1] neg_lo:[1,0,0]
    v_cvt_pk_bf16_f32 v104, v82, v83
    v_cvt_pk_bf16_f32 v105, v88, v89
    v_pk_mul_f32 v[84:85], v[82:83], v[86:87] op_sel:[0,0] op_sel_hi:[0,1]
    v_pk_mul_f32 v[90:91], v[88:89], v[92:93] op_sel:[0,0] op_sel_hi:[0,1]
    v_pk_fma_f32 v[84:85], v[82:83], v[86:87], v[84:85] op_sel:[1,1,0] op_sel_hi:[1,0,1] neg_lo:[1,0,0]
    v_pk_fma_f32 v[90:91], v[88:89], v[92:93], v[90:91] op_sel:[1,1,0] op_sel_hi:[1,0,1] neg_lo:[1,0,0]
    v_cvt_pk_bf16_f32 v106, v84, v85
    v_cvt_pk_bf16_f32 v107, v90, v91
    ds_write_b64 v25, v[104:105] offset:8448
    ds_write_b64 v25, v[106:107] offset:8976
    v_pk_mul_f32 v[82:83], v[84:85], v[86:87] op_sel:[0,0] op_sel_hi:[0,1]
    v_pk_mul_f32 v[88:89], v[90:91], v[92:93] op_sel:[0,0] op_sel_hi:[0,1]
    v_pk_fma_f32 v[82:83], v[84:85], v[86:87], v[82:83] op_sel:[1,1,0] op_sel_hi:[1,0,1] neg_lo:[1,0,0]
    v_pk_fma_f32 v[88:89], v[90:91], v[92:93], v[88:89] op_sel:[1,1,0] op_sel_hi:[1,0,1] neg_lo:[1,0,0]
    v_cvt_pk_bf16_f32 v108, v82, v83
    v_cvt_pk_bf16_f32 v109, v88, v89
    v_pk_mul_f32 v[84:85], v[82:83], v[86:87] op_sel:[0,0] op_sel_hi:[0,1]
    v_pk_mul_f32 v[90:91], v[88:89], v[92:93] op_sel:[0,0] op_sel_hi:[0,1]
    v_pk_fma_f32 v[84:85], v[82:83], v[86:87], v[84:85] op_sel:[1,1,0] op_sel_hi:[1,0,1] neg_lo:[1,0,0]
    v_pk_fma_f32 v[90:91], v[88:89], v[92:93], v[90:91] op_sel:[1,1,0] op_sel_hi:[1,0,1] neg_lo:[1,0,0]
    v_cvt_pk_bf16_f32 v94, v84, v85
    v_cvt_pk_bf16_f32 v95, v90, v91
    ds_write_b64 v25, v[108:109] offset:9504
    ds_write_b64 v25, v[94:95] offset:10032
    v_pk_mul_f32 v[82:83], v[84:85], v[86:87] op_sel:[0,0] op_sel_hi:[0,1]
    v_pk_mul_f32 v[88:89], v[90:91], v[92:93] op_sel:[0,0] op_sel_hi:[0,1]
    v_pk_fma_f32 v[82:83], v[84:85], v[86:87], v[82:83] op_sel:[1,1,0] op_sel_hi:[1,0,1] neg_lo:[1,0,0]
    v_pk_fma_f32 v[88:89], v[90:91], v[92:93], v[88:89] op_sel:[1,1,0] op_sel_hi:[1,0,1] neg_lo:[1,0,0]
    v_cvt_pk_bf16_f32 v96, v82, v83
    v_cvt_pk_bf16_f32 v97, v88, v89
    v_pk_mul_f32 v[84:85], v[82:83], v[86:87] op_sel:[0,0] op_sel_hi:[0,1]
    v_pk_mul_f32 v[90:91], v[88:89], v[92:93] op_sel:[0,0] op_sel_hi:[0,1]
    v_pk_fma_f32 v[84:85], v[82:83], v[86:87], v[84:85] op_sel:[1,1,0] op_sel_hi:[1,0,1] neg_lo:[1,0,0]
    v_pk_fma_f32 v[90:91], v[88:89], v[92:93], v[90:91] op_sel:[1,1,0] op_sel_hi:[1,0,1] neg_lo:[1,0,0]
    v_cvt_pk_bf16_f32 v98, v84, v85
    v_cvt_pk_bf16_f32 v99, v90, v91
    ds_write_b64 v25, v[96:97] offset:10560
    ds_write_b64 v25, v[98:99] offset:11088
    v_pk_mul_f32 v[82:83], v[84:85], v[86:87] op_sel:[0,0] op_sel_hi:[0,1]
    v_pk_mul_f32 v[88:89], v[90:91], v[92:93] op_sel:[0,0] op_sel_hi:[0,1]
    v_pk_fma_f32 v[82:83], v[84:85], v[86:87], v[82:83] op_sel:[1,1,0] op_sel_hi:[1,0,1] neg_lo:[1,0,0]
    v_pk_fma_f32 v[88:89], v[90:91], v[92:93], v[88:89] op_sel:[1,1,0] op_sel_hi:[1,0,1] neg_lo:[1,0,0]
    v_cvt_pk_bf16_f32 v100, v82, v83
    v_cvt_pk_bf16_f32 v101, v88, v89
    v_pk_mul_f32 v[84:85], v[82:83], v[86:87] op_sel:[0,0] op_sel_hi:[0,1]
    v_pk_mul_f32 v[90:91], v[88:89], v[92:93] op_sel:[0,0] op_sel_hi:[0,1]
    v_pk_fma_f32 v[84:85], v[82:83], v[86:87], v[84:85] op_sel:[1,1,0] op_sel_hi:[1,0,1] neg_lo:[1,0,0]
    v_pk_fma_f32 v[90:91], v[88:89], v[92:93], v[90:91] op_sel:[1,1,0] op_sel_hi:[1,0,1] neg_lo:[1,0,0]
    v_cvt_pk_bf16_f32 v102, v84, v85
    v_cvt_pk_bf16_f32 v103, v90, v91
    ds_write_b64 v25, v[100:101] offset:11616
    ds_write_b64 v25, v[102:103] offset:12144
    v_pk_mul_f32 v[82:83], v[84:85], v[86:87] op_sel:[0,0] op_sel_hi:[0,1]
    v_pk_mul_f32 v[88:89], v[90:91], v[92:93] op_sel:[0,0] op_sel_hi:[0,1]
    v_pk_fma_f32 v[82:83], v[84:85], v[86:87], v[82:83] op_sel:[1,1,0] op_sel_hi:[1,0,1] neg_lo:[1,0,0]
    v_pk_fma_f32 v[88:89], v[90:91], v[92:93], v[88:89] op_sel:[1,1,0] op_sel_hi:[1,0,1] neg_lo:[1,0,0]
    v_cvt_pk_bf16_f32 v104, v82, v83
    v_cvt_pk_bf16_f32 v105, v88, v89
    v_pk_mul_f32 v[84:85], v[82:83], v[86:87] op_sel:[0,0] op_sel_hi:[0,1]
    v_pk_mul_f32 v[90:91], v[88:89], v[92:93] op_sel:[0,0] op_sel_hi:[0,1]
    v_pk_fma_f32 v[84:85], v[82:83], v[86:87], v[84:85] op_sel:[1,1,0] op_sel_hi:[1,0,1] neg_lo:[1,0,0]
    v_pk_fma_f32 v[90:91], v[88:89], v[92:93], v[90:91] op_sel:[1,1,0] op_sel_hi:[1,0,1] neg_lo:[1,0,0]
    v_cvt_pk_bf16_f32 v106, v84, v85
    v_cvt_pk_bf16_f32 v107, v90, v91
    ds_write_b64 v25, v[104:105] offset:12672
    ds_write_b64 v25, v[106:107] offset:13200
    v_pk_mul_f32 v[82:83], v[84:85], v[86:87] op_sel:[0,0] op_sel_hi:[0,1]
    v_pk_mul_f32 v[88:89], v[90:91], v[92:93] op_sel:[0,0] op_sel_hi:[0,1]
    v_pk_fma_f32 v[82:83], v[84:85], v[86:87], v[82:83] op_sel:[1,1,0] op_sel_hi:[1,0,1] neg_lo:[1,0,0]
    v_pk_fma_f32 v[88:89], v[90:91], v[92:93], v[88:89] op_sel:[1,1,0] op_sel_hi:[1,0,1] neg_lo:[1,0,0]
    v_cvt_pk_bf16_f32 v108, v82, v83
    v_cvt_pk_bf16_f32 v109, v88, v89
    v_pk_mul_f32 v[84:85], v[82:83], v[86:87] op_sel:[0,0] op_sel_hi:[0,1]
    v_pk_mul_f32 v[90:91], v[88:89], v[92:93] op_sel:[0,0] op_sel_hi:[0,1]
    v_pk_fma_f32 v[84:85], v[82:83], v[86:87], v[84:85] op_sel:[1,1,0] op_sel_hi:[1,0,1] neg_lo:[1,0,0]
    v_pk_fma_f32 v[90:91], v[88:89], v[92:93], v[90:91] op_sel:[1,1,0] op_sel_hi:[1,0,1] neg_lo:[1,0,0]
    v_cvt_pk_bf16_f32 v94, v84, v85
    v_cvt_pk_bf16_f32 v95, v90, v91
    ds_write_b64 v25, v[108:109] offset:13728
    ds_write_b64 v25, v[94:95] offset:14256
    v_pk_mul_f32 v[82:83], v[84:85], v[86:87] op_sel:[0,0] op_sel_hi:[0,1]
    v_pk_mul_f32 v[88:89], v[90:91], v[92:93] op_sel:[0,0] op_sel_hi:[0,1]
    v_pk_fma_f32 v[82:83], v[84:85], v[86:87], v[82:83] op_sel:[1,1,0] op_sel_hi:[1,0,1] neg_lo:[1,0,0]
    v_pk_fma_f32 v[88:89], v[90:91], v[92:93], v[88:89] op_sel:[1,1,0] op_sel_hi:[1,0,1] neg_lo:[1,0,0]
    v_cvt_pk_bf16_f32 v96, v82, v83
    v_cvt_pk_bf16_f32 v97, v88, v89
    v_pk_mul_f32 v[84:85], v[82:83], v[86:87] op_sel:[0,0] op_sel_hi:[0,1]
    v_pk_mul_f32 v[90:91], v[88:89], v[92:93] op_sel:[0,0] op_sel_hi:[0,1]
    v_pk_fma_f32 v[84:85], v[82:83], v[86:87], v[84:85] op_sel:[1,1,0] op_sel_hi:[1,0,1] neg_lo:[1,0,0]
    v_pk_fma_f32 v[90:91], v[88:89], v[92:93], v[90:91] op_sel:[1,1,0] op_sel_hi:[1,0,1] neg_lo:[1,0,0]
    v_cvt_pk_bf16_f32 v98, v84, v85
    v_cvt_pk_bf16_f32 v99, v90, v91
    ds_write_b64 v25, v[96:97] offset:14784
    ds_write_b64 v25, v[98:99] offset:15312
    v_pk_mul_f32 v[82:83], v[84:85], v[86:87] op_sel:[0,0] op_sel_hi:[0,1]
    v_pk_mul_f32 v[88:89], v[90:91], v[92:93] op_sel:[0,0] op_sel_hi:[0,1]
    v_pk_fma_f32 v[82:83], v[84:85], v[86:87], v[82:83] op_sel:[1,1,0] op_sel_hi:[1,0,1] neg_lo:[1,0,0]
    v_pk_fma_f32 v[88:89], v[90:91], v[92:93], v[88:89] op_sel:[1,1,0] op_sel_hi:[1,0,1] neg_lo:[1,0,0]
    v_cvt_pk_bf16_f32 v100, v82, v83
    v_cvt_pk_bf16_f32 v101, v88, v89
    v_pk_mul_f32 v[84:85], v[82:83], v[86:87] op_sel:[0,0] op_sel_hi:[0,1]
    v_pk_mul_f32 v[90:91], v[88:89], v[92:93] op_sel:[0,0] op_sel_hi:[0,1]
    v_pk_fma_f32 v[84:85], v[82:83], v[86:87], v[84:85] op_sel:[1,1,0] op_sel_hi:[1,0,1] neg_lo:[1,0,0]
    v_pk_fma_f32 v[90:91], v[88:89], v[92:93], v[90:91] op_sel:[1,1,0] op_sel_hi:[1,0,1] neg_lo:[1,0,0]
    v_cvt_pk_bf16_f32 v102, v84, v85
    v_cvt_pk_bf16_f32 v103, v90, v91
    ds_write_b64 v25, v[100:101] offset:15840
    ds_write_b64 v25, v[102:103] offset:16368
    ds_read_b128 v[176:179], v67 offset:0
    ds_read_b128 v[180:183], v67 offset:32
    ds_read_b128 v[184:187], v67 offset:64
    ds_read_b128 v[188:191], v67 offset:96
    ds_read_b128 v[192:195], v67 offset:128
    ds_read_b128 v[196:199], v67 offset:160
    ds_read_b128 v[200:203], v67 offset:192
    ds_read_b128 v[204:207], v67 offset:224
    ds_read_b128 v[208:211], v67 offset:256
    ds_read_b128 v[212:215], v67 offset:288
    ds_read_b128 v[216:219], v67 offset:320
    ds_read_b128 v[220:223], v67 offset:352
    ds_read_b128 v[224:227], v67 offset:384
    ds_read_b128 v[228:231], v67 offset:416
    ds_read_b128 v[232:235], v67 offset:448
    ds_read_b128 v[236:239], v67 offset:480
    s_waitcnt lgkmcnt(15)
    v_mfma_f32_32x32x16_bf16 v[240:255], v[112:115], v[176:179], 0
    s_mul_i32 s59, s3, 11424
    s_and_b32 s62, s3, 1
    s_mul_i32 s62, s62, 96
    s_waitcnt lgkmcnt(14)
    v_mfma_f32_32x32x16_bf16 v[240:255], v[116:119], v[180:183], v[240:255]
    s_add_u32 s59, s59, s62
    v_mov_b32 v64, s59
    s_lshr_b32 s59, s3, 1
    s_waitcnt lgkmcnt(13)
    v_mfma_f32_32x32x16_bf16 v[240:255], v[120:123], v[184:187], v[240:255]
    s_lshl_b32 s62, s59, 4
    v_lshrrev_b32 v66, s62, v18
    v_lshlrev_b32 v66, 16, v66
    s_waitcnt lgkmcnt(12)
    v_mfma_f32_32x32x16_bf16 v[240:255], v[124:127], v[188:191], v[240:255]
    v_and_b32 v68, 127, v0
    v_cmp_eq_u32 vcc, 127, v68
    s_mul_i32 s62, s59, 16640
    s_waitcnt lgkmcnt(11)
    v_mfma_f32_32x32x16_bf16 v[240:255], v[128:131], v[192:195], v[240:255]
    s_and_b32 s63, s3, 1
    v_cndmask_b32 v66, 0, v66, vcc
    s_lshl_b32 s68, s63, 11
    s_waitcnt lgkmcnt(10)
    v_mfma_f32_32x32x16_bf16 v[240:255], v[132:135], v[196:199], v[240:255]
    s_add_u32 s68, s68, s62
    s_add_u32 s68, s68, 130528
    v_lshl_add_u32 v67, v1, 5, s68
    s_waitcnt lgkmcnt(9)
    v_mfma_f32_32x32x16_bf16 v[240:255], v[136:139], v[200:203], v[240:255]
    s_lshl_b32 s68, s63, 10
    s_sub_u32 s62, s62, s68
    s_add_u32 s62, s62, 133656
    s_waitcnt lgkmcnt(8)
    v_mfma_f32_32x32x16_bf16 v[240:255], v[140:143], v[204:207], v[240:255]
    v_and_b32 v68, 3, v1
    v_mul_u32_u24 v26, 4160, v68
    v_and_b32 v68, 28, v1
    s_waitcnt lgkmcnt(7)
    v_mfma_f32_32x32x16_bf16 v[240:255], v[144:147], v[208:211], v[240:255]
    v_lshlrev_b32 v68, 1, v68
    v_sub_u32 v26, v26, v68
    v_lshl_add_u32 v26, v69, 4, v26
    s_waitcnt lgkmcnt(6)
    v_mfma_f32_32x32x16_bf16 v[240:255], v[148:151], v[212:215], v[240:255]
    v_add_u32 v26, s62, v26
    v_subrev_u32 v27, 2048, v26
    s_mul_i32 s62, s59, 7600
    s_waitcnt lgkmcnt(5)
    v_mfma_f32_32x32x16_bf16 v[240:255], v[152:155], v[216:219], v[240:255]
    s_mul_i32 s68, s63, 16*80
    s_sub_u32 s62, s62, s68
    s_add_u32 s62, s62, 116608
    s_waitcnt lgkmcnt(4)
    v_mfma_f32_32x32x16_bf16 v[240:255], v[156:159], v[220:223], v[240:255]
    v_and_b32 v68, 31, v1
    v_mul_u32_u24 v78, 80, v68
    v_lshl_add_u32 v78, v69, 4, v78
    s_waitcnt lgkmcnt(3)
    v_mfma_f32_32x32x16_bf16 v[240:255], v[160:163], v[224:227], v[240:255]
    buffer_load_dwordx4 v[20:23], v71, s[40:43], s64 offen offset:0 sc1
    v_add_u32 v78, s62, v78
    v_and_b32 v68, 28, v0
    v_bcnt_u32_b32 v68, v68, 0
    s_waitcnt lgkmcnt(2)
    v_mfma_f32_32x32x16_bf16 v[240:255], v[164:167], v[228:231], v[240:255]
    buffer_load_dwordx4 v[56:59], v71, s[40:43], s64 offen offset:1024 sc1
    v_and_b32_e64 v68, 1, v68
    v_bfe_u32 v65, v0, 5, 1
    v_lshl_or_b32 v68, v65, 1, v68
    s_waitcnt lgkmcnt(1)
    v_mfma_f32_32x32x16_bf16 v[240:255], v[168:171], v[232:235], v[240:255]
    buffer_load_dwordx4 v[60:63], v71, s[40:43], s64 offen offset:2048 sc1
    v_bfe_u32 v65, v0, 3, 2
    v_lshl_or_b32 v68, v65, 2, v68
    v_and_b32 v0, 0xc3, v0
    s_waitcnt lgkmcnt(0)
    v_mfma_f32_32x32x16_bf16 v[240:255], v[172:175], v[236:239], v[240:255]
    buffer_load_dwordx4 v[82:85], v71, s[40:43], s64 offen offset:3072 sc1
    v_lshl_or_b32 v0, v68, 2, v0
    v_mov_b32_e64 v68, 0
    ds_write_b32 v64, v68 offset:9776
    s_waitcnt vmcnt(5)
    s_nop 6
    ds_write_b32 v47, v240 offset:0
    ds_write_b32 v47, v241 offset:4
    ds_write_b32 v47, v242 offset:8
    ds_write_b32 v47, v243 offset:12
    ds_write_b32 v48, v244
    ds_write_b32 v49, v245
    ds_write_b32 v50, v246
    ds_write_b32 v51, v247
    ds_write_b32 v52, v248
    ds_write_b32 v53, v249
    ds_write_b32 v54, v250
    ds_write_b32 v55, v251
    s_waitcnt lgkmcnt(0)
    s_barrier
    ds_read2st64_b32 v[112:113], v28 offset0:0 offset1:45
    ds_read2st64_b32 v[114:115], v29 offset0:0 offset1:45
    ds_read2st64_b32 v[116:117], v30 offset0:0 offset1:45
    ds_read2st64_b32 v[118:119], v31 offset0:0 offset1:45
    ds_read2st64_b32 v[120:121], v32 offset0:0 offset1:45
    ds_read2st64_b32 v[122:123], v33 offset0:0 offset1:45
    ds_read2st64_b32 v[124:125], v34 offset0:0 offset1:45
    ds_read2st64_b32 v[126:127], v35 offset0:0 offset1:45
    ds_read2st64_b32 v[128:129], v36 offset0:0 offset1:45
    ds_read2st64_b32 v[130:131], v37 offset0:0 offset1:45
    ds_read2st64_b32 v[132:133], v38 offset0:0 offset1:45
    ds_read2st64_b32 v[134:135], v39 offset0:0 offset1:45
    ds_read2st64_b32 v[136:137], v40 offset0:0 offset1:45
    ds_read2st64_b32 v[138:139], v41 offset0:0 offset1:45
    ds_read2st64_b32 v[140:141], v42 offset0:0 offset1:45
    ds_read2st64_b32 v[142:143], v43 offset0:0 offset1:45
    ds_read2st64_b32 v[144:145], v44 offset0:0 offset1:45
    ds_read2st64_b32 v[146:147], v45 offset0:0 offset1:45
    ds_read2st64_b32 v[148:149], v46 offset0:0 offset1:45
    s_add_u32 s66, s67, 0
    buffer_load_dwordx4 v[2:5], v80, s[40:43], s66 offen sc1
    s_waitcnt lgkmcnt(9)
    s_add_u32 s66, s67, 17408
    buffer_load_dwordx4 v[6:9], v80, s[40:43], s66 offen sc1
    v_add_f32_e64 v112, v112, v113
    v_add_f32 v114, v114, v115
    v_add_f32 v116, v116, v117
    v_add_f32 v118, v118, v119
    v_add_f32 v120, v120, v121
    v_add_f32 v122, v122, v123
    v_add_f32 v124, v124, v125
    v_add_f32 v126, v126, v127
    v_add_f32 v128, v128, v129
    v_add_f32 v130, v130, v131
    s_add_u32 s66, s67, 34816
    buffer_load_dwordx4 v[10:13], v80, s[40:43], s66 offen sc1
    s_waitcnt lgkmcnt(0)
    v_add_f32 v132, v132, v133
    v_add_f32 v134, v134, v135
    v_add_f32 v136, v136, v137
    v_add_f32 v138, v138, v139
    v_add_f32 v140, v140, v141
    v_add_f32 v142, v142, v143
    v_add_f32 v144, v144, v145
    v_add_f32 v146, v146, v147
    v_add_f32_e64 v148, v148, v149
    v_add_f32 v142, v142, v66
    s_add_u32 s66, s67, 52224
    buffer_load_dwordx4 v[14:17], v80, s[40:43], s66 offen sc1
    v_cvt_pk_bf16_f32 v232, v112, v114
    v_cvt_pk_bf16_f32 v233, v116, v118
    v_cvt_pk_bf16_f32 v234, v120, v122
    v_cvt_pk_bf16_f32 v235, v124, v126
    s_add_u32 m0, s23, 0
    s_add_u32 s71, s95, s24
    buffer_load_dwordx4 v73, s[44:47], s71 offen lds
    v_cvt_pk_bf16_f32 v236, v128, v130
    v_cvt_pk_bf16_f32 v237, v132, v134
    v_cvt_pk_bf16_f32 v238, v136, v138
    v_cvt_pk_bf16_f32 v239, v140, v142
    s_add_u32 m0, s23, 1024
    s_nop 0
    buffer_load_dwordx4 v74, s[44:47], s71 offen lds
    ds_write_b128 v67, v[232:235] offset:12480
    ds_write_b128 v67, v[236:239] offset:12496
    v_cvt_pk_bf16_f32 v224, v114, v116
    v_cvt_pk_bf16_f32 v225, v118, v120
    v_cvt_pk_bf16_f32 v226, v122, v124
    v_cvt_pk_bf16_f32 v227, v126, v128
    s_add_u32 m0, s23, 2048
    s_nop 0
    buffer_load_dwordx4 v75, s[44:47], s71 offen lds
    v_cvt_pk_bf16_f32 v228, v130, v132
    v_cvt_pk_bf16_f32 v229, v134, v136
    v_cvt_pk_bf16_f32 v230, v138, v140
    v_cvt_pk_bf16_f32 v231, v142, v144
    s_add_u32 m0, s23, 3072
    s_nop 0
    buffer_load_dwordx4 v76, s[44:47], s71 offen lds
    ds_write_b128 v67, v[224:227] offset:8320
    ds_write_b128 v67, v[228:231] offset:8336
    v_cvt_pk_bf16_f32 v216, v116, v118
    v_cvt_pk_bf16_f32 v217, v120, v122
    v_cvt_pk_bf16_f32 v218, v124, v126
    v_cvt_pk_bf16_f32 v219, v128, v130
    s_add_u32 m0, s100, 4096
    s_add_u32 s71, s95, s25
    buffer_load_dwordx4 v73, s[44:47], s71 offen lds
    v_cvt_pk_bf16_f32 v220, v132, v134
    v_cvt_pk_bf16_f32 v221, v136, v138
    v_cvt_pk_bf16_f32 v222, v140, v142
    v_cvt_pk_bf16_f32 v223, v144, v146
    s_add_u32 m0, s100, 5120
    s_nop 0
    buffer_load_dwordx4 v74, s[44:47], s71 offen lds
    ds_write_b128 v67, v[216:219] offset:4160
    ds_write_b128 v67, v[220:223] offset:4176
    v_cvt_pk_bf16_f32 v208, v118, v120
    v_cvt_pk_bf16_f32 v209, v122, v124
    v_cvt_pk_bf16_f32 v210, v126, v128
    v_cvt_pk_bf16_f32 v211, v130, v132
    s_add_u32 m0, s100, 6144
    s_nop 0
    buffer_load_dwordx4 v75, s[44:47], s71 offen lds
    v_cvt_pk_bf16_f32 v212, v134, v136
    v_cvt_pk_bf16_f32 v213, v138, v140
    v_cvt_pk_bf16_f32 v214, v142, v144
    v_cvt_pk_bf16_f32 v215, v146, v148
    s_add_u32 m0, s100, 7168
    s_nop 0
    buffer_load_dwordx4 v76, s[44:47], s71 offen lds
    ds_write_b128 v67, v[208:211] offset:0
    ds_write_b128 v67, v[212:215] offset:16
    s_mov_b32 s59, 0
    s_waitcnt vmcnt(8)
L_ST1:
    v_xor_b32_e64 v68, s52, v21
    v_xad_u32 v68, v23, s52, v68
    v_xad_u32 v68, v57, s52, v68
    v_xad_u32 v68, v59, s52, v68
    v_xad_u32 v68, v61, s52, v68
    v_xad_u32 v68, v63, s52, v68
    v_xad_u32 v68, v83, s52, v68
    v_xad_u32 v68, v85, s52, v68
    v_xad_u32 v68, v3, s52, v68
    v_xad_u32 v68, v5, s52, v68
    v_xad_u32 v68, v7, s52, v68
    v_xad_u32 v68, v9, s52, v68
    v_xad_u32 v68, v11, s52, v68
    v_xad_u32 v68, v13, s52, v68
    v_xad_u32 v68, v15, s52, v68
    v_xad_u32 v68, v17, s52, v68
    v_cmp_ne_u32 vcc, 0, v68
    s_nop 0
    s_cbranch_vccz L_ST1_x
    s_add_u32 s59, s59, 1
    s_cmp_gt_u32 s59, 65536
    s_cbranch_scc1 L_ST1_x
    buffer_load_dwordx4 v[20:23], v71, s[40:43], s64 offen offset:0 sc1
    buffer_load_dwordx4 v[56:59], v71, s[40:43], s64 offen offset:1024 sc1
    buffer_load_dwordx4 v[60:63], v71, s[40:43], s64 offen offset:2048 sc1
    buffer_load_dwordx4 v[82:85], v71, s[40:43], s64 offen offset:3072 sc1
    s_add_u32 s66, s67, 0
    buffer_load_dwordx4 v[2:5], v80, s[40:43], s66 offen sc1
    s_add_u32 s66, s67, 17408
    buffer_load_dwordx4 v[6:9], v80, s[40:43], s66 offen sc1
    s_add_u32 s66, s67, 34816
    buffer_load_dwordx4 v[10:13], v80, s[40:43], s66 offen sc1
    s_add_u32 s66, s67, 52224
    buffer_load_dwordx4 v[14:17], v80, s[40:43], s66 offen sc1
    s_waitcnt vmcnt(0)
    s_branch L_ST1
L_ST1_x:
    v_add_u32 v64, 1024, v70
    v_and_b32 v21, 0xffff0000, v2
    v_and_b32 v23, 0xffff0000, v4
    v_and_b32 v57, 0xffff0000, v6
    v_and_b32 v59, 0xffff0000, v8
    v_and_b32 v61, 0xffff0000, v10
    v_and_b32 v63, 0xffff0000, v12
    v_and_b32 v83, 0xffff0000, v14
    v_and_b32 v85, 0xffff0000, v16
    ds_write2_b32 v70, v20, v22 offset0:0 offset1:1
    ds_write2_b32 v70, v56, v58 offset0:128 offset1:129
    ds_write2_b32 v64, v60, v62 offset0:0 offset1:1
    ds_write2_b32 v64, v82, v84 offset0:128 offset1:129
    v_rcp_f32 v21, v21
    v_rcp_f32 v23, v23
    v_rcp_f32 v57, v57
    v_rcp_f32 v59, v59
    v_rcp_f32 v61, v61
    v_rcp_f32 v63, v63
    v_rcp_f32 v83, v83
    v_rcp_f32 v85, v85
    v_lshlrev_b32 v2, 16, v2
    v_lshlrev_b32 v176, 16, v20
    v_and_b32 v177, 0xffff0000, v20
    v_lshlrev_b32 v4, 16, v4
    v_lshlrev_b32 v178, 16, v22
    v_and_b32 v179, 0xffff0000, v22
    v_lshlrev_b32 v6, 16, v6
    v_lshlrev_b32 v180, 16, v56
    v_and_b32 v181, 0xffff0000, v56
    v_lshlrev_b32 v8, 16, v8
    v_lshlrev_b32 v182, 16, v58
    v_and_b32 v183, 0xffff0000, v58
    v_lshlrev_b32 v10, 16, v10
    v_lshlrev_b32 v184, 16, v60
    v_and_b32 v185, 0xffff0000, v60
    v_lshlrev_b32 v12, 16, v12
    v_lshlrev_b32 v186, 16, v62
    v_and_b32 v187, 0xffff0000, v62
    v_lshlrev_b32 v14, 16, v14
    v_lshlrev_b32 v188, 16, v82
    v_and_b32 v189, 0xffff0000, v82
    v_lshlrev_b32 v16, 16, v16
    v_lshlrev_b32 v190, 16, v84
    v_and_b32 v191, 0xffff0000, v84
    v_pk_add_f32 v[2:3], v[176:177], v[2:3] op_sel_hi:[1,0] neg_lo:[0,1] neg_hi:[0,1]
    v_pk_add_f32 v[4:5], v[178:179], v[4:5] op_sel_hi:[1,0] neg_lo:[0,1] neg_hi:[0,1]
    v_pk_add_f32 v[6:7], v[180:181], v[6:7] op_sel_hi:[1,0] neg_lo:[0,1] neg_hi:[0,1]
    v_pk_add_f32 v[8:9], v[182:183], v[8:9] op_sel_hi:[1,0] neg_lo:[0,1] neg_hi:[0,1]
    v_pk_add_f32 v[10:11], v[184:185], v[10:11] op_sel_hi:[1,0] neg_lo:[0,1] neg_hi:[0,1]
    v_pk_add_f32 v[12:13], v[186:187], v[12:13] op_sel_hi:[1,0] neg_lo:[0,1] neg_hi:[0,1]
    v_pk_add_f32 v[14:15], v[188:189], v[14:15] op_sel_hi:[1,0] neg_lo:[0,1] neg_hi:[0,1]
    v_pk_add_f32 v[16:17], v[190:191], v[16:17] op_sel_hi:[1,0] neg_lo:[0,1] neg_hi:[0,1]
    v_add_u32 v64, 7600, v72
    v_pk_mul_f32 v[2:3], v[2:3], v[20:21] op_sel:[0,1] op_sel_hi:[1,1]
    v_pk_mul_f32 v[4:5], v[4:5], v[22:23] op_sel:[0,1] op_sel_hi:[1,1]
    v_pk_mul_f32 v[6:7], v[6:7], v[56:57] op_sel:[0,1] op_sel_hi:[1,1]
    v_pk_mul_f32 v[8:9], v[8:9], v[58:59] op_sel:[0,1] op_sel_hi:[1,1]
    v_pk_mul_f32 v[10:11], v[10:11], v[60:61] op_sel:[0,1] op_sel_hi:[1,1]
    v_pk_mul_f32 v[12:13], v[12:13], v[62:63] op_sel:[0,1] op_sel_hi:[1,1]
    v_pk_mul_f32 v[14:15], v[14:15], v[82:83] op_sel:[0,1] op_sel_hi:[1,1]
    v_pk_mul_f32 v[16:17], v[16:17], v[84:85] op_sel:[0,1] op_sel_hi:[1,1]
    v_cvt_pk_bf16_f32 v176, v2, v4
    v_cvt_pk_bf16_f32 v177, v6, v8
    v_cvt_pk_bf16_f32 v178, v10, v12
    v_cvt_pk_bf16_f32 v179, v14, v16
    ds_write2_b32 v72, v176, v177 offset0:0 offset1:80
    ds_write2_b32 v72, v178, v179 offset0:160 offset1:240
    v_cvt_pk_bf16_f32 v180, v3, v5
    v_cvt_pk_bf16_f32 v181, v7, v9
    v_cvt_pk_bf16_f32 v182, v11, v13
    v_cvt_pk_bf16_f32 v183, v15, v17
    ds_write2_b32 v64, v180, v181 offset0:0 offset1:80
    ds_write2_b32 v64, v182, v183 offset0:160 offset1:240
    v_lshlrev_b32 v10, 4, v1
    s_waitcnt lgkmcnt(0)
    s_barrier
    v_and_b32 v64, 63, v0
    v_lshl_add_u32 v64, v64, 5, s100
    ds_read_b64 v[112:113], v26 offset:960
    ds_read_b64 v[114:115], v26 offset:968
    ds_read_b128 v[120:123], v78 offset:1200
    ds_read_b128 v[124:127], v78 offset:3760
    ds_read_b64 v[116:117], v27 offset:960
    ds_read_b64 v[118:119], v27 offset:968
    ds_read_b64 v[128:129], v26 offset:992
    ds_read_b64 v[130:131], v26 offset:1000
    ds_read_b128 v[136:139], v78 offset:1232
    ds_read_b128 v[140:143], v78 offset:3792
    ds_read_b64 v[132:133], v27 offset:992
    ds_read_b64 v[134:135], v27 offset:1000
    ds_read_b128 v[2:5], v64 offset:12288
    ds_read_b128 v[6:9], v64 offset:12304
    s_waitcnt lgkmcnt(6)
    v_mfma_f32_32x32x16_bf16 v[240:255], v[112:115], v[120:123], 0
    ds_read_b64 v[144:145], v26 offset:896
    ds_read_b64 v[146:147], v26 offset:904
    ds_read_b128 v[152:155], v78 offset:1120
    s_lshl_b32 s59, s54, 2
    v_mfma_f32_32x32x16_bf16 v[192:207], v[112:115], v[124:127], 0
    ds_read_b128 v[156:159], v78 offset:3680
    ds_read_b64 v[148:149], v27 offset:896
    ds_read_b64 v[150:151], v27 offset:904
    s_add_u32 s59, s59, s3
    v_mfma_f32_32x32x16_bf16 v[192:207], v[116:119], v[120:123], v[192:207]
    buffer_load_dword v64, v77, s[40:43], 0 offen sc1
    s_add_u32 m0, s100, 8192
    s_add_u32 s71, s95, s30
    buffer_load_dwordx4 v73, s[44:47], s71 offen lds
    s_add_u32 m0, s100, 9216
    s_nop 0
    buffer_load_dwordx4 v74, s[44:47], s71 offen lds
    s_waitcnt lgkmcnt(6)
    v_mfma_f32_32x32x16_bf16 v[240:255], v[128:131], v[136:139], v[240:255]
    ds_read_b64 v[160:161], v26 offset:928
    ds_read_b64 v[162:163], v26 offset:936
    ds_read_b128 v[168:171], v78 offset:1152
    s_mul_i32 s59, s59, 28672
    v_mfma_f32_32x32x16_bf16 v[192:207], v[128:131], v[140:143], v[192:207]
    ds_read_b128 v[172:175], v78 offset:3712
    ds_read_b64 v[164:165], v27 offset:928
    ds_read_b64 v[166:167], v27 offset:936
    s_lshl_b32 s65, s55, 12
    v_mfma_f32_32x32x16_bf16 v[192:207], v[132:135], v[136:139], v[192:207]
    s_add_u32 m0, s100, 10240
    s_nop 0
    buffer_load_dwordx4 v75, s[44:47], s71 offen lds
    s_waitcnt lgkmcnt(6)
    v_mfma_f32_32x32x16_bf16 v[240:255], v[144:147], v[152:155], v[240:255]
    ds_read_b64 v[112:113], v26 offset:832
    ds_read_b64 v[114:115], v26 offset:840
    ds_read_b128 v[120:123], v78 offset:1040
    s_add_u32 s59, s59, s65
    v_mfma_f32_32x32x16_bf16 v[192:207], v[144:147], v[156:159], v[192:207]
    ds_read_b128 v[124:127], v78 offset:3600
    ds_read_b64 v[116:117], v27 offset:832
    ds_read_b64 v[118:119], v27 offset:840
    s_add_u32 s65, s59, 9043968
    v_mfma_f32_32x32x16_bf16 v[192:207], v[148:151], v[152:155], v[192:207]
    s_add_u32 m0, s100, 11264
    s_nop 0
    buffer_load_dwordx4 v76, s[44:47], s71 offen lds
    s_add_u32 m0, s100, 12288
    s_add_u32 s71, s95, s31
    buffer_load_dwordx4 v73, s[44:47], s71 offen lds
    s_waitcnt lgkmcnt(6)
    v_mfma_f32_32x32x16_bf16 v[240:255], v[160:163], v[168:171], v[240:255]
    ds_read_b64 v[128:129], v26 offset:864
    ds_read_b64 v[130:131], v26 offset:872
    ds_read_b128 v[136:139], v78 offset:1072
    v_mov_b32 v13, -1
    v_mfma_f32_32x32x16_bf16 v[192:207], v[160:163], v[172:175], v[192:207]
    ds_read_b128 v[140:143], v78 offset:3632
    ds_read_b64 v[132:133], v27 offset:864
    ds_read_b64 v[134:135], v27 offset:872
    s_mul_i32 s59, s3, 9216
    v_mfma_f32_32x32x16_bf16 v[192:207], v[164:167], v[168:171], v[192:207]
    s_add_u32 m0, s100, 13312
    s_nop 0
    buffer_load_dwordx4 v74, s[44:47], s71 offen lds
    s_waitcnt lgkmcnt(6)
    v_mfma_f32_32x32x16_bf16 v[240:255], v[112:115], v[120:123], v[240:255]
    ds_read_b64 v[144:145], v26 offset:768
    ds_read_b64 v[146:147], v26 offset:776
    ds_read_b128 v[152:155], v78 offset:960
    s_add_u32 s59, s59, 115328
    v_mfma_f32_32x32x16_bf16 v[192:207], v[112:115], v[124:127], v[192:207]
    ds_read_b128 v[156:159], v78 offset:3520
    ds_read_b64 v[148:149], v27 offset:768
    ds_read_b64 v[150:151], v27 offset:776
    v_and_b32 v68, 31, v1
    v_mfma_f32_32x32x16_bf16 v[192:207], v[116:119], v[120:123], v[192:207]
    s_add_u32 m0, s100, 14336
    s_nop 0
    buffer_load_dwordx4 v75, s[44:47], s71 offen lds
    s_add_u32 m0, s100, 15360
    s_nop 0
    buffer_load_dwordx4 v76, s[44:47], s71 offen lds
    s_waitcnt lgkmcnt(6)
    v_mfma_f32_32x32x16_bf16 v[240:255], v[128:131], v[136:139], v[240:255]
    ds_read_b64 v[160:161], v26 offset:800
    ds_read_b64 v[162:163], v26 offset:808
    ds_read_b128 v[168:171], v78 offset:992
    v_mul_u32_u24 v67, 144, v68
    v_mfma_f32_32x32x16_bf16 v[192:207], v[128:131], v[140:143], v[192:207]
    ds_read_b128 v[172:175], v78 offset:3552
    ds_read_b64 v[164:165], v27 offset:800
    ds_read_b64 v[166:167], v27 offset:808
    v_lshl_add_u32 v67, v69, 6, v67
    v_mfma_f32_32x32x16_bf16 v[192:207], v[132:135], v[136:139], v[192:207]
    s_add_u32 m0, s101, 0
    s_add_u32 s71, s96, s24
    buffer_load_dwordx4 v73, s[44:47], s71 offen lds
    s_waitcnt lgkmcnt(6)
    v_mfma_f32_32x32x16_bf16 v[240:255], v[144:147], v[152:155], v[240:255]
    ds_read_b64 v[112:113], v26 offset:704
    ds_read_b64 v[114:115], v26 offset:712
    ds_read_b128 v[120:123], v78 offset:880
    v_add_u32 v67, s59, v67
    v_mfma_f32_32x32x16_bf16 v[192:207], v[144:147], v[156:159], v[192:207]
    ds_read_b128 v[124:127], v78 offset:3440
    ds_read_b64 v[116:117], v27 offset:704
    ds_read_b64 v[118:119], v27 offset:712
    v_lshrrev_b32 v68, 2, v0
    v_mfma_f32_32x32x16_bf16 v[192:207], v[148:151], v[152:155], v[192:207]
    s_add_u32 m0, s101, 1024
    s_nop 0
    buffer_load_dwordx4 v74, s[44:47], s71 offen lds
    s_waitcnt lgkmcnt(6)
    v_mfma_f32_32x32x16_bf16 v[240:255], v[160:163], v[168:171], v[240:255]
    ds_read_b64 v[128:129], v26 offset:736
    ds_read_b64 v[130:131], v26 offset:744
    ds_read_b128 v[136:139], v78 offset:912
    v_mul_u32_u24 v66, 144, v68
    v_mfma_f32_32x32x16_bf16 v[192:207], v[160:163], v[172:175], v[192:207]
    ds_read_b128 v[140:143], v78 offset:3472
    ds_read_b64 v[132:133], v27 offset:736
    ds_read_b64 v[134:135], v27 offset:744
    v_and_b32 v68, 3, v0
    v_mfma_f32_32x32x16_bf16 v[192:207], v[164:167], v[168:171], v[192:207]
    s_add_u32 m0, s101, 2048
    s_nop 0
    buffer_load_dwordx4 v75, s[44:47], s71 offen lds
    s_add_u32 m0, s101, 3072
    s_nop 0
    buffer_load_dwordx4 v76, s[44:47], s71 offen lds
    s_waitcnt lgkmcnt(6)
    v_mfma_f32_32x32x16_bf16 v[240:255], v[112:115], v[120:123], v[240:255]
    ds_read_b64 v[144:145], v26 offset:640
    ds_read_b64 v[146:147], v26 offset:648
    ds_read_b128 v[152:155], v78 offset:800
    v_lshl_add_u32 v66, v68, 4, v66
    v_mfma_f32_32x32x16_bf16 v[192:207], v[112:115], v[124:127], v[192:207]
    ds_read_b128 v[156:159], v78 offset:3360
    ds_read_b64 v[148:149], v27 offset:640
    ds_read_b64 v[150:151], v27 offset:648
    v_add_u32 v66, 115328, v66
    v_mfma_f32_32x32x16_bf16 v[192:207], v[116:119], v[120:123], v[192:207]
    s_add_u32 m0, s101, 4096
    s_add_u32 s71, s96, s25
    buffer_load_dwordx4 v73, s[44:47], s71 offen lds
    s_waitcnt lgkmcnt(6)
    v_mfma_f32_32x32x16_bf16 v[240:255], v[128:131], v[136:139], v[240:255]
    ds_read_b64 v[160:161], v26 offset:672
    ds_read_b64 v[162:163], v26 offset:680
    ds_read_b128 v[168:171], v78 offset:832
    v_lshrrev_b32 v68, 3, v0
    v_mfma_f32_32x32x16_bf16 v[192:207], v[128:131], v[140:143], v[192:207]
    ds_read_b128 v[172:175], v78 offset:3392
    ds_read_b64 v[164:165], v27 offset:672
    ds_read_b64 v[166:167], v27 offset:680
    s_lshl_b32 s59, s53, 4
    v_mfma_f32_32x32x16_bf16 v[192:207], v[132:135], v[136:139], v[192:207]
    s_add_u32 m0, s101, 5120
    s_nop 0
    buffer_load_dwordx4 v74, s[44:47], s71 offen lds
    s_add_u32 m0, s101, 6144
    s_nop 0
    buffer_load_dwordx4 v75, s[44:47], s71 offen lds
    s_waitcnt lgkmcnt(6)
    v_mfma_f32_32x32x16_bf16 v[240:255], v[144:147], v[152:155], v[240:255]
    ds_read_b64 v[112:113], v26 offset:576
    ds_read_b64 v[114:115], v26 offset:584
    ds_read_b128 v[120:123], v78 offset:720
    s_add_u32 s59, s59, s53
    v_mfma_f32_32x32x16_bf16 v[192:207], v[144:147], v[156:159], v[192:207]
    ds_read_b128 v[124:127], v78 offset:3280
    ds_read_b64 v[116:117], v27 offset:576
    ds_read_b64 v[118:119], v27 offset:584
    v_add_u32 v68, s59, v68
    v_mfma_f32_32x32x16_bf16 v[192:207], v[148:151], v[152:155], v[192:207]
    s_waitcnt vmcnt(15)
    v_cmp_ne_u32 vcc, s52, v64
    s_nop 0
    s_cbranch_vccz L_PA_x
    s_mov_b32 s69, 0
L_PA:
    buffer_load_dword v64, v77, s[40:43], 0 offen sc1
    s_add_u32 s69, s69, 1
    s_waitcnt vmcnt(0)
    v_cmpx_ne_u32 vcc, s52, v64
    s_cmp_gt_u32 s69, 65536
    s_cbranch_scc1 L_PA_y
    s_cbranch_vccnz L_PA
L_PA_y:
    s_mov_b64 exec, -1
L_PA_x:
    s_add_u32 m0, s101, 7168
    s_nop 0
    buffer_load_dwordx4 v76, s[44:47], s71 offen lds
    s_waitcnt lgkmcnt(6)
    v_mfma_f32_32x32x16_bf16 v[240:255], v[160:163], v[168:171], v[240:255]
    ds_read_b64 v[128:129], v26 offset:608
    ds_read_b64 v[130:131], v26 offset:616
    ds_read_b128 v[136:139], v78 offset:752
    v_and_b32 v68, 31, v68
    v_mfma_f32_32x32x16_bf16 v[192:207], v[160:163], v[172:175], v[192:207]
    ds_read_b128 v[140:143], v78 offset:3312
    ds_read_b64 v[132:133], v27 offset:608
    ds_read_b64 v[134:135], v27 offset:616
    v_lshlrev_b32 v65, 8, v68
    v_mfma_f32_32x32x16_bf16 v[192:207], v[164:167], v[168:171], v[192:207]
    s_add_u32 m0, s101, 8192
    s_add_u32 s71, s96, s30
    buffer_load_dwordx4 v73, s[44:47], s71 offen lds
    s_add_u32 m0, s101, 9216
    s_nop 0
    buffer_load_dwordx4 v74, s[44:47], s71 offen lds
    s_waitcnt lgkmcnt(6)
    v_mfma_f32_32x32x16_bf16 v[240:255], v[112:115], v[120:123], v[240:255]
    ds_read_b64 v[144:145], v26 offset:512
    ds_read_b64 v[146:147], v26 offset:520
    ds_read_b128 v[152:155], v78 offset:640
    s_and_b32 s59, s53, 1
    v_mfma_f32_32x32x16_bf16 v[192:207], v[112:115], v[124:127], v[192:207]
    ds_read_b128 v[156:159], v78 offset:3200
    ds_read_b64 v[148:149], v27 offset:512
    ds_read_b64 v[150:151], v27 offset:520
    s_lshl_b32 s59, s59, 2
    v_mfma_f32_32x32x16_bf16 v[192:207], v[116:119], v[120:123], v[192:207]
    s_add_u32 m0, s101, 10240
    s_nop 0
    buffer_load_dwordx4 v75, s[44:47], s71 offen lds
    s_waitcnt lgkmcnt(6)
    v_mfma_f32_32x32x16_bf16 v[240:255], v[128:131], v[136:139], v[240:255]
    ds_read_b64 v[160:161], v26 offset:544
    ds_read_b64 v[162:163], v26 offset:552
    ds_read_b128 v[168:171], v78 offset:672
    v_and_b32 v68, 7, v0
    v_mfma_f32_32x32x16_bf16 v[192:207], v[128:131], v[140:143], v[192:207]
    ds_read_b128 v[172:175], v78 offset:3232
    ds_read_b64 v[164:165], v27 offset:544
    ds_read_b64 v[166:167], v27 offset:552
    v_xor_b32 v68, s59, v68
    v_mfma_f32_32x32x16_bf16 v[192:207], v[132:135], v[136:139], v[192:207]
    s_add_u32 m0, s101, 11264
    s_nop 0
    buffer_load_dwordx4 v76, s[44:47], s71 offen lds
    s_waitcnt lgkmcnt(6)
    v_mfma_f32_32x32x16_bf16 v[240:255], v[144:147], v[152:155], v[240:255]
    ds_read_b64 v[112:113], v26 offset:448
    ds_read_b64 v[114:115], v26 offset:456
    ds_read_b128 v[120:123], v78 offset:560
    v_lshl_add_u32 v65, v68, 4, v65
    v_mfma_f32_32x32x16_bf16 v[192:207], v[144:147], v[156:159], v[192:207]
    ds_read_b128 v[124:127], v78 offset:3120
    ds_read_b64 v[116:117], v27 offset:448
    ds_read_b64 v[118:119], v27 offset:456
    s_lshl_b32 s62, s53, 14
    v_mfma_f32_32x32x16_bf16 v[192:207], v[148:151], v[152:155], v[192:207]
    s_add_u32 s70, s99, s48
    s_add_u32 s70, s70, 802816
    buffer_load_dwordx4 a[112:115], v10, s[40:43], s70 offen offset:0 sc1
    buffer_load_dwordx4 a[116:119], v10, s[40:43], s70 offen offset:1024 sc1
    s_waitcnt lgkmcnt(6)
    v_mfma_f32_32x32x16_bf16 v[240:255], v[160:163], v[168:171], v[240:255]
    ds_read_b64 v[128:129], v26 offset:480
    ds_read_b64 v[130:131], v26 offset:488
    ds_read_b128 v[136:139], v78 offset:592
    s_add_u32 s62, s62, 14680064
    v_mfma_f32_32x32x16_bf16 v[192:207], v[160:163], v[172:175], v[192:207]
    ds_read_b128 v[140:143], v78 offset:3152
    ds_read_b64 v[132:133], v27 offset:480
    ds_read_b64 v[134:135], v27 offset:488
    s_and_b32 s59, s53, 2
    v_mfma_f32_32x32x16_bf16 v[192:207], v[164:167], v[168:171], v[192:207]
    buffer_load_dwordx4 a[120:123], v10, s[40:43], s70 offen offset:2048 sc1
    s_waitcnt lgkmcnt(6)
    v_mfma_f32_32x32x16_bf16 v[240:255], v[112:115], v[120:123], v[240:255]
    ds_read_b64 v[144:145], v26 offset:384
    ds_read_b64 v[146:147], v26 offset:392
    ds_read_b128 v[152:155], v78 offset:480
    s_lshl_b32 s59, s59, 12
    v_mfma_f32_32x32x16_bf16 v[192:207], v[112:115], v[124:127], v[192:207]
    ds_read_b128 v[156:159], v78 offset:3040
    ds_read_b64 v[148:149], v27 offset:384
    ds_read_b64 v[150:151], v27 offset:392
    s_add_u32 s62, s62, s59
    v_mfma_f32_32x32x16_bf16 v[192:207], v[116:119], v[120:123], v[192:207]
    buffer_load_dwordx4 a[124:127], v10, s[40:43], s70 offen offset:3072 sc1
    s_waitcnt lgkmcnt(6)
    v_mfma_f32_32x32x16_bf16 v[240:255], v[128:131], v[136:139], v[240:255]
    ds_read_b64 v[160:161], v26 offset:416
    ds_read_b64 v[162:163], v26 offset:424
    ds_read_b128 v[168:171], v78 offset:512
    s_mul_i32 s59, s3, 224
    v_mfma_f32_32x32x16_bf16 v[192:207], v[128:131], v[140:143], v[192:207]
    ds_read_b128 v[172:175], v78 offset:3072
    ds_read_b64 v[164:165], v27 offset:416
    ds_read_b64 v[166:167], v27 offset:424
    s_add_u32 s59, s59, s53
    v_mfma_f32_32x32x16_bf16 v[192:207], v[132:135], v[136:139], v[192:207]
    s_add_u32 s70, s70, 4096
    buffer_load_dwordx4 a[128:131], v10, s[40:43], s70 offen offset:0 sc1
    s_waitcnt lgkmcnt(6)
    v_mfma_f32_32x32x16_bf16 v[240:255], v[144:147], v[152:155], v[240:255]
    ds_read_b64 v[112:113], v26 offset:320
    ds_read_b64 v[114:115], v26 offset:328
    ds_read_b128 v[120:123], v78 offset:400
    s_lshl_b32 s59, s59, 6
    v_mfma_f32_32x32x16_bf16 v[192:207], v[144:147], v[156:159], v[192:207]
    ds_read_b128 v[124:127], v78 offset:2960
    ds_read_b64 v[116:117], v27 offset:320
    ds_read_b64 v[118:119], v27 offset:328
    s_add_u32 s63, s59, 32768
    v_mfma_f32_32x32x16_bf16 v[192:207], v[148:151], v[152:155], v[192:207]
    buffer_load_dwordx4 a[132:135], v10, s[40:43], s70 offen offset:1024 sc1
    s_waitcnt lgkmcnt(6)
    v_mfma_f32_32x32x16_bf16 v[240:255], v[160:163], v[168:171], v[240:255]
    ds_read_b64 v[128:129], v26 offset:352
    ds_read_b64 v[130:131], v26 offset:360
    ds_read_b128 v[136:139], v78 offset:432
    v_lshlrev_b32 v176, 16, v2
    v_mfma_f32_32x32x16_bf16 v[192:207], v[160:163], v[172:175], v[192:207]
    ds_read_b128 v[140:143], v78 offset:2992
    ds_read_b64 v[132:133], v27 offset:352
    ds_read_b64 v[134:135], v27 offset:360
    v_and_b32 v177, 0xffff0000, v2
    v_mfma_f32_32x32x16_bf16 v[192:207], v[164:167], v[168:171], v[192:207]
    buffer_load_dwordx4 a[136:139], v10, s[40:43], s70 offen offset:2048 sc1
    s_waitcnt lgkmcnt(6)
    v_mfma_f32_32x32x16_bf16 v[240:255], v[112:115], v[120:123], v[240:255]
    ds_read_b64 v[144:145], v26 offset:256
    ds_read_b64 v[146:147], v26 offset:264
    ds_read_b128 v[152:155], v78 offset:320
    v_lshlrev_b32 v178, 16, v3
    v_mfma_f32_32x32x16_bf16 v[192:207], v[112:115], v[124:127], v[192:207]
    ds_read_b128 v[156:159], v78 offset:2880
    ds_read_b64 v[148:149], v27 offset:256
    ds_read_b64 v[150:151], v27 offset:264
    v_and_b32 v179, 0xffff0000, v3
    v_mfma_f32_32x32x16_bf16 v[192:207], v[116:119], v[120:123], v[192:207]
    s_add_u32 s70, s99, s49
    s_add_u32 s70, s70, 802816
    buffer_load_dwordx4 a[140:143], v10, s[40:43], s70 offen offset:0 sc1
    s_waitcnt lgkmcnt(6)
    v_mfma_f32_32x32x16_bf16 v[240:255], v[128:131], v[136:139], v[240:255]
    ds_read_b64 v[160:161], v26 offset:288
    ds_read_b64 v[162:163], v26 offset:296
    ds_read_b128 v[168:171], v78 offset:352
    v_lshlrev_b32 v180, 16, v4
    v_mfma_f32_32x32x16_bf16 v[192:207], v[128:131], v[140:143], v[192:207]
    ds_read_b128 v[172:175], v78 offset:2912
    ds_read_b64 v[164:165], v27 offset:288
    ds_read_b64 v[166:167], v27 offset:296
    v_and_b32 v181, 0xffff0000, v4
    v_mfma_f32_32x32x16_bf16 v[192:207], v[132:135], v[136:139], v[192:207]
    buffer_load_dwordx4 a[144:147], v10, s[40:43], s70 offen offset:1024 sc1
    s_waitcnt lgkmcnt(6)
    v_mfma_f32_32x32x16_bf16 v[240:255], v[144:147], v[152:155], v[240:255]
    ds_read_b64 v[112:113], v26 offset:192
    ds_read_b64 v[114:115], v26 offset:200
    ds_read_b128 v[120:123], v78 offset:240
    v_lshlrev_b32 v182, 16, v5
    v_mfma_f32_32x32x16_bf16 v[192:207], v[144:147], v[156:159], v[192:207]
    ds_read_b128 v[124:127], v78 offset:2800
    ds_read_b64 v[116:117], v27 offset:192
    ds_read_b64 v[118:119], v27 offset:200
    v_and_b32 v183, 0xffff0000, v5
    v_mfma_f32_32x32x16_bf16 v[192:207], v[148:151], v[152:155], v[192:207]
    buffer_load_dwordx4 a[148:151], v10, s[40:43], s70 offen offset:2048 sc1
    buffer_store_dwordx4 v[12:15], v10, s[40:43], s65 offen offset:0 sc1
    s_waitcnt lgkmcnt(6)
    v_mfma_f32_32x32x16_bf16 v[240:255], v[160:163], v[168:171], v[240:255]
    ds_read_b64 v[128:129], v26 offset:224
    ds_read_b64 v[130:131], v26 offset:232
    ds_read_b128 v[136:139], v78 offset:272
    v_lshlrev_b32 v184, 16, v6
    v_mfma_f32_32x32x16_bf16 v[192:207], v[160:163], v[172:175], v[192:207]
    ds_read_b128 v[140:143], v78 offset:2832
    ds_read_b64 v[132:133], v27 offset:224
    ds_read_b64 v[134:135], v27 offset:232
    v_and_b32 v185, 0xffff0000, v6
    v_mfma_f32_32x32x16_bf16 v[192:207], v[164:167], v[168:171], v[192:207]
    buffer_load_dwordx4 a[152:155], v10, s[40:43], s70 offen offset:3072 sc1
    s_waitcnt lgkmcnt(6)
    v_mfma_f32_32x32x16_bf16 v[240:255], v[112:115], v[120:123], v[240:255]
    ds_read_b64 v[144:145], v26 offset:128
    ds_read_b64 v[146:147], v26 offset:136
    ds_read_b128 v[152:155], v78 offset:160
    v_lshlrev_b32 v186, 16, v7
    v_mfma_f32_32x32x16_bf16 v[192:207], v[112:115], v[124:127], v[192:207]
    ds_read_b128 v[156:159], v78 offset:2720
    ds_read_b64 v[148:149], v27 offset:128
    ds_read_b64 v[150:151], v27 offset:136
    v_and_b32 v187, 0xffff0000, v7
    v_mfma_f32_32x32x16_bf16 v[192:207], v[116:119], v[120:123], v[192:207]
    s_add_u32 s70, s70, 4096
    buffer_load_dwordx4 a[156:159], v10, s[40:43], s70 offen offset:0 sc1
    s_waitcnt lgkmcnt(6)
    v_mfma_f32_32x32x16_bf16 v[240:255], v[128:131], v[136:139], v[240:255]
    ds_read_b64 v[160:161], v26 offset:160
    ds_read_b64 v[162:163], v26 offset:168
    ds_read_b128 v[168:171], v78 offset:192
    v_lshlrev_b32 v188, 16, v8
    v_mfma_f32_32x32x16_bf16 v[192:207], v[128:131], v[140:143], v[192:207]
    ds_read_b128 v[172:175], v78 offset:2752
    ds_read_b64 v[164:165], v27 offset:160
    ds_read_b64 v[166:167], v27 offset:168
    v_and_b32 v189, 0xffff0000, v8
    v_mfma_f32_32x32x16_bf16 v[192:207], v[132:135], v[136:139], v[192:207]
    buffer_load_dwordx4 a[160:163], v10, s[40:43], s70 offen offset:1024 sc1
    s_waitcnt lgkmcnt(6)
    v_mfma_f32_32x32x16_bf16 v[240:255], v[144:147], v[152:155], v[240:255]
    ds_read_b64 v[112:113], v26 offset:64
    ds_read_b64 v[114:115], v26 offset:72
    ds_read_b128 v[120:123], v78 offset:80
    v_lshlrev_b32 v190, 16, v9
    v_mfma_f32_32x32x16_bf16 v[192:207], v[144:147], v[156:159], v[192:207]
    ds_read_b128 v[124:127], v78 offset:2640
    ds_read_b64 v[116:117], v27 offset:64
    ds_read_b64 v[118:119], v27 offset:72
    v_and_b32 v191, 0xffff0000, v9
    v_mfma_f32_32x32x16_bf16 v[192:207], v[148:151], v[152:155], v[192:207]
    buffer_load_dwordx4 a[164:167], v10, s[40:43], s70 offen offset:2048 sc1
    buffer_store_dwordx4 v[12:15], v10, s[40:43], s65 offen offset:1024 sc1
    s_waitcnt lgkmcnt(6)
    v_mfma_f32_32x32x16_bf16 v[240:255], v[160:163], v[168:171], v[240:255]
    ds_read_b64 v[128:129], v26 offset:96
    ds_read_b64 v[130:131], v26 offset:104
    ds_read_b128 v[136:139], v78 offset:112
    v_mfma_f32_32x32x16_bf16 v[192:207], v[160:163], v[172:175], v[192:207]
    ds_read_b128 v[140:143], v78 offset:2672
    ds_read_b64 v[132:133], v27 offset:96
    ds_read_b64 v[134:135], v27 offset:104
    v_mfma_f32_32x32x16_bf16 v[192:207], v[164:167], v[168:171], v[192:207]
    s_add_u32 s70, s99, s50
    s_add_u32 s70, s70, 802816
    buffer_load_dwordx4 a[168:171], v10, s[40:43], s70 offen offset:0 sc1
    s_waitcnt lgkmcnt(6)
    v_mfma_f32_32x32x16_bf16 v[240:255], v[112:115], v[120:123], v[240:255]
    ds_read_b64 v[144:145], v26 offset:0
    ds_read_b64 v[146:147], v26 offset:8
    ds_read_b128 v[152:155], v78 offset:0
    v_mfma_f32_32x32x16_bf16 v[192:207], v[112:115], v[124:127], v[192:207]
    ds_read_b128 v[156:159], v78 offset:2560
    ds_read_b64 v[148:149], v27 offset:0
    ds_read_b64 v[150:151], v27 offset:8
    v_mfma_f32_32x32x16_bf16 v[192:207], v[116:119], v[120:123], v[192:207]
    buffer_load_dwordx4 a[172:175], v10, s[40:43], s70 offen offset:1024 sc1
    s_waitcnt lgkmcnt(6)
    v_mfma_f32_32x32x16_bf16 v[240:255], v[128:131], v[136:139], v[240:255]
    ds_read_b64 v[160:161], v26 offset:32
    ds_read_b64 v[162:163], v26 offset:40
    ds_read_b128 v[168:171], v78 offset:32
    v_mfma_f32_32x32x16_bf16 v[192:207], v[128:131], v[140:143], v[192:207]
    ds_read_b128 v[172:175], v78 offset:2592
    ds_read_b64 v[164:165], v27 offset:32
    ds_read_b64 v[166:167], v27 offset:40
    v_mfma_f32_32x32x16_bf16 v[192:207], v[132:135], v[136:139], v[192:207]
    buffer_load_dwordx4 a[176:179], v10, s[40:43], s70 offen offset:2048 sc1
    s_waitcnt lgkmcnt(6)
    v_mfma_f32_32x32x16_bf16 v[240:255], v[144:147], v[152:155], v[240:255]
    v_mfma_f32_32x32x16_bf16 v[192:207], v[144:147], v[156:159], v[192:207]
    v_mfma_f32_32x32x16_bf16 v[192:207], v[148:151], v[152:155], v[192:207]
    buffer_load_dwordx4 a[180:183], v10, s[40:43], s70 offen offset:3072 sc1
    buffer_store_dwordx4 v[12:15], v10, s[40:43], s65 offen offset:2048 sc1
    s_waitcnt lgkmcnt(0)
    v_mfma_f32_32x32x16_bf16 v[240:255], v[160:163], v[168:171], v[240:255]
    v_mfma_f32_32x32x16_bf16 v[192:207], v[160:163], v[172:175], v[192:207]
    v_mfma_f32_32x32x16_bf16 v[192:207], v[164:167], v[168:171], v[192:207]
    s_barrier
    s_nop 8
    ds_write_b128 v67, v[240:243] offset:0
    ds_write_b128 v67, v[244:247] offset:16
    ds_write_b128 v67, v[248:251] offset:32
    ds_write_b128 v67, v[252:255] offset:48
    ds_write_b128 v67, v[192:195] offset:4608
    ds_write_b128 v67, v[196:199] offset:4624
    ds_write_b128 v67, v[200:203] offset:4640
    ds_write_b128 v67, v[204:207] offset:4656
    s_waitcnt lgkmcnt(0)
    s_barrier
    ds_read_b128 v[112:115], v66 offset:0
    ds_read_b128 v[116:119], v66 offset:64
    ds_read_b128 v[120:123], v66 offset:9216
    ds_read_b128 v[124:127], v66 offset:9280
    ds_read_b128 v[128:131], v66 offset:18432
    ds_read_b128 v[132:135], v66 offset:18496
    ds_read_b128 v[136:139], v66 offset:27648
    ds_read_b128 v[140:143], v66 offset:27712
    s_waitcnt lgkmcnt(4)
    v_pk_add_f32 v[112:113], v[112:113], v[120:121]
    v_pk_add_f32 v[114:115], v[114:115], v[122:123]
    v_pk_add_f32 v[116:117], v[116:117], v[124:125]
    v_pk_add_f32 v[118:119], v[118:119], v[126:127]
    v_add_f32 v112, v112, v176
    v_add_f32 v113, v113, v178
    v_add_f32 v114, v114, v180
    v_add_f32 v115, v115, v182
    v_add_f32 v116, v116, v184
    v_add_f32 v117, v117, v186
    v_add_f32 v118, v118, v188
    v_add_f32_e64 v119, v119, v190
    v_cvt_pk_bf16_f32 v208, v112, v113
    v_cvt_pk_bf16_f32 v209, v114, v115
    v_cvt_pk_bf16_f32 v210, v116, v117
    v_cvt_pk_bf16_f32 v211, v118, v119
    buffer_store_dwordx4 v[208:211], v65, s[40:43], s62 offen offset:0 sc1
    s_waitcnt lgkmcnt(0)
    v_pk_add_f32 v[128:129], v[128:129], v[136:137]
    v_pk_add_f32 v[130:131], v[130:131], v[138:139]
    v_pk_add_f32 v[132:133], v[132:133], v[140:141]
    v_pk_add_f32 v[134:135], v[134:135], v[142:143]
    v_add_f32 v128, v128, v177
    v_add_f32 v129, v129, v179
    v_add_f32 v130, v130, v181
    v_add_f32 v131, v131, v183
    v_add_f32 v132, v132, v185
    v_add_f32 v133, v133, v187
    v_add_f32 v134, v134, v189
    v_add_f32_e64 v135, v135, v191
    v_cvt_pk_bf16_f32 v212, v128, v129
    v_cvt_pk_bf16_f32 v213, v130, v131
    v_cvt_pk_bf16_f32 v214, v132, v133
    v_cvt_pk_bf16_f32 v215, v134, v135
    buffer_store_dwordx4 v[212:215], v65, s[40:43], s62 offen offset:128 sc1
    v_mov_b32 v68, s52
    s_mov_b64 exec, 1
    buffer_store_dword v68, off, s[40:43], s63 sc1
    s_mov_b64 exec, -1
    s_add_u32 s70, s70, 4096
    buffer_load_dwordx4 a[184:187], v10, s[40:43], s70 offen offset:0 sc1
    buffer_load_dwordx4 a[188:191], v10, s[40:43], s70 offen offset:1024 sc1
    buffer_load_dwordx4 a[192:195], v10, s[40:43], s70 offen offset:2048 sc1
    s_add_u32 s70, s99, s51
    s_add_u32 s70, s70, 802816
    buffer_load_dwordx4 a[196:199], v10, s[40:43], s70 offen offset:0 sc1
    buffer_load_dwordx4 a[200:203], v10, s[40:43], s70 offen offset:1024 sc1
    buffer_load_dwordx4 a[204:207], v10, s[40:43], s70 offen offset:2048 sc1
    buffer_load_dwordx4 a[208:211], v10, s[40:43], s70 offen offset:3072 sc1
    s_add_u32 s70, s70, 4096
    buffer_load_dwordx4 a[212:215], v10, s[40:43], s70 offen offset:0 sc1
    buffer_load_dwordx4 a[216:219], v10, s[40:43], s70 offen offset:1024 sc1
    buffer_load_dwordx4 a[220:223], v10, s[40:43], s70 offen offset:2048 sc1
    v_and_b32 v31, 15, v1
    v_lshrrev_b32 v19, 4, v1
    v_xor_b32 v19, v19, v31
    v_lshlrev_b32 v19, 4, v19
    v_lshl_add_u32 v19, v31, 8, v19
    s_mul_i32 s12, s3, 24576
    s_add_u32 s12, s12, 65536
    v_xor_b32 v31, 0, v19
    v_add_u32 v15, s100, v31
    v_add_u32 v20, s101, v31
    v_add_u32 v24, s12, v31
    v_add_u32 v88, s23, v31
    v_xor_b32 v31, 64, v19
    v_add_u32 v16, s100, v31
    v_add_u32 v21, s101, v31
    v_add_u32 v25, s12, v31
    v_add_u32 v89, s23, v31
    v_xor_b32 v31, 128, v19
    v_add_u32 v17, s100, v31
    v_add_u32 v22, s101, v31
    v_add_u32 v26, s12, v31
    v_add_u32 v90, s23, v31
    v_xor_b32 v31, 192, v19
    v_add_u32 v18, s100, v31
    v_add_u32 v23, s101, v31
    v_add_u32 v27, s12, v31
    v_add_u32_e64 v91, s23, v31
    s_waitcnt vmcnt(13)
    ds_read_b128 a[0:3], v88 offset:0
    ds_read_b128 a[4:7], v89 offset:0
    ds_read_b128 a[8:11], v90 offset:0
    ds_read_b128 a[12:15], v91 offset:0
    ds_read_b128 a[64:67], v20 offset:0
    ds_read_b128 a[68:71], v21 offset:0
    ds_read_b128 a[72:75], v22 offset:0
    ds_read_b128 a[76:79], v23 offset:0
    ds_read_b128 a[80:83], v20 offset:4096
    ds_read_b128 a[84:87], v21 offset:4096
    ds_read_b128 a[88:91], v22 offset:4096
    ds_read_b128 a[92:95], v23 offset:4096
    ds_read_b128 a[96:99], v20 offset:8192
    ds_read_b128 a[100:103], v21 offset:8192
    ds_read_b128 a[104:107], v22 offset:8192
    ds_read_b128 a[108:111], v23 offset:8192
    ds_read_b128 a[16:19], v15 offset:4096
    ds_read_b128 a[20:23], v16 offset:4096
    ds_read_b128 a[24:27], v17 offset:4096
    ds_read_b128 a[28:31], v18 offset:4096
    ds_read_b128 a[32:35], v15 offset:8192
    ds_read_b128 a[36:39], v16 offset:8192
    ds_read_b128 a[40:43], v17 offset:8192
    ds_read_b128 a[44:47], v18 offset:8192
    ds_read_b128 a[48:51], v15 offset:12288
    ds_read_b128 a[52:55], v16 offset:12288
    ds_read_b128 a[56:59], v17 offset:12288
    ds_read_b128 a[60:63], v18 offset:12288
    v_mov_b32 v11, v73
    v_mov_b32 v12, v74
    v_mov_b32 v13, v75
    v_mov_b32 v14, v76
    v_bfe_u32 v31, v1, 2, 2
    v_lshrrev_b32 v2, 5, v1
    v_lshlrev_b32 v28, 4, v2
    v_lshl_add_u32 v2, v2, 3, v31
    v_lshlrev_b32 v2, 7, v2
    v_bfe_u32 v3, v1, 4, 1
    v_lshlrev_b32 v3, 1, v3
    v_bfe_u32 v31, v1, 1, 1
    v_add_u32 v3, v3, v31
    v_bfe_u32 v31, v1, 3, 1
    v_lshlrev_b32 v31, 2, v31
    v_xor_b32 v3, v3, v31
    v_lshl_add_u32 v2, v3, 4, v2
    v_and_b32 v31, 1, v1
    v_lshl_add_u32 v31, v31, 3, v2
    s_lshl_b32 s59, s48, 1
    v_add_u32 v2, s59, v31
    v_xor_b32 v3, 64, v2
    s_lshl_b32 s59, s49, 1
    v_add_u32 v4, s59, v31
    v_xor_b32 v5, 64, v4
    s_lshl_b32 s59, s50, 1
    v_add_u32 v6, s59, v31
    v_xor_b32 v7, 64, v6
    s_lshl_b32 s59, s51, 1
    v_add_u32 v8, s59, v31
    v_xor_b32 v9, 64, v8
    v_lshlrev_b32 v30, 5, v1
    v_add_u32 v30, 57344, v30
    s_lshl_b32 s59, s3, 3
    v_add_u32 v29, s59, v30
    s_lshl_b32 s7, s55, 2
    s_add_u32 s7, s7, s3
    s_lshl_b32 s7, s7, 7
    s_add_u32 s7, s7, 671744
    s_mul_i32 s8, s54, 7168
    s_add_u32 s8, s8, 409600
    v_min_u32 v19, 55, v1
    s_lshr_b32 s59, s48, 7
    v_add_u32 v19, s59, v19
    s_lshr_b32 s59, s54, 3
    s_mul_i32 s59, s59, 224
    v_add_lshl_u32 v19, v19, s59, 6
    v_add_u32 v19, 32768, v19
    s_mul_i32 s59, s3, 7
    s_add_u32 s59, s59, 1128
    v_min_u32 v31, 62, v1
    v_add_lshl_u32 v31, v31, s59, 7
    v_cmp_lt_u32 vcc, 55, v1
    s_nop 1
    v_cndmask_b32 v19, v19, v31, vcc
    s_lshl_b32 s64, s48, 1
    s_lshr_b32 s59, s48, 7
    s_lshl_b32 s6, s59, 14
    s_add_u32 s6, s6, 14680064
    s_add_u32 s59, s59, s54
    v_lshrrev_b32 v31, 4, v1
    v_add_lshl_u32 v143, v31, s59, 8
    v_and_b32 v142, 15, v1
    v_lshlrev_b32 v142, 4, v142
    v_lshl_or_b32 v31, v31, 14, v142
    s_movk_i32 s59, 0x1f00
    v_lshlrev_b32 v142, 8, v1
    v_and_b32 v142, 0x3000, v142
    v_add_u32_e64 v143, v143, v142
    v_and_b32 v142, 0x2000, v142
    v_or_b32_e64 v31, v31, v142
    v_and_or_b32 v136, v143, s59, v31
    v_add_u32 v143, 1024, v143
    v_and_or_b32 v137, v143, s59, v31
    v_add_u32 v143, 1024, v143
    v_and_or_b32 v138, v143, s59, v31
    v_add_u32 v143, 1024, v143
    v_and_or_b32 v139, v143, s59, v31
    v_add_u32 v143, 1024, v143
    v_and_or_b32 v140, v143, s59, v31
    v_add_u32 v143, 1024, v143
    v_and_or_b32 v141, v143, s59, v31
    v_add_u32 v143, 1024, v143
    v_and_or_b32 v142, v143, s59, v31
    v_add_u32 v143, 1024, v143
    v_and_or_b32 v143, v143, s59, v31
    s_add_u32 s63, s63, 1015808
    s_add_u32 s70, s99, s48
    buffer_load_dwordx4 v[144:147], v10, s[40:43], s70 offen offset:0 sc1
    buffer_load_dwordx4 v[148:151], v10, s[40:43], s70 offen offset:1024 sc1
    buffer_load_dwordx4 v[152:155], v10, s[40:43], s70 offen offset:2048 sc1
    buffer_load_dwordx4 v[156:159], v10, s[40:43], s70 offen offset:3072 sc1
    s_add_u32 s70, s70, 4096
    buffer_load_dwordx4 v[160:163], v10, s[40:43], s70 offen offset:0 sc1
    buffer_load_dwordx4 v[164:167], v10, s[40:43], s70 offen offset:1024 sc1
    buffer_load_dwordx4 v[168:171], v10, s[40:43], s70 offen offset:2048 sc1
    s_add_u32 s70, s99, s49
    buffer_load_dwordx4 v[172:175], v10, s[40:43], s70 offen offset:0 sc1
    s_lshl_b32 s59, s55, 19
    s_add_u32 s59, s59, 5373952
    s_lshl_b32 s62, s3, 17
    s_add_u32 s11, s59, s62
    s_lshr_b32 s62, s54, 3
    s_lshl_b32 s62, s62, 17
    s_add_u32 s59, s59, s62
    s_lshl_b32 s62, s3, 15
    s_add_u32 s59, s59, s62
    s_and_b32 s62, s54, 7
    s_lshl_b32 s62, s62, 12
    s_add_u32 s9, s59, s62
    s_lshr_b32 s62, s54, 3
    s_lshl_b32 s62, s62, 15
    s_xor_b32 s9, s9, s62
    s_lshl_b32 s62, s3, 15
    s_add_u32 s11, s11, s62
    s_and_b32 s62, s55, 1
    s_lshl_b32 s62, s62, 12
    s_xor_b32 s9, s9, s62
    s_add_u32 s11, s11, s62
    s_lshl_b32 s59, s55, 5
    s_add_u32 s59, s59, s54
    s_lshl_b32 s59, s59, 2
    s_add_u32 s59, s59, s3
    s_lshl_b32 s59, s59, 7
    s_add_u32 s10, s59, 163840
    s_add_u32 s59, s55, 0
    s_sub_u32 s62, s59, 7
    s_cselect_b32 s59, s59, s62
    s_lshl_b32 s16, s59, 12
    s_add_u32 s59, s55, 1
    s_sub_u32 s62, s59, 7
    s_cselect_b32 s59, s59, s62
    s_lshl_b32 s17, s59, 12
    s_add_u32 s59, s55, 2
    s_sub_u32 s62, s59, 7
    s_cselect_b32 s59, s59, s62
    s_lshl_b32 s18, s59, 12
    s_add_u32 s59, s55, 3
    s_sub_u32 s62, s59, 7
    s_cselect_b32 s59, s59, s62
    s_lshl_b32 s19, s59, 12
    s_add_u32 s59, s55, 4
    s_sub_u32 s62, s59, 7
    s_cselect_b32 s59, s59, s62
    s_lshl_b32 s20, s59, 12
    s_add_u32 s59, s55, 5
    s_sub_u32 s62, s59, 7
    s_cselect_b32 s59, s59, s62
    s_lshl_b32 s21, s59, 12
    s_add_u32 s59, s55, 6
    s_sub_u32 s62, s59, 7
    s_cselect_b32 s59, s59, s62
    s_lshl_b32 s22, s59, 12
    s_mul_i32 s15, s55, 114688
    s_add_u32 s15, s15, 4521984
    s_lshl_b32 s65, s55, 2
    s_mul_i32 s66, s3, 6
    s_add_u32 s66, s66, s65
    s_add_u32 s65, s65, s3
    s_add_u32 s59, s66, 4
    s_sub_u32 s62, s59, 28
    s_cselect_b32 s59, s59, s62
    s_lshl_b32 s59, s59, 12
    s_add_u32 s26, s59, s15
    s_add_u32 s59, s66, 5
    s_sub_u32 s62, s59, 28
    s_cselect_b32 s59, s59, s62
    s_lshl_b32 s59, s59, 12
    s_add_u32 s27, s59, s15
    s_add_u32 s59, s66, 6
    s_sub_u32 s62, s59, 28
    s_cselect_b32 s59, s59, s62
    s_lshl_b32 s59, s59, 12
    s_add_u32 s34, s59, s15
    s_add_u32 s59, s66, 7
    s_sub_u32 s62, s59, 28
    s_cselect_b32 s59, s59, s62
    s_lshl_b32 s59, s59, 12
    s_add_u32 s35, s59, s15
    s_add_u32 s59, s66, 8
    s_sub_u32 s62, s59, 28
    s_cselect_b32 s59, s59, s62
    s_lshl_b32 s59, s59, 12
    s_add_u32 s36, s59, s15
    s_add_u32 s59, s66, 9
    s_sub_u32 s62, s59, 28
    s_cselect_b32 s59, s59, s62
    s_lshl_b32 s59, s59, 12
    s_add_u32 s37, s59, s15
    s_add_u32 s59, s65, 0
    s_sub_u32 s62, s59, 28
    s_cselect_b32 s59, s59, s62
    s_lshl_b32 s59, s59, 12
    s_add_u32 s5, s59, s15
    s_waitcnt lgkmcnt(0)
    s_barrier
    s_mov_b32 s59, 0
L_PH:
    buffer_load_dword v31, v19, s[40:43], 0 offen sc1
    s_add_u32 s59, s59, 1
    s_waitcnt vmcnt(0)
    v_cmpx_ne_u32_e64 vcc, s52, v31
    s_cmp_gt_u32 s59, 65536
    s_cbranch_scc1 L_PH_y
    s_cbranch_vccnz L_PH
L_PH_y:
    s_mov_b64 exec, -1
L_PH_x:
    s_mov_b32 m0, s64
    s_mov_b32 s59, s6
    buffer_load_dwordx4 v136, s[40:43], s59 offen offset:0 sc1 lds
    s_add_u32 s59, s59, 64512
    buffer_load_dwordx4 v137, s[40:43], s59 offen offset:1024 sc1 lds
    s_add_u32 s59, s59, 64512
    buffer_load_dwordx4 v138, s[40:43], s59 offen offset:2048 sc1 lds
    s_add_u32 s59, s59, 64512
    buffer_load_dwordx4 v139, s[40:43], s59 offen offset:3072 sc1 lds
    s_add_u32 s59, s59, 68608
    s_add_u32 m0, m0, 4096
    s_nop 0
    buffer_load_dwordx4 v140, s[40:43], s59 offen offset:0 sc1 lds
    s_add_u32 s59, s59, 64512
    buffer_load_dwordx4 v141, s[40:43], s59 offen offset:1024 sc1 lds
    s_add_u32 s59, s59, 64512
    buffer_load_dwordx4 v142, s[40:43], s59 offen offset:2048 sc1 lds
    s_add_u32 s59, s59, 64512
    buffer_load_dwordx4 v143, s[40:43], s59 offen offset:3072 sc1 lds
    s_add_u32 s59, s59, 68608
    s_add_u32 m0, m0, 4096
    s_nop 0
    buffer_load_dwordx4 v136, s[40:43], s59 offen offset:0 sc1 lds
    s_add_u32 s59, s59, 64512
    buffer_load_dwordx4 v137, s[40:43], s59 offen offset:1024 sc1 lds
    s_add_u32 s59, s59, 64512
    buffer_load_dwordx4 v138, s[40:43], s59 offen offset:2048 sc1 lds
    s_add_u32 s59, s59, 64512
    buffer_load_dwordx4 v139, s[40:43], s59 offen offset:3072 sc1 lds
    s_add_u32 s59, s59, 68608
    s_add_u32 m0, m0, 4096
    s_nop 0
    buffer_load_dwordx4 v140, s[40:43], s59 offen offset:0 sc1 lds
    s_add_u32 s59, s59, 64512
    buffer_load_dwordx4 v141, s[40:43], s59 offen offset:1024 sc1 lds
    v_mov_b32 v31, s52
    s_mov_b64 exec, 1
    buffer_store_dword v31, off, s[40:43], s63 sc1
    s_mov_b64 exec, -1
    s_or_b32 s59, s2, s3
    s_cmp_lg_u32 s59, 0
    s_cbranch_scc1 L_EPX
    v_mov_b32_e64 v31, s52
    s_mov_b64 exec, 1
    buffer_store_dword v31, off, s[40:43], s59 sc1
    s_mov_b64 exec, -1
L_EPX:
    s_lshl_b32 s59, s54, 2
    s_add_u32 s59, s59, s3
    s_mul_i32 s13, s59, 28672
    s_add_u32 s13, s13, 9043968
    s_lshl_b32 s59, s59, 10
    s_lshl_b32 s62, s55, 7
    s_add_u32 s59, s59, s62
    s_add_u32 s14, s59, 278528
    s_add_u32 s67, s13, s16
    s_add_u32 s66, s14, 507904
    s_lshl_b32 s59, s24, 5
    s_add_u32 s61, s59, s11
    s_lshl_b32 s59, s25, 5
    s_add_u32 s100, s59, s11
    s_lshl_b32 s59, s30, 5
    s_add_u32 s101, s59, s11
    s_lshl_b32 s59, s31, 5
    s_add_u32 s68, s59, s11
    s_lshl_b32 s59, s53, 14
    s_add_u32 s59, s59, 14688256
    s_and_b32 s62, s53, 3
    s_lshl_b32 s62, s62, 12
    s_xor_b32 s59, s59, s62
    s_cmp_eq_u32 s3, 0
    s_cselect_b32 s9, s59, s9
    s_lshl_b32 s59, s3, 3
    s_add_u32 s59, s59, s55
    s_lshl_b32 s59, s59, 5
    s_add_u32 s59, s59, s54
    s_lshl_b32 s59, s59, 7
    s_add_u32 s69, s59, 1179648
    s_lshr_b32 s59, s55, 2
    s_lshl_b32 s62, s3, 1
    s_add_u32 s59, s59, s62
    s_mul_i32 s59, s59, 28
    s_and_b32 s62, s55, 3
    s_lshl_b32 s62, s62, 3
    s_add_u32 s59, s59, s62
    s_lshl_b32 s59, s59, 14
    s_add_u32 s62, s59, 14688256
    s_cmp_eq_u32 s55, 3
    s_cselect_b32 s65, 393216, 0
    s_cmp_ge_u32 s24, 512
    s_cselect_b32 s59, s65, 0
    s_add_u32 s59, s59, s62
    s_lshl_b32 s53, s24, 7
    s_add_u32 s53, s53, s59
    s_and_b32 s59, s24, 256
    s_lshl_b32 s59, s59, 5
    s_xor_b32 s53, s53, s59
    s_cmp_ge_u32 s25, 512
    s_cselect_b32 s59, s65, 0
    s_add_u32 s59, s59, s62
    s_lshl_b32 s56, s25, 7
    s_add_u32 s56, s56, s59
    s_and_b32 s59, s25, 256
    s_lshl_b32 s59, s59, 5
    s_xor_b32 s56, s56, s59
    s_cmp_ge_u32 s30, 512
    s_cselect_b32 s59, s65, 0
    s_add_u32 s59, s59, s62
    s_lshl_b32 s57, s30, 7
    s_add_u32 s57, s57, s59
    s_and_b32 s59, s30, 256
    s_lshl_b32 s59, s59, 5
    s_xor_b32 s57, s57, s59
    s_cmp_ge_u32 s31, 512
    s_cselect_b32 s59, s65, 0
    s_add_u32 s59, s59, s62
    s_lshl_b32 s60, s31, 7
    s_add_u32 s60, s60, s59
    s_and_b32 s59, s31, 256
    s_lshl_b32 s59, s59, 5
    s_xor_b32 s60, s60, s59
    s_waitcnt vmcnt(13)
    ds_read_b64_tr_b16 v[88:89], v2 offset:0
    ds_read_b64_tr_b16 v[90:91], v2 offset:512
    ds_read_b64_tr_b16 v[92:93], v3 offset:0
    ds_read_b64_tr_b16 v[94:95], v3 offset:512
    s_add_u32 s71, s7, 3584
    buffer_load_dwordx4 v[40:43], v28, s[40:43], s71 offen sc1
    s_waitcnt vmcnt(12)
    ds_read_b64_tr_b16 v[96:97], v2 offset:2048
    ds_read_b64_tr_b16 v[98:99], v2 offset:2560
    ds_read_b64_tr_b16 v[100:101], v3 offset:2048
    ds_read_b64_tr_b16 v[102:103], v3 offset:2560
    s_waitcnt lgkmcnt(4)
    v_dot2_f32_bf16 v20, v88, s58, 0
    v_dot2_f32_bf16 v21, v88, v88, 0
    v_dot2_f32_bf16 v22, v92, s58, 0
    v_dot2_f32_bf16 v23, v92, v92, 0
    v_dot2_f32_bf16 v20, v89, s58, v20
    v_dot2_f32_bf16 v21, v89, v89, v21
    v_dot2_f32_bf16 v22, v93, s58, v22
    v_dot2_f32_bf16 v23, v93, v93, v23
    v_dot2_f32_bf16 v20, v90, s58, v20
    v_dot2_f32_bf16 v21, v90, v90, v21
    v_dot2_f32_bf16 v22, v94, s58, v22
    v_dot2_f32_bf16 v23, v94, v94, v23
    v_dot2_f32_bf16 v20, v91, s58, v20
    v_dot2_f32_bf16 v21, v91, v91, v21
    v_dot2_f32_bf16 v22, v95, s58, v22
    v_dot2_f32_bf16 v23, v95, v95, v23
    s_add_u32 s71, s7, 3584
    buffer_load_dwordx4 v[44:47], v28, s[40:43], s71 offen offset:32 sc1
    s_waitcnt vmcnt(11)
    ds_read_b64_tr_b16 v[104:105], v2 offset:4096
    ds_read_b64_tr_b16 v[106:107], v2 offset:4608
    ds_read_b64_tr_b16 v[108:109], v3 offset:4096
    ds_read_b64_tr_b16 v[110:111], v3 offset:4608
    s_waitcnt lgkmcnt(4)
    v_dot2_f32_bf16 v20, v96, s58, v20
    v_dot2_f32_bf16 v21, v96, v96, v21
    v_dot2_f32_bf16 v22, v100, s58, v22
    v_dot2_f32_bf16 v23, v100, v100, v23
    v_dot2_f32_bf16 v20, v97, s58, v20
    v_dot2_f32_bf16 v21, v97, v97, v21
    v_dot2_f32_bf16 v22, v101, s58, v22
    v_dot2_f32_bf16 v23, v101, v101, v23
    v_dot2_f32_bf16 v20, v98, s58, v20
    v_dot2_f32_bf16 v21, v98, v98, v21
    v_dot2_f32_bf16 v22, v102, s58, v22
    v_dot2_f32_bf16 v23, v102, v102, v23
    v_dot2_f32_bf16 v20, v99, s58, v20
    v_dot2_f32_bf16 v21, v99, v99, v21
    v_dot2_f32_bf16 v22, v103, s58, v22
    v_dot2_f32_bf16 v23, v103, v103, v23
    s_add_u32 s71, s7, 3584
    buffer_load_dwordx4 v[48:51], v28, s[40:43], s71 offen offset:64 sc1
    s_waitcnt vmcnt(10)
    ds_read_b64_tr_b16 v[112:113], v2 offset:6144
    ds_read_b64_tr_b16 v[114:115], v2 offset:6656
    ds_read_b64_tr_b16 v[116:117], v3 offset:6144
    ds_read_b64_tr_b16 v[118:119], v3 offset:6656
    s_waitcnt lgkmcnt(4)
    v_dot2_f32_bf16 v20, v104, s58, v20
    v_dot2_f32_bf16 v21, v104, v104, v21
    v_dot2_f32_bf16 v22, v108, s58, v22
    v_dot2_f32_bf16 v23, v108, v108, v23
    v_dot2_f32_bf16 v20, v105, s58, v20
    v_dot2_f32_bf16 v21, v105, v105, v21
    v_dot2_f32_bf16 v22, v109, s58, v22
    v_dot2_f32_bf16 v23, v109, v109, v23
    v_dot2_f32_bf16 v20, v106, s58, v20
    v_dot2_f32_bf16 v21, v106, v106, v21
    v_dot2_f32_bf16 v22, v110, s58, v22
    v_dot2_f32_bf16 v23, v110, v110, v23
    v_dot2_f32_bf16 v20, v107, s58, v20
    v_dot2_f32_bf16 v21, v107, v107, v21
    v_dot2_f32_bf16 v22, v111, s58, v22
    v_dot2_f32_bf16 v23, v111, v111, v23
    s_add_u32 s71, s7, 3584
    buffer_load_dwordx4 v[52:55], v28, s[40:43], s71 offen offset:96 sc1
    s_waitcnt vmcnt(9)
    ds_read_b64_tr_b16 v[120:121], v2 offset:8192
    ds_read_b64_tr_b16 v[122:123], v2 offset:8704
    ds_read_b64_tr_b16 v[124:125], v3 offset:8192
    ds_read_b64_tr_b16 v[126:127], v3 offset:8704
    s_waitcnt lgkmcnt(4)
    v_dot2_f32_bf16 v20, v112, s58, v20
    v_dot2_f32_bf16 v21, v112, v112, v21
    v_dot2_f32_bf16 v22, v116, s58, v22
    v_dot2_f32_bf16 v23, v116, v116, v23
    v_dot2_f32_bf16 v20, v113, s58, v20
    v_dot2_f32_bf16 v21, v113, v113, v21
    v_dot2_f32_bf16 v22, v117, s58, v22
    v_dot2_f32_bf16 v23, v117, v117, v23
    v_dot2_f32_bf16 v20, v114, s58, v20
    v_dot2_f32_bf16 v21, v114, v114, v21
    v_dot2_f32_bf16 v22, v118, s58, v22
    v_dot2_f32_bf16 v23, v118, v118, v23
    v_dot2_f32_bf16 v20, v115, s58, v20
    v_dot2_f32_bf16 v21, v115, v115, v21
    v_dot2_f32_bf16 v22, v119, s58, v22
    v_dot2_f32_bf16 v23, v119, v119, v23
    buffer_load_dwordx4 v[176:179], v10, s[40:43], s70 offen offset:1024 sc1
    s_waitcnt vmcnt(8)
    ds_read_b64_tr_b16 v[128:129], v2 offset:10240
    ds_read_b64_tr_b16 v[130:131], v2 offset:10752
    ds_read_b64_tr_b16 v[132:133], v3 offset:10240
    ds_read_b64_tr_b16 v[134:135], v3 offset:10752
    s_waitcnt lgkmcnt(4)
    v_dot2_f32_bf16 v20, v120, s58, v20
    v_dot2_f32_bf16 v21, v120, v120, v21
    v_dot2_f32_bf16 v22, v124, s58, v22
    v_dot2_f32_bf16 v23, v124, v124, v23
    v_dot2_f32_bf16 v20, v121, s58, v20
    v_dot2_f32_bf16 v21, v121, v121, v21
    v_dot2_f32_bf16 v22, v125, s58, v22
    v_dot2_f32_bf16 v23, v125, v125, v23
    v_dot2_f32_bf16 v20, v122, s58, v20
    v_dot2_f32_bf16 v21, v122, v122, v21
    v_dot2_f32_bf16 v22, v126, s58, v22
    v_dot2_f32_bf16 v23, v126, v126, v23
    v_dot2_f32_bf16 v20, v123, s58, v20
    v_dot2_f32_bf16 v21, v123, v123, v21
    v_dot2_f32_bf16 v22, v127, s58, v22
    v_dot2_f32_bf16 v23, v127, v127, v23
    buffer_load_dwordx4 v[180:183], v10, s[40:43], s70 offen offset:2048 sc1
    s_waitcnt vmcnt(7)
    ds_read_b64_tr_b16 v[136:137], v2 offset:12288
    ds_read_b64_tr_b16 v[138:139], v2 offset:12800
    ds_read_b64_tr_b16 v[140:141], v3 offset:12288
    ds_read_b64_tr_b16 v[142:143], v3 offset:12800
    s_waitcnt lgkmcnt(4)
    v_dot2_f32_bf16 v20, v128, s58, v20
    v_dot2_f32_bf16 v21, v128, v128, v21
    v_dot2_f32_bf16 v22, v132, s58, v22
    v_dot2_f32_bf16 v23, v132, v132, v23
    v_dot2_f32_bf16 v20, v129, s58, v20
    v_dot2_f32_bf16 v21, v129, v129, v21
    v_dot2_f32_bf16 v22, v133, s58, v22
    v_dot2_f32_bf16 v23, v133, v133, v23
    v_dot2_f32_bf16 v20, v130, s58, v20
    v_dot2_f32_bf16 v21, v130, v130, v21
    v_dot2_f32_bf16 v22, v134, s58, v22
    v_dot2_f32_bf16 v23, v134, v134, v23
    v_dot2_f32_bf16 v20, v131, s58, v20
    v_dot2_f32_bf16 v21, v131, v131, v21
    v_dot2_f32_bf16 v22, v135, s58, v22
    v_dot2_f32_bf16 v23, v135, v135, v23
    buffer_load_dwordx4 v[184:187], v10, s[40:43], s70 offen offset:3072 sc1
    s_waitcnt lgkmcnt(0)
    v_dot2_f32_bf16 v20, v136, s58, v20
    v_dot2_f32_bf16 v21, v136, v136, v21
    v_dot2_f32_bf16 v22, v140, s58, v22
    v_dot2_f32_bf16 v23, v140, v140, v23
    v_dot2_f32_bf16 v20, v137, s58, v20
    v_dot2_f32_bf16 v21, v137, v137, v21
    s_nop 0
    v_dot2_f32_bf16 v22, v141, s58, v22
    v_dot2_f32_bf16 v23, v141, v141, v23
    v_dot2_f32_bf16 v20, v138, s58, v20
    v_dot2_f32_bf16 v21, v138, v138, v21
    v_dot2_f32_bf16 v22, v142, s58, v22
    v_dot2_f32_bf16 v23, v142, v142, v23
    v_dot2_f32_bf16 v20, v139, s58, v20
    v_dot2_f32_bf16 v21, v139, v139, v21
    v_dot2_f32_bf16 v22, v143, s58, v22
    v_dot2_f32_bf16 v23, v143, v143, v23
    s_nop 2
    v_cmp_u_f32 vcc, v21, v23
    s_nop 0
    s_cbranch_vccnz L_HBAD
L_HOK:
    s_add_u32 s70, s70, 4096
    buffer_load_dwordx4 v[188:191], v10, s[40:43], s70 offen offset:0 sc1
    v_permlane32_swap_b32 v20, v22
    v_permlane32_swap_b32 v21, v23
    v_add_f32 v20, v20, v22
    v_add_f32 v21, v21, v23
    ds_write_b64 v29, v[20:21]
    v_mfma_f32_32x32x16_bf16 v[56:71], a[112:115], v[88:91], 0
    s_waitcnt lgkmcnt(0)
    s_barrier
    s_add_u32 m0, s12, 0
    s_add_u32 s71, s96, s31
    buffer_load_dwordx4 v11, s[44:47], s71 offen lds
    v_mfma_f32_32x32x16_bf16 v[72:87], a[112:115], v[92:95], 0
    ds_read_b64_tr_b16 v[88:89], v4 offset:0
    ds_read_b64_tr_b16 v[90:91], v4 offset:512
    ds_read_b64_tr_b16 v[92:93], v5 offset:0
    ds_read_b64_tr_b16 v[94:95], v5 offset:512
    v_mfma_f32_32x32x16_bf16 v[56:71], a[116:119], v[96:99], v[56:71]
    ds_read_b128 v[32:35], v30
    ds_read_b128 v[36:39], v30 offset:16
    s_add_u32 m0, s12, 1024
    s_nop 0
    buffer_load_dwordx4 v12, s[44:47], s71 offen lds
    v_mfma_f32_32x32x16_bf16 v[72:87], a[116:119], v[100:103], v[72:87]
    ds_read_b64_tr_b16 v[96:97], v4 offset:2048
    ds_read_b64_tr_b16 v[98:99], v4 offset:2560
    ds_read_b64_tr_b16 v[100:101], v5 offset:2048
    ds_read_b64_tr_b16 v[102:103], v5 offset:2560
    v_mfma_f32_32x32x16_bf16 v[56:71], a[120:123], v[104:107], v[56:71]
    s_add_u32 m0, s12, 2048
    s_nop 0
    buffer_load_dwordx4 v13, s[44:47], s71 offen lds
    v_mfma_f32_32x32x16_bf16 v[72:87], a[120:123], v[108:111], v[72:87]
    ds_read_b64_tr_b16 v[104:105], v4 offset:4096
    ds_read_b64_tr_b16 v[106:107], v4 offset:4608
    ds_read_b64_tr_b16 v[108:109], v5 offset:4096
    ds_read_b64_tr_b16 v[110:111], v5 offset:4608
    v_mfma_f32_32x32x16_bf16 v[56:71], a[124:127], v[112:115], v[56:71]
    s_add_u32 m0, s12, 3072
    s_nop 0
    buffer_load_dwordx4 v14, s[44:47], s71 offen lds
    v_mfma_f32_32x32x16_bf16 v[72:87], a[124:127], v[116:119], v[72:87]
    ds_read_b64_tr_b16 v[112:113], v4 offset:6144
    ds_read_b64_tr_b16 v[114:115], v4 offset:6656
    ds_read_b64_tr_b16 v[116:117], v5 offset:6144
    ds_read_b64_tr_b16 v[118:119], v5 offset:6656
    v_mfma_f32_32x32x16_bf16 v[56:71], a[128:131], v[120:123], v[56:71]
    s_waitcnt lgkmcnt(12)
    s_add_u32 m0, s12, 4096
    s_add_u32 s71, s97, s24
    buffer_load_dwordx4 v11, s[44:47], s71 offen lds
    v_add_f32 v32, v32, v34
    v_add_f32 v33, v33, v35
    v_mfma_f32_32x32x16_bf16 v[72:87], a[128:131], v[124:127], v[72:87]
    ds_read_b64_tr_b16 v[120:121], v4 offset:8192
    ds_read_b64_tr_b16 v[122:123], v4 offset:8704
    ds_read_b64_tr_b16 v[124:125], v5 offset:8192
    ds_read_b64_tr_b16 v[126:127], v5 offset:8704
    v_add_f32 v36, v36, v38
    v_mfma_f32_32x32x16_bf16 v[56:71], a[132:135], v[128:131], v[56:71]
    s_add_u32 m0, s12, 5120
    s_nop 0
    buffer_load_dwordx4 v12, s[44:47], s71 offen lds
    v_add_f32 v37, v37, v39
    v_add_f32 v32, v32, v36
    v_mfma_f32_32x32x16_bf16 v[72:87], a[132:135], v[132:135], v[72:87]
    ds_read_b64_tr_b16 v[128:129], v4 offset:10240
    ds_read_b64_tr_b16 v[130:131], v4 offset:10752
    ds_read_b64_tr_b16 v[132:133], v5 offset:10240
    ds_read_b64_tr_b16 v[134:135], v5 offset:10752
    v_add_f32 v33, v33, v37
    v_mfma_f32_32x32x16_bf16 v[56:71], a[136:139], v[136:139], v[56:71]
    s_add_u32 m0, s12, 6144
    s_nop 0
    buffer_load_dwordx4 v13, s[44:47], s71 offen lds
    v_mul_f32 v32, 0x3b124925, v32
    v_mul_f32 v33, 0x3b124925, v33
    v_mfma_f32_32x32x16_bf16 v[72:87], a[136:139], v[140:143], v[72:87]
    ds_read_b64_tr_b16 v[136:137], v4 offset:12288
    ds_read_b64_tr_b16 v[138:139], v4 offset:12800
    ds_read_b64_tr_b16 v[140:141], v5 offset:12288
    ds_read_b64_tr_b16 v[142:143], v5 offset:12800
    v_fma_f32 v33, -v32, v32, v33
    v_mfma_f32_32x32x16_bf16 v[56:71], a[140:143], v[88:91], v[56:71]
    s_add_u32 m0, s12, 7168
    s_nop 0
    buffer_load_dwordx4 v14, s[44:47], s71 offen lds
    v_max_f32 v33, 0, v33
    v_cvt_pk_bf16_f32 v33, v32, v33
    v_mfma_f32_32x32x16_bf16 v[72:87], a[140:143], v[92:95], v[72:87]
    ds_read_b64_tr_b16 v[88:89], v6 offset:0
    ds_read_b64_tr_b16 v[90:91], v6 offset:512
    ds_read_b64_tr_b16 v[92:93], v7 offset:0
    ds_read_b64_tr_b16 v[94:95], v7 offset:512
    v_lshlrev_b32 v32, 16, v33
    s_waitcnt lgkmcnt(15)
    v_mfma_f32_32x32x16_bf16 v[56:71], a[144:147], v[96:99], v[56:71]
    s_add_u32 m0, s12, 8192
    s_add_u32 s71, s97, s25
    buffer_load_dwordx4 v11, s[44:47], s71 offen lds
    v_and_b32 v33, 0xffff0000, v33
    v_add_f32 v33, 0x3727c5ac, v33
    v_mfma_f32_32x32x16_bf16 v[72:87], a[144:147], v[100:103], v[72:87]
    ds_read_b64_tr_b16 v[96:97], v6 offset:2048
    ds_read_b64_tr_b16 v[98:99], v6 offset:2560
    ds_read_b64_tr_b16 v[100:101], v7 offset:2048
    ds_read_b64_tr_b16 v[102:103], v7 offset:2560
    v_cvt_pk_bf16_f32 v33, v33, v33
    v_mfma_f32_32x32x16_bf16 v[56:71], a[148:151], v[104:107], v[56:71]
    s_add_u32 m0, s12, 9216
    s_nop 0
    buffer_load_dwordx4 v12, s[44:47], s71 offen lds
    v_and_b32 v33, 0xffff0000, v33
    v_sqrt_f32 v33, v33
    v_mfma_f32_32x32x16_bf16 v[72:87], a[148:151], v[108:111], v[72:87]
    ds_read_b64_tr_b16 v[104:105], v6 offset:4096
    ds_read_b64_tr_b16 v[106:107], v6 offset:4608
    ds_read_b64_tr_b16 v[108:109], v7 offset:4096
    ds_read_b64_tr_b16 v[110:111], v7 offset:4608
    v_cvt_pk_bf16_f32 v33, v33, v33
    v_mfma_f32_32x32x16_bf16 v[56:71], a[152:155], v[112:115], v[56:71]
    s_add_u32 m0, s12, 10240
    s_nop 0
    buffer_load_dwordx4 v13, s[44:47], s71 offen lds
    v_and_b32 v33, 0xffff0000, v33
    v_rcp_f32 v31, v33
    v_mfma_f32_32x32x16_bf16 v[72:87], a[152:155], v[116:119], v[72:87]
    ds_read_b64_tr_b16 v[112:113], v6 offset:6144
    ds_read_b64_tr_b16 v[114:115], v6 offset:6656
    ds_read_b64_tr_b16 v[116:117], v7 offset:6144
    ds_read_b64_tr_b16 v[118:119], v7 offset:6656
    v_mov_b32 v36, v32
    s_waitcnt lgkmcnt(15)
    v_mfma_f32_32x32x16_bf16 v[56:71], a[156:159], v[120:123], v[56:71]
    s_add_u32 m0, s12, 11264
    s_nop 0
    buffer_load_dwordx4 v14, s[44:47], s71 offen lds
    v_mul_f32 v34, 0xc0135761, v31
    v_mul_f32 v35, v31, v31
    v_mfma_f32_32x32x16_bf16 v[72:87], a[156:159], v[124:127], v[72:87]
    ds_read_b64_tr_b16 v[120:121], v6 offset:8192
    ds_read_b64_tr_b16 v[122:123], v6 offset:8704
    ds_read_b64_tr_b16 v[124:125], v7 offset:8192
    ds_read_b64_tr_b16 v[126:127], v7 offset:8704
    v_mul_f32 v31, 0xbdd2d3e8, v31
    v_mfma_f32_32x32x16_bf16 v[56:71], a[160:163], v[128:131], v[56:71]
    buffer_load_dwordx4 v[192:195], v10, s[40:43], s70 offen offset:1024 sc1
    v_mul_f32 v35, v35, v31
    v_mov_b32 v37, v33
    v_mfma_f32_32x32x16_bf16 v[72:87], a[160:163], v[132:135], v[72:87]
    ds_read_b64_tr_b16 v[128:129], v6 offset:10240
    ds_read_b64_tr_b16 v[130:131], v6 offset:10752
    ds_read_b64_tr_b16 v[132:133], v7 offset:10240
    ds_read_b64_tr_b16 v[134:135], v7 offset:10752
    v_mov_b32 v38, v34
    v_mfma_f32_32x32x16_bf16 v[56:71], a[164:167], v[136:139], v[56:71]
    buffer_load_dwordx4 v[196:199], v10, s[40:43], s70 offen offset:2048 sc1
    v_mov_b32 v39, v35
    v_permlane32_swap_b32 v32, v36
    v_mfma_f32_32x32x16_bf16 v[72:87], a[164:167], v[140:143], v[72:87]
    ds_read_b64_tr_b16 v[136:137], v6 offset:12288
    ds_read_b64_tr_b16 v[138:139], v6 offset:12800
    ds_read_b64_tr_b16 v[140:141], v7 offset:12288
    ds_read_b64_tr_b16 v[142:143], v7 offset:12800
    v_permlane32_swap_b32 v33, v37
    s_waitcnt lgkmcnt(15)
    v_mfma_f32_32x32x16_bf16 v[56:71], a[168:171], v[88:91], v[56:71]
    s_add_u32 s70, s99, s50
    buffer_load_dwordx4 v[200:203], v10, s[40:43], s70 offen offset:0 sc1
    v_permlane32_swap_b32 v34, v38
    v_permlane32_swap_b32 v35, v39
    v_mfma_f32_32x32x16_bf16 v[72:87], a[168:171], v[92:95], v[72:87]
    ds_read_b64_tr_b16 v[88:89], v8 offset:0
    ds_read_b64_tr_b16 v[90:91], v8 offset:512
    ds_read_b64_tr_b16 v[92:93], v9 offset:0
    ds_read_b64_tr_b16 v[94:95], v9 offset:512
    v_mfma_f32_32x32x16_bf16 v[56:71], a[172:175], v[96:99], v[56:71]
    buffer_load_dwordx4 v[204:207], v10, s[40:43], s70 offen offset:1024 sc1
    v_mfma_f32_32x32x16_bf16 v[72:87], a[172:175], v[100:103], v[72:87]
    ds_read_b64_tr_b16 v[96:97], v8 offset:2048
    ds_read_b64_tr_b16 v[98:99], v8 offset:2560
    ds_read_b64_tr_b16 v[100:101], v9 offset:2048
    ds_read_b64_tr_b16 v[102:103], v9 offset:2560
    v_mfma_f32_32x32x16_bf16 v[56:71], a[176:179], v[104:107], v[56:71]
    buffer_load_dwordx4 v[208:211], v10, s[40:43], s70 offen offset:2048 sc1
    v_mfma_f32_32x32x16_bf16 v[72:87], a[176:179], v[108:111], v[72:87]
    ds_read_b64_tr_b16 v[104:105], v8 offset:4096
    ds_read_b64_tr_b16 v[106:107], v8 offset:4608
    ds_read_b64_tr_b16 v[108:109], v9 offset:4096
    ds_read_b64_tr_b16 v[110:111], v9 offset:4608
    s_waitcnt lgkmcnt(15)
    v_mfma_f32_32x32x16_bf16 v[56:71], a[180:183], v[112:115], v[56:71]
    buffer_load_dwordx4 v[212:215], v10, s[40:43], s70 offen offset:3072 sc1
    v_mfma_f32_32x32x16_bf16 v[72:87], a[180:183], v[116:119], v[72:87]
    ds_read_b64_tr_b16 v[112:113], v8 offset:6144
    ds_read_b64_tr_b16 v[114:115], v8 offset:6656
    ds_read_b64_tr_b16 v[116:117], v9 offset:6144
    ds_read_b64_tr_b16 v[118:119], v9 offset:6656
    v_mfma_f32_32x32x16_bf16 v[56:71], a[184:187], v[120:123], v[56:71]
    s_add_u32 s70, s70, 4096
    buffer_load_dwordx4 v[216:219], v10, s[40:43], s70 offen offset:0 sc1
    v_mfma_f32_32x32x16_bf16 v[72:87], a[184:187], v[124:127], v[72:87]
    ds_read_b64_tr_b16 v[120:121], v8 offset:8192
    ds_read_b64_tr_b16 v[122:123], v8 offset:8704
    ds_read_b64_tr_b16 v[124:125], v9 offset:8192
    ds_read_b64_tr_b16 v[126:127], v9 offset:8704
    v_mfma_f32_32x32x16_bf16 v[56:71], a[188:191], v[128:131], v[56:71]
    buffer_load_dwordx4 v[220:223], v10, s[40:43], s70 offen offset:1024 sc1
    v_mfma_f32_32x32x16_bf16 v[72:87], a[188:191], v[132:135], v[72:87]
    ds_read_b64_tr_b16 v[128:129], v8 offset:10240
    ds_read_b64_tr_b16 v[130:131], v8 offset:10752
    ds_read_b64_tr_b16 v[132:133], v9 offset:10240
    ds_read_b64_tr_b16 v[134:135], v9 offset:10752
    s_waitcnt lgkmcnt(15)
    v_mfma_f32_32x32x16_bf16 v[56:71], a[192:195], v[136:139], v[56:71]
    s_add_u32 m0, s12, 12288
    s_add_u32 s71, s97, s30
    buffer_load_dwordx4 v11, s[44:47], s71 offen lds
    v_mfma_f32_32x32x16_bf16 v[72:87], a[192:195], v[140:143], v[72:87]
    ds_read_b64_tr_b16 v[136:137], v8 offset:12288
    ds_read_b64_tr_b16 v[138:139], v8 offset:12800
    ds_read_b64_tr_b16 v[140:141], v9 offset:12288
    ds_read_b64_tr_b16 v[142:143], v9 offset:12800
    v_mfma_f32_32x32x16_bf16 v[56:71], a[196:199], v[88:91], v[56:71]
    s_add_u32 m0, s12, 13312
    s_nop 0
    buffer_load_dwordx4 v12, s[44:47], s71 offen lds
    v_mfma_f32_32x32x16_bf16 v[72:87], a[196:199], v[92:95], v[72:87]
    v_mfma_f32_32x32x16_bf16 v[56:71], a[200:203], v[96:99], v[56:71]
    buffer_load_dword v0, v10, s[40:43], s67 offen offset:2048 sc1
    v_mfma_f32_32x32x16_bf16 v[72:87], a[200:203], v[100:103], v[72:87]
    s_waitcnt lgkmcnt(15)
    v_mfma_f32_32x32x16_bf16 v[56:71], a[204:207], v[104:107], v[56:71]
    s_add_u32 m0, s12, 14336
    s_nop 0
    buffer_load_dwordx4 v13, s[44:47], s71 offen lds
    v_mfma_f32_32x32x16_bf16 v[72:87], a[204:207], v[108:111], v[72:87]
    s_waitcnt lgkmcnt(12)
    v_mfma_f32_32x32x16_bf16 v[56:71], a[208:211], v[112:115], v[56:71]
    s_add_u32 m0, s12, 15360
    s_nop 0
    buffer_load_dwordx4 v14, s[44:47], s71 offen lds
    v_mfma_f32_32x32x16_bf16 v[72:87], a[208:211], v[116:119], v[72:87]
    s_waitcnt lgkmcnt(8)
    v_mfma_f32_32x32x16_bf16 v[56:71], a[212:215], v[120:123], v[56:71]
    buffer_load_dwordx4 v[224:227], v10, s[40:43], s70 offen offset:2048 sc1
    v_mfma_f32_32x32x16_bf16 v[72:87], a[212:215], v[124:127], v[72:87]
    s_waitcnt lgkmcnt(4)
    v_mfma_f32_32x32x16_bf16 v[56:71], a[216:219], v[128:131], v[56:71]
    s_add_u32 s70, s99, s51
    buffer_load_dwordx4 v[228:231], v10, s[40:43], s70 offen offset:0 sc1
    v_mfma_f32_32x32x16_bf16 v[72:87], a[216:219], v[132:135], v[72:87]
    s_waitcnt lgkmcnt(0)
    v_mfma_f32_32x32x16_bf16 v[56:71], a[220:223], v[136:139], v[56:71]
    buffer_load_dwordx4 v[232:235], v10, s[40:43], s70 offen offset:1024 sc1
    v_mfma_f32_32x32x16_bf16 v[72:87], a[220:223], v[140:143], v[72:87]
    s_waitcnt vmcnt(32)
    s_nop 8
    v_pk_fma_f32 v[56:57], v[40:41], v[32:33], v[56:57] op_sel:[0,0,0] op_sel_hi:[1,0,1] neg_lo:[0,1,0] neg_hi:[0,1,0]
    v_pk_fma_f32 v[58:59], v[42:43], v[32:33], v[58:59] op_sel:[0,0,0] op_sel_hi:[1,0,1] neg_lo:[0,1,0] neg_hi:[0,1,0]
    v_pk_fma_f32 v[60:61], v[44:45], v[32:33], v[60:61] op_sel:[0,0,0] op_sel_hi:[1,0,1] neg_lo:[0,1,0] neg_hi:[0,1,0]
    v_pk_fma_f32 v[62:63], v[46:47], v[32:33], v[62:63] op_sel:[0,0,0] op_sel_hi:[1,0,1] neg_lo:[0,1,0] neg_hi:[0,1,0]
    v_pk_fma_f32 v[64:65], v[48:49], v[32:33], v[64:65] op_sel:[0,0,0] op_sel_hi:[1,0,1] neg_lo:[0,1,0] neg_hi:[0,1,0]
    v_pk_fma_f32 v[66:67], v[50:51], v[32:33], v[66:67] op_sel:[0,0,0] op_sel_hi:[1,0,1] neg_lo:[0,1,0] neg_hi:[0,1,0]
    v_pk_fma_f32 v[68:69], v[52:53], v[32:33], v[68:69] op_sel:[0,0,0] op_sel_hi:[1,0,1] neg_lo:[0,1,0] neg_hi:[0,1,0]
    v_pk_fma_f32 v[70:71], v[54:55], v[32:33], v[70:71] op_sel:[0,0,0] op_sel_hi:[1,0,1] neg_lo:[0,1,0] neg_hi:[0,1,0]
    v_pk_mul_f32 v[88:89], v[56:57], v[56:57]
    v_pk_mul_f32 v[90:91], v[58:59], v[58:59]
    v_pk_mul_f32 v[92:93], v[60:61], v[60:61]
    v_pk_mul_f32 v[94:95], v[62:63], v[62:63]
    v_pk_mul_f32 v[96:97], v[64:65], v[64:65]
    v_pk_mul_f32 v[98:99], v[66:67], v[66:67]
    v_pk_mul_f32 v[100:101], v[68:69], v[68:69]
    v_pk_mul_f32 v[102:103], v[70:71], v[70:71]
    buffer_load_dwordx4 v[236:239], v10, s[40:43], s70 offen offset:2048 sc1
    v_pk_fma_f32 v[88:89], v[88:89], v[34:35], v[34:35] op_sel:[0,1,0] op_sel_hi:[1,1,0]
    v_pk_fma_f32 v[90:91], v[90:91], v[34:35], v[34:35] op_sel:[0,1,0] op_sel_hi:[1,1,0]
    v_pk_fma_f32 v[92:93], v[92:93], v[34:35], v[34:35] op_sel:[0,1,0] op_sel_hi:[1,1,0]
    v_pk_fma_f32 v[94:95], v[94:95], v[34:35], v[34:35] op_sel:[0,1,0] op_sel_hi:[1,1,0]
    v_pk_fma_f32 v[96:97], v[96:97], v[34:35], v[34:35] op_sel:[0,1,0] op_sel_hi:[1,1,0]
    v_pk_fma_f32 v[98:99], v[98:99], v[34:35], v[34:35] op_sel:[0,1,0] op_sel_hi:[1,1,0]
    v_pk_fma_f32 v[100:101], v[100:101], v[34:35], v[34:35] op_sel:[0,1,0] op_sel_hi:[1,1,0]
    v_pk_fma_f32 v[102:103], v[102:103], v[34:35], v[34:35] op_sel:[0,1,0] op_sel_hi:[1,1,0]
    v_pk_mul_f32 v[88:89], v[88:89], v[56:57]
    v_pk_mul_f32 v[90:91], v[90:91], v[58:59]
    v_pk_mul_f32 v[92:93], v[92:93], v[60:61]
    v_pk_mul_f32 v[94:95], v[94:95], v[62:63]
    v_pk_mul_f32 v[96:97], v[96:97], v[64:65]
    v_pk_mul_f32 v[98:99], v[98:99], v[66:67]
    v_pk_mul_f32 v[100:101], v[100:101], v[68:69]
    v_pk_mul_f32 v[102:103], v[102:103], v[70:71]
    s_add_u32 m0, s12, 16384
    s_add_u32 s71, s97, s31
    buffer_load_dwordx4 v11, s[44:47], s71 offen lds
    v_exp_f32 v88, v88
    v_exp_f32 v89, v89
    v_exp_f32 v90, v90
    v_exp_f32 v91, v91
    v_exp_f32 v92, v92
    v_exp_f32 v93, v93
    v_exp_f32 v94, v94
    v_exp_f32 v95, v95
    s_add_u32 m0, s12, 17408
    s_nop 0
    buffer_load_dwordx4 v12, s[44:47], s71 offen lds
    v_exp_f32 v96, v96
    v_exp_f32 v97, v97
    v_exp_f32 v98, v98
    v_exp_f32 v99, v99
    v_exp_f32 v100, v100
    v_exp_f32 v101, v101
    v_exp_f32 v102, v102
    v_exp_f32_e64 v103, v103
    s_add_u32 m0, s12, 18432
    s_nop 0
    buffer_load_dwordx4 v13, s[44:47], s71 offen lds
    v_pk_fma_f32 v[88:89], v[88:89], v[32:33], v[32:33] op_sel:[0,1,1] op_sel_hi:[1,1,1]
    v_pk_fma_f32 v[90:91], v[90:91], v[32:33], v[32:33] op_sel:[0,1,1] op_sel_hi:[1,1,1]
    v_pk_fma_f32 v[92:93], v[92:93], v[32:33], v[32:33] op_sel:[0,1,1] op_sel_hi:[1,1,1]
    v_pk_fma_f32 v[94:95], v[94:95], v[32:33], v[32:33] op_sel:[0,1,1] op_sel_hi:[1,1,1]
    v_pk_fma_f32 v[96:97], v[96:97], v[32:33], v[32:33] op_sel:[0,1,1] op_sel_hi:[1,1,1]
    v_pk_fma_f32 v[98:99], v[98:99], v[32:33], v[32:33] op_sel:[0,1,1] op_sel_hi:[1,1,1]
    v_pk_fma_f32 v[100:101], v[100:101], v[32:33], v[32:33] op_sel:[0,1,1] op_sel_hi:[1,1,1]
    v_pk_fma_f32 v[102:103], v[102:103], v[32:33], v[32:33] op_sel:[0,1,1] op_sel_hi:[1,1,1]
    v_rcp_f32 v88, v88
    v_rcp_f32 v89, v89
    v_rcp_f32 v90, v90
    v_rcp_f32 v91, v91
    s_add_u32 m0, s12, 19456
    s_nop 0
    buffer_load_dwordx4 v14, s[44:47], s71 offen lds
    v_rcp_f32 v92, v92
    v_rcp_f32 v93, v93
    v_rcp_f32 v94, v94
    v_rcp_f32 v95, v95
    v_rcp_f32 v96, v96
    v_rcp_f32 v97, v97
    v_rcp_f32 v98, v98
    v_rcp_f32 v99, v99
    buffer_load_dwordx4 v[240:243], v10, s[40:43], s70 offen offset:3072 sc1
    v_rcp_f32 v100, v100
    v_rcp_f32 v101, v101
    v_rcp_f32 v102, v102
    v_rcp_f32_e64 v103, v103
    v_pk_mul_f32 v[56:57], v[56:57], v[88:89]
    v_pk_mul_f32 v[58:59], v[58:59], v[90:91]
    v_pk_mul_f32 v[60:61], v[60:61], v[92:93]
    v_pk_mul_f32 v[62:63], v[62:63], v[94:95]
    v_pk_mul_f32 v[64:65], v[64:65], v[96:97]
    v_pk_mul_f32 v[66:67], v[66:67], v[98:99]
    v_pk_mul_f32 v[68:69], v[68:69], v[100:101]
    v_pk_mul_f32 v[70:71], v[70:71], v[102:103]
    s_add_u32 s70, s70, 4096
    buffer_load_dwordx4 v[244:247], v10, s[40:43], s70 offen offset:0 sc1
    v_pk_add_f32 v[104:105], v[56:57], v[58:59]
    v_pk_mul_f32 v[106:107], v[56:57], v[56:57]
    v_pk_fma_f32 v[106:107], v[58:59], v[58:59], v[106:107]
    v_pk_add_f32 v[104:105], v[104:105], v[60:61]
    v_pk_fma_f32 v[106:107], v[60:61], v[60:61], v[106:107]
    v_pk_add_f32 v[104:105], v[104:105], v[62:63]
    v_pk_fma_f32 v[106:107], v[62:63], v[62:63], v[106:107]
    v_pk_add_f32 v[104:105], v[104:105], v[64:65]
    v_pk_fma_f32 v[106:107], v[64:65], v[64:65], v[106:107]
    v_pk_add_f32 v[104:105], v[104:105], v[66:67]
    v_pk_fma_f32 v[106:107], v[66:67], v[66:67], v[106:107]
    v_pk_add_f32 v[104:105], v[104:105], v[68:69]
    v_pk_fma_f32 v[106:107], v[68:69], v[68:69], v[106:107]
    v_pk_add_f32 v[104:105], v[104:105], v[70:71]
    v_pk_fma_f32 v[106:107], v[70:71], v[70:71], v[106:107]
    v_pk_fma_f32 v[72:73], v[40:41], v[36:37], v[72:73] op_sel:[0,0,0] op_sel_hi:[1,0,1] neg_lo:[0,1,0] neg_hi:[0,1,0]
    v_pk_fma_f32 v[74:75], v[42:43], v[36:37], v[74:75] op_sel:[0,0,0] op_sel_hi:[1,0,1] neg_lo:[0,1,0] neg_hi:[0,1,0]
    v_pk_fma_f32 v[76:77], v[44:45], v[36:37], v[76:77] op_sel:[0,0,0] op_sel_hi:[1,0,1] neg_lo:[0,1,0] neg_hi:[0,1,0]
    v_pk_fma_f32 v[78:79], v[46:47], v[36:37], v[78:79] op_sel:[0,0,0] op_sel_hi:[1,0,1] neg_lo:[0,1,0] neg_hi:[0,1,0]
    v_pk_fma_f32 v[80:81], v[48:49], v[36:37], v[80:81] op_sel:[0,0,0] op_sel_hi:[1,0,1] neg_lo:[0,1,0] neg_hi:[0,1,0]
    v_pk_fma_f32 v[82:83], v[50:51], v[36:37], v[82:83] op_sel:[0,0,0] op_sel_hi:[1,0,1] neg_lo:[0,1,0] neg_hi:[0,1,0]
    v_pk_fma_f32 v[84:85], v[52:53], v[36:37], v[84:85] op_sel:[0,0,0] op_sel_hi:[1,0,1] neg_lo:[0,1,0] neg_hi:[0,1,0]
    v_pk_fma_f32 v[86:87], v[54:55], v[36:37], v[86:87] op_sel:[0,0,0] op_sel_hi:[1,0,1] neg_lo:[0,1,0] neg_hi:[0,1,0]
    v_pk_mul_f32 v[88:89], v[72:73], v[72:73]
    v_pk_mul_f32 v[90:91], v[74:75], v[74:75]
    v_pk_mul_f32 v[92:93], v[76:77], v[76:77]
    v_pk_mul_f32 v[94:95], v[78:79], v[78:79]
    v_pk_mul_f32 v[96:97], v[80:81], v[80:81]
    v_pk_mul_f32 v[98:99], v[82:83], v[82:83]
    v_pk_mul_f32 v[100:101], v[84:85], v[84:85]
    v_pk_mul_f32 v[102:103], v[86:87], v[86:87]
    buffer_load_dwordx4 v[40:43], v28, s[40:43], s7 offen offset:0 sc1
    v_pk_fma_f32 v[88:89], v[88:89], v[38:39], v[38:39] op_sel:[0,1,0] op_sel_hi:[1,1,0]
    v_pk_fma_f32 v[90:91], v[90:91], v[38:39], v[38:39] op_sel:[0,1,0] op_sel_hi:[1,1,0]
    v_pk_fma_f32 v[92:93], v[92:93], v[38:39], v[38:39] op_sel:[0,1,0] op_sel_hi:[1,1,0]
    v_pk_fma_f32 v[94:95], v[94:95], v[38:39], v[38:39] op_sel:[0,1,0] op_sel_hi:[1,1,0]
    v_pk_fma_f32 v[96:97], v[96:97], v[38:39], v[38:39] op_sel:[0,1,0] op_sel_hi:[1,1,0]
    v_pk_fma_f32 v[98:99], v[98:99], v[38:39], v[38:39] op_sel:[0,1,0] op_sel_hi:[1,1,0]
    v_pk_fma_f32 v[100:101], v[100:101], v[38:39], v[38:39] op_sel:[0,1,0] op_sel_hi:[1,1,0]
    v_pk_fma_f32 v[102:103], v[102:103], v[38:39], v[38:39] op_sel:[0,1,0] op_sel_hi:[1,1,0]
    v_pk_mul_f32 v[88:89], v[88:89], v[72:73]
    v_pk_mul_f32 v[90:91], v[90:91], v[74:75]
    v_pk_mul_f32 v[92:93], v[92:93], v[76:77]
    v_pk_mul_f32 v[94:95], v[94:95], v[78:79]
    v_pk_mul_f32 v[96:97], v[96:97], v[80:81]
    v_pk_mul_f32 v[98:99], v[98:99], v[82:83]
    v_pk_mul_f32 v[100:101], v[100:101], v[84:85]
    v_pk_mul_f32 v[102:103], v[102:103], v[86:87]
    buffer_load_dwordx4 v[44:47], v28, s[40:43], s7 offen offset:32 sc1
    v_exp_f32 v88, v88
    v_exp_f32 v89, v89
    v_exp_f32 v90, v90
    v_exp_f32 v91, v91
    v_exp_f32 v92, v92
    v_exp_f32 v93, v93
    v_exp_f32 v94, v94
    v_exp_f32 v95, v95
    buffer_load_dwordx4 v[48:51], v28, s[40:43], s7 offen offset:64 sc1
    v_exp_f32 v96, v96
    v_exp_f32 v97, v97
    v_exp_f32 v98, v98
    v_exp_f32 v99, v99
    v_exp_f32 v100, v100
    v_exp_f32 v101, v101
    v_exp_f32 v102, v102
    v_exp_f32 v103, v103
    buffer_load_dwordx4 v[52:55], v28, s[40:43], s7 offen offset:96 sc1
    v_pk_fma_f32 v[88:89], v[88:89], v[36:37], v[36:37] op_sel:[0,1,1] op_sel_hi:[1,1,1]
    v_pk_fma_f32 v[90:91], v[90:91], v[36:37], v[36:37] op_sel:[0,1,1] op_sel_hi:[1,1,1]
    v_pk_fma_f32 v[92:93], v[92:93], v[36:37], v[36:37] op_sel:[0,1,1] op_sel_hi:[1,1,1]
    v_pk_fma_f32 v[94:95], v[94:95], v[36:37], v[36:37] op_sel:[0,1,1] op_sel_hi:[1,1,1]
    v_pk_fma_f32 v[96:97], v[96:97], v[36:37], v[36:37] op_sel:[0,1,1] op_sel_hi:[1,1,1]
    v_pk_fma_f32 v[98:99], v[98:99], v[36:37], v[36:37] op_sel:[0,1,1] op_sel_hi:[1,1,1]
    v_pk_fma_f32 v[100:101], v[100:101], v[36:37], v[36:37] op_sel:[0,1,1] op_sel_hi:[1,1,1]
    v_pk_fma_f32 v[102:103], v[102:103], v[36:37], v[36:37] op_sel:[0,1,1] op_sel_hi:[1,1,1]
    v_rcp_f32 v88, v88
    v_rcp_f32 v89, v89
    v_rcp_f32 v90, v90
    v_rcp_f32 v91, v91
    buffer_load_dwordx4 v[248:251], v10, s[40:43], s70 offen offset:1024 sc1
    v_rcp_f32 v92, v92
    v_rcp_f32 v93, v93
    v_rcp_f32 v94, v94
    v_rcp_f32 v95, v95
    v_rcp_f32 v96, v96
    v_rcp_f32 v97, v97
    v_rcp_f32 v98, v98
    v_rcp_f32 v99, v99
    buffer_load_dwordx4 v[252:255], v10, s[40:43], s70 offen offset:2048 sc1
    v_rcp_f32 v100, v100
    v_rcp_f32 v101, v101
    v_rcp_f32 v102, v102
    v_rcp_f32 v103, v103
    ds_read_b64_tr_b16 v[120:121], v2 offset:0
    ds_read_b64_tr_b16 v[122:123], v2 offset:512
    ds_read_b64_tr_b16 v[124:125], v3 offset:0
    ds_read_b64_tr_b16 v[126:127], v3 offset:512
    ds_read_b64_tr_b16 v[128:129], v2 offset:2048
    ds_read_b64_tr_b16 v[130:131], v2 offset:2560
    ds_read_b64_tr_b16 v[132:133], v3 offset:2048
    ds_read_b64_tr_b16 v[134:135], v3 offset:2560
    v_pk_mul_f32 v[72:73], v[72:73], v[88:89]
    v_pk_mul_f32 v[74:75], v[74:75], v[90:91]
    v_pk_mul_f32 v[76:77], v[76:77], v[92:93]
    v_pk_mul_f32 v[78:79], v[78:79], v[94:95]
    v_pk_mul_f32 v[80:81], v[80:81], v[96:97]
    v_pk_mul_f32 v[82:83], v[82:83], v[98:99]
    v_pk_mul_f32 v[84:85], v[84:85], v[100:101]
    v_pk_mul_f32 v[86:87], v[86:87], v[102:103]
    s_add_u32 m0, s12, 20480
    s_add_u32 s71, s98, s24
    buffer_load_dwordx4 v11, s[44:47], s71 offen lds
    v_pk_add_f32 v[108:109], v[72:73], v[74:75]
    v_pk_mul_f32 v[110:111], v[72:73], v[72:73]
    v_pk_fma_f32 v[110:111], v[74:75], v[74:75], v[110:111]
    s_nop 0
    v_pk_add_f32 v[108:109], v[108:109], v[76:77]
    v_pk_fma_f32 v[110:111], v[76:77], v[76:77], v[110:111]
    v_pk_add_f32 v[108:109], v[108:109], v[78:79]
    v_pk_fma_f32 v[110:111], v[78:79], v[78:79], v[110:111]
    v_pk_add_f32 v[108:109], v[108:109], v[80:81]
    v_pk_fma_f32 v[110:111], v[80:81], v[80:81], v[110:111]
    v_pk_add_f32 v[108:109], v[108:109], v[82:83]
    v_pk_fma_f32 v[110:111], v[82:83], v[82:83], v[110:111]
    v_pk_add_f32 v[108:109], v[108:109], v[84:85]
    v_pk_fma_f32 v[110:111], v[84:85], v[84:85], v[110:111]
    v_pk_add_f32 v[108:109], v[108:109], v[86:87]
    v_pk_fma_f32 v[110:111], v[86:87], v[86:87], v[110:111]
    v_add_f32 v20, v104, v105
    v_add_f32 v21, v106, v107
    v_add_f32 v22, v108, v109
    v_add_f32 v23, v110, v111
    s_nop 0
    v_permlane32_swap_b32 v20, v22
    v_permlane32_swap_b32 v21, v23
    v_add_f32 v20, v20, v22
    v_add_f32 v21, v21, v23
    ds_write_b64 v29, v[20:21] offset:2048
    s_waitcnt lgkmcnt(0)
    s_lshl_b32 s62, s55, 10
    s_add_u32 s62, s62, s8
    s_add_u32 s65, s8, 4096
    v_mfma_f32_32x32x16_bf16 v[88:103], v[144:147], v[120:123], 0
    s_barrier
    ds_read_b128 v[16:19], v30 offset:2048
    ds_read_b128 v[20:23], v30 offset:2064
    ds_read_b64_tr_b16 v[136:137], v2 offset:4096
    ds_read_b64_tr_b16 v[138:139], v2 offset:4608
    s_add_u32 m0, s12, 21504
    s_nop 0
    buffer_load_dwordx4 v12, s[44:47], s71 offen lds
    v_mfma_f32_32x32x16_bf16 v[104:119], v[144:147], v[124:127], 0
    ds_read_b64_tr_b16 v[140:141], v3 offset:4096
    ds_read_b64_tr_b16 v[142:143], v3 offset:4608
    s_waitcnt vmcnt(39)
    ds_read_b128 a[112:115], v24 offset:0
    ds_read_b128 a[116:119], v25 offset:0
    v_mfma_f32_32x32x16_bf16 v[88:103], v[148:151], v[128:131], v[88:103]
    ds_read_b64_tr_b16 v[120:121], v2 offset:6144
    ds_read_b64_tr_b16 v[122:123], v2 offset:6656
    s_add_u32 m0, s12, 22528
    s_nop 0
    buffer_load_dwordx4 v13, s[44:47], s71 offen lds
    ds_read_b128 a[120:123], v26 offset:0
    ds_read_b128 a[124:127], v27 offset:0
    v_mfma_f32_32x32x16_bf16 v[104:119], v[148:151], v[132:135], v[104:119]
    ds_read_b64_tr_b16 v[124:125], v3 offset:6144
    ds_read_b64_tr_b16 v[126:127], v3 offset:6656
    s_waitcnt lgkmcnt(12)
    v_add_f32 v16, v16, v18
    v_add_f32 v17, v17, v19
    v_add_f32 v20, v20, v22
    s_waitcnt vmcnt(36)
    ds_read_b128 a[128:131], v24 offset:4096
    ds_read_b128 a[132:135], v25 offset:4096
    s_waitcnt lgkmcnt(10)
    v_mfma_f32_32x32x16_bf16 v[88:103], v[152:155], v[136:139], v[88:103]
    ds_read_b64_tr_b16 v[128:129], v2 offset:8192
    ds_read_b64_tr_b16 v[130:131], v2 offset:8704
    v_add_f32 v21, v21, v23
    v_add_f32 v16, v16, v20
    v_add_f32 v18, v17, v21
    s_add_u32 m0, s12, 23552
    s_nop 0
    buffer_load_dwordx4 v14, s[44:47], s71 offen lds
    ds_read_b128 a[136:139], v26 offset:4096
    ds_read_b128 a[140:143], v27 offset:4096
    v_mfma_f32_32x32x16_bf16 v[104:119], v[152:155], v[140:143], v[104:119]
    ds_read_b64_tr_b16 v[132:133], v3 offset:8192
    ds_read_b64_tr_b16 v[134:135], v3 offset:8704
    v_mov_b32 v17, s52
    v_mov_b32 v19, s52
    s_lshl_b32 s59, s3, 4
    s_lshl_b64 exec, 0xffff, s59
    buffer_store_dwordx4 v[16:19], v10, s[40:43], s62 offen sc1
    s_mov_b64 exec, -1
    s_waitcnt vmcnt(34)
    ds_read_b128 a[144:147], v24 offset:8192
    ds_read_b128 a[148:151], v25 offset:8192
    s_waitcnt lgkmcnt(10)
    v_mfma_f32_32x32x16_bf16 v[88:103], v[156:159], v[120:123], v[88:103]
    ds_read_b64_tr_b16 v[136:137], v2 offset:10240
    ds_read_b64_tr_b16 v[138:139], v2 offset:10752
    ds_read_b128 a[152:155], v26 offset:8192
    ds_read_b128 a[156:159], v27 offset:8192
    v_mfma_f32_32x32x16_bf16 v[104:119], v[156:159], v[124:127], v[104:119]
    ds_read_b64_tr_b16 v[140:141], v3 offset:10240
    ds_read_b64_tr_b16 v[142:143], v3 offset:10752
    s_waitcnt vmcnt(21)
    ds_read_b128 a[160:163], v24 offset:12288
    s_waitcnt lgkmcnt(9)
    v_mfma_f32_32x32x16_bf16 v[88:103], v[160:163], v[128:131], v[88:103]
    ds_read_b64_tr_b16 v[120:121], v2 offset:12288
    ds_read_b64_tr_b16 v[122:123], v2 offset:12800
    s_waitcnt lgkmcnt(5)
    s_add_u32 m0, s12, 0
    s_add_u32 s71, s98, s25
    buffer_load_dwordx4 v11, s[44:47], s71 offen lds
    ds_read_b128 a[164:167], v25 offset:12288
    v_mfma_f32_32x32x16_bf16 v[104:119], v[160:163], v[132:135], v[104:119]
    ds_read_b64_tr_b16 v[124:125], v3 offset:12288
    ds_read_b64_tr_b16 v[126:127], v3 offset:12800
    ds_read_b128 a[168:171], v26 offset:12288
    s_waitcnt lgkmcnt(7)
    v_mfma_f32_32x32x16_bf16 v[88:103], v[164:167], v[136:139], v[88:103]
    ds_read_b64_tr_b16 v[128:129], v4 offset:0
    ds_read_b64_tr_b16 v[130:131], v4 offset:512
    s_add_u32 m0, s12, 1024
    s_nop 0
    buffer_load_dwordx4 v12, s[44:47], s71 offen lds
    ds_read_b128 a[172:175], v27 offset:12288
    v_mfma_f32_32x32x16_bf16 v[104:119], v[164:167], v[140:143], v[104:119]
    ds_read_b64_tr_b16 v[132:133], v5 offset:0
    ds_read_b64_tr_b16 v[134:135], v5 offset:512
    s_waitcnt vmcnt(15)
    ds_read_b128 a[176:179], v24 offset:16384
    s_waitcnt lgkmcnt(7)
    v_mfma_f32_32x32x16_bf16 v[88:103], v[168:171], v[120:123], v[88:103]
    ds_read_b64_tr_b16 v[136:137], v4 offset:2048
    ds_read_b64_tr_b16 v[138:139], v4 offset:2560
    s_add_u32 m0, s12, 2048
    s_nop 0
    buffer_load_dwordx4 v13, s[44:47], s71 offen lds
    ds_read_b128 a[180:183], v25 offset:16384
    v_lshrrev_b32 v17, 4, v1
    v_mfma_f32_32x32x16_bf16 v[104:119], v[168:171], v[124:127], v[104:119]
    ds_read_b64_tr_b16 v[140:141], v5 offset:2048
    ds_read_b64_tr_b16 v[142:143], v5 offset:2560
    ds_read_b128 a[184:187], v26 offset:16384
    v_bfe_u32 v31, v1, 2, 2
    s_waitcnt lgkmcnt(7)
    v_mfma_f32_32x32x16_bf16 v[88:103], v[172:175], v[128:131], v[88:103]
    ds_read_b64_tr_b16 v[120:121], v4 offset:4096
    ds_read_b64_tr_b16 v[122:123], v4 offset:4608
    s_add_u32 m0, s12, 3072
    s_nop 0
    buffer_load_dwordx4 v14, s[44:47], s71 offen lds
    ds_read_b128 a[188:191], v27 offset:16384
    v_lshl_add_u32 v17, v17, 3, v31
    v_mfma_f32_32x32x16_bf16 v[104:119], v[172:175], v[132:135], v[104:119]
    ds_read_b64_tr_b16 v[124:125], v5 offset:4096
    ds_read_b64_tr_b16 v[126:127], v5 offset:4608
    s_waitcnt vmcnt(5)
    ds_read_b128 a[192:195], v24 offset:20480
    v_lshlrev_b32 v17, 7, v17
    s_waitcnt lgkmcnt(7)
    v_mfma_f32_32x32x16_bf16 v[88:103], v[176:179], v[136:139], v[88:103]
    ds_read_b64_tr_b16 v[128:129], v4 offset:6144
    ds_read_b64_tr_b16 v[130:131], v4 offset:6656
    s_add_u32 m0, s12, 4096
    s_add_u32 s71, s98, s30
    buffer_load_dwordx4 v11, s[44:47], s71 offen lds
    ds_read_b128 a[196:199], v25 offset:20480
    v_bfe_u32 v31, v1, 1, 1
    v_mfma_f32_32x32x16_bf16 v[104:119], v[176:179], v[140:143], v[104:119]
    ds_read_b64_tr_b16 v[132:133], v5 offset:6144
    ds_read_b64_tr_b16 v[134:135], v5 offset:6656
    ds_read_b128 a[200:203], v26 offset:20480
    s_lshl_b32 s59, s3, 1
    s_waitcnt lgkmcnt(7)
    v_mfma_f32_32x32x16_bf16 v[88:103], v[180:183], v[120:123], v[88:103]
    ds_read_b64_tr_b16 v[136:137], v4 offset:8192
    ds_read_b64_tr_b16 v[138:139], v4 offset:8704
    s_add_u32 m0, s12, 5120
    s_nop 0
    buffer_load_dwordx4 v12, s[44:47], s71 offen lds
    ds_read_b128 a[204:207], v27 offset:20480
    v_add_u32 v31, s59, v31
    v_mfma_f32_32x32x16_bf16 v[104:119], v[180:183], v[124:127], v[104:119]
    ds_read_b64_tr_b16 v[140:141], v5 offset:8192
    ds_read_b64_tr_b16 v[142:143], v5 offset:8704
    v_bfe_u32 v18, v1, 3, 1
    s_waitcnt lgkmcnt(6)
    v_mfma_f32_32x32x16_bf16 v[88:103], v[184:187], v[128:131], v[88:103]
    ds_read_b64_tr_b16 v[120:121], v4 offset:10240
    ds_read_b64_tr_b16 v[122:123], v4 offset:10752
    s_add_u32 m0, s12, 6144
    s_nop 0
    buffer_load_dwordx4 v13, s[44:47], s71 offen lds
    v_lshlrev_b32 v18, 2, v18
    v_mfma_f32_32x32x16_bf16 v[104:119], v[184:187], v[132:135], v[104:119]
    ds_read_b64_tr_b16 v[124:125], v5 offset:10240
    ds_read_b64_tr_b16 v[126:127], v5 offset:10752
    v_xor_b32 v31, v31, v18
    s_waitcnt lgkmcnt(4)
    v_mfma_f32_32x32x16_bf16 v[88:103], v[188:191], v[136:139], v[88:103]
    ds_read_b64_tr_b16 v[128:129], v4 offset:12288
    ds_read_b64_tr_b16 v[130:131], v4 offset:12800
    s_add_u32 m0, s12, 7168
    s_nop 0
    buffer_load_dwordx4 v14, s[44:47], s71 offen lds
    v_lshl_add_u32 v17, v31, 4, v17
    v_mfma_f32_32x32x16_bf16 v[104:119], v[188:191], v[140:143], v[104:119]
    ds_read_b64_tr_b16 v[132:133], v5 offset:12288
    ds_read_b64_tr_b16 v[134:135], v5 offset:12800
    v_and_b32 v31, 1, v1
    s_waitcnt lgkmcnt(4)
    v_mfma_f32_32x32x16_bf16 v[88:103], v[192:195], v[120:123], v[88:103]
    ds_read_b64_tr_b16 v[136:137], v6 offset:0
    ds_read_b64_tr_b16 v[138:139], v6 offset:512
    s_add_u32 m0, s12, 8192
    s_add_u32 s71, s98, s31
    buffer_load_dwordx4 v11, s[44:47], s71 offen lds
    v_lshl_add_u32 v17, v31, 3, v17
    v_mfma_f32_32x32x16_bf16 v[104:119], v[192:195], v[124:127], v[104:119]
    ds_read_b64_tr_b16 v[140:141], v7 offset:0
    ds_read_b64_tr_b16 v[142:143], v7 offset:512
    s_lshl_b32 s59, s55, 13
    s_waitcnt lgkmcnt(4)
    v_mfma_f32_32x32x16_bf16 v[88:103], v[196:199], v[128:131], v[88:103]
    ds_read_b64_tr_b16 v[120:121], v6 offset:2048
    ds_read_b64_tr_b16 v[122:123], v6 offset:2560
    s_add_u32 m0, s12, 9216
    s_nop 0
    buffer_load_dwordx4 v12, s[44:47], s71 offen lds
    v_add_u32 v17, s59, v17
    v_mfma_f32_32x32x16_bf16 v[104:119], v[196:199], v[132:135], v[104:119]
    ds_read_b64_tr_b16 v[124:125], v7 offset:2048
    ds_read_b64_tr_b16 v[126:127], v7 offset:2560
    ds_read_b64_tr_b16 v[180:181], v17 offset:0
    s_waitcnt lgkmcnt(5)
    v_mfma_f32_32x32x16_bf16 v[88:103], v[200:203], v[136:139], v[88:103]
    ds_read_b64_tr_b16 v[128:129], v6 offset:4096
    ds_read_b64_tr_b16 v[130:131], v6 offset:4608
    s_add_u32 m0, s12, 10240
    s_nop 0
    buffer_load_dwordx4 v13, s[44:47], s71 offen lds
    ds_read_b64_tr_b16 v[182:183], v17 offset:512
    v_mfma_f32_32x32x16_bf16 v[104:119], v[200:203], v[140:143], v[104:119]
    ds_read_b64_tr_b16 v[132:133], v7 offset:4096
    ds_read_b64_tr_b16 v[134:135], v7 offset:4608
    ds_read_b64_tr_b16 v[184:185], v17 offset:4096
    s_waitcnt lgkmcnt(7)
    v_mfma_f32_32x32x16_bf16 v[88:103], v[204:207], v[120:123], v[88:103]
    ds_read_b64_tr_b16 v[136:137], v6 offset:6144
    ds_read_b64_tr_b16 v[138:139], v6 offset:6656
    s_add_u32 m0, s12, 11264
    s_nop 0
    buffer_load_dwordx4 v14, s[44:47], s71 offen lds
    ds_read_b64_tr_b16 v[186:187], v17 offset:4608
    v_mfma_f32_32x32x16_bf16 v[104:119], v[204:207], v[124:127], v[104:119]
    ds_read_b64_tr_b16 v[140:141], v7 offset:6144
    ds_read_b64_tr_b16 v[142:143], v7 offset:6656
    v_and_b32 v31, 31, v1
    s_waitcnt lgkmcnt(6)
    v_mfma_f32_32x32x16_bf16 v[88:103], v[208:211], v[128:131], v[88:103]
    ds_read_b64_tr_b16 v[120:121], v6 offset:8192
    ds_read_b64_tr_b16 v[122:123], v6 offset:8704
    s_and_b32 s62, s2, 1
    s_lshl_b32 s62, s62, 12
    s_sub_u32 s65, s65, s62
    s_add_u32 s62, s62, s8
    buffer_load_dwordx4 v[152:155], v10, s[40:43], s62 offen offset:0 sc1
    v_mul_u32_u24 v15, 72, v31
    v_mfma_f32_32x32x16_bf16 v[104:119], v[208:211], v[132:135], v[104:119]
    ds_read_b64_tr_b16 v[124:125], v7 offset:8192
    ds_read_b64_tr_b16 v[126:127], v7 offset:8704
    buffer_load_dwordx4 v[156:159], v10, s[40:43], s62 offen offset:1024 sc1
    v_lshrrev_b32 v31, 5, v1
    s_waitcnt lgkmcnt(4)
    v_mfma_f32_32x32x16_bf16 v[88:103], v[212:215], v[136:139], v[88:103]
    ds_read_b64_tr_b16 v[128:129], v6 offset:10240
    ds_read_b64_tr_b16 v[130:131], v6 offset:10752
    buffer_load_dwordx4 v[160:163], v10, s[40:43], s62 offen offset:2048 sc1
    v_lshl_add_u32 v15, v31, 3, v15
    v_mfma_f32_32x32x16_bf16 v[104:119], v[212:215], v[140:143], v[104:119]
    ds_read_b64_tr_b16 v[132:133], v7 offset:10240
    ds_read_b64_tr_b16 v[134:135], v7 offset:10752
    buffer_load_dwordx4 v[164:167], v10, s[40:43], s8 offen offset:3072 sc1
    s_mov_b32 s59, s12
    s_waitcnt lgkmcnt(4)
    v_mfma_f32_32x32x16_bf16 v[88:103], v[216:219], v[120:123], v[88:103]
    ds_read_b64_tr_b16 v[136:137], v6 offset:12288
    ds_read_b64_tr_b16 v[138:139], v6 offset:12800
    buffer_load_dwordx4 v[168:171], v10, s[40:43], s65 offen offset:0 sc1
    v_add_u32 v15, s59, v15
    v_mfma_f32_32x32x16_bf16 v[104:119], v[216:219], v[124:127], v[104:119]
    ds_read_b64_tr_b16 v[140:141], v7 offset:12288
    ds_read_b64_tr_b16 v[142:143], v7 offset:12800
    buffer_load_dwordx4 v[172:175], v10, s[40:43], s65 offen offset:1024 sc1
    v_bfe_u32 v31, v1, 2, 2
    s_waitcnt lgkmcnt(4)
    v_mfma_f32_32x32x16_bf16 v[88:103], v[220:223], v[128:131], v[88:103]
    ds_read_b64_tr_b16 v[120:121], v8 offset:0
    ds_read_b64_tr_b16 v[122:123], v8 offset:512
    buffer_load_dwordx4 v[176:179], v10, s[40:43], s65 offen offset:2048 sc1
    v_lshrrev_b32 v16, 4, v1
    v_mfma_f32_32x32x16_bf16 v[104:119], v[220:223], v[132:135], v[104:119]
    ds_read_b64_tr_b16 v[124:125], v9 offset:0
    ds_read_b64_tr_b16 v[126:127], v9 offset:512
    v_lshl_add_u32 v16, v16, 3, v31
    s_waitcnt lgkmcnt(4)
    v_mfma_f32_32x32x16_bf16 v[88:103], v[224:227], v[136:139], v[88:103]
    ds_read_b64_tr_b16 v[128:129], v8 offset:2048
    ds_read_b64_tr_b16 v[130:131], v8 offset:2560
    s_add_u32 m0, s12, 12288
    s_nop 0
    buffer_load_dwordx4 v10, s[40:43], s35 offen offset:0 sc1 lds
    v_mul_u32_u24 v16, 72, v16
    v_mfma_f32_32x32x16_bf16 v[104:119], v[224:227], v[140:143], v[104:119]
    ds_read_b64_tr_b16 v[132:133], v9 offset:2048
    ds_read_b64_tr_b16 v[134:135], v9 offset:2560
    v_and_b32 v31, 3, v1
    s_waitcnt lgkmcnt(4)
    v_mfma_f32_32x32x16_bf16 v[88:103], v[228:231], v[120:123], v[88:103]
    ds_read_b64_tr_b16 v[136:137], v8 offset:4096
    ds_read_b64_tr_b16 v[138:139], v8 offset:4608
    s_add_u32 m0, s12, 12288
    s_nop 0
    buffer_load_dwordx4 v10, s[40:43], s35 offen offset:1024 sc1 lds
    s_waitcnt vmcnt(17)
    ds_read_b128 a[208:211], v24 offset:0
    v_lshl_add_u32 v16, v31, 3, v16
    v_mfma_f32_32x32x16_bf16 v[104:119], v[228:231], v[124:127], v[104:119]
    ds_read_b64_tr_b16 v[140:141], v9 offset:4096
    ds_read_b64_tr_b16 v[142:143], v9 offset:4608
    ds_read_b128 a[212:215], v25 offset:0
    v_add_u32 v16, s59, v16
    s_waitcnt lgkmcnt(6)
    v_mfma_f32_32x32x16_bf16 v[88:103], v[232:235], v[128:131], v[88:103]
    ds_read_b64_tr_b16 v[120:121], v8 offset:6144
    ds_read_b64_tr_b16 v[122:123], v8 offset:6656
    s_add_u32 m0, s12, 12288
    s_nop 0
    buffer_load_dwordx4 v10, s[40:43], s35 offen offset:2048 sc1 lds
    ds_read_b128 a[216:219], v26 offset:0
    v_and_b32 v31, 15, v1
    v_mfma_f32_32x32x16_bf16 v[104:119], v[232:235], v[132:135], v[104:119]
    ds_read_b64_tr_b16 v[124:125], v9 offset:6144
    ds_read_b64_tr_b16 v[126:127], v9 offset:6656
    ds_read_b128 a[220:223], v27 offset:0
    s_lshl_b32 s59, s54, 2
    s_waitcnt lgkmcnt(7)
    v_mfma_f32_32x32x16_bf16 v[88:103], v[236:239], v[136:139], v[88:103]
    ds_read_b64_tr_b16 v[128:129], v8 offset:8192
    ds_read_b64_tr_b16 v[130:131], v8 offset:8704
    s_add_u32 m0, s12, 12288
    s_nop 0
    buffer_load_dwordx4 v10, s[40:43], s35 offen offset:3072 sc1 lds
    s_waitcnt vmcnt(15)
    ds_read_b128 a[224:227], v24 offset:4096
    s_add_u32 s59, s59, s3
    v_mfma_f32_32x32x16_bf16 v[104:119], v[236:239], v[140:143], v[104:119]
    ds_read_b64_tr_b16 v[132:133], v9 offset:8192
    ds_read_b64_tr_b16 v[134:135], v9 offset:8704
    ds_read_b128 a[228:231], v25 offset:4096
    s_lshl_b32 s59, s59, 4
    s_waitcnt lgkmcnt(7)
    v_mfma_f32_32x32x16_bf16 v[88:103], v[240:243], v[120:123], v[88:103]
    ds_read_b64_tr_b16 v[136:137], v8 offset:10240
    ds_read_b64_tr_b16 v[138:139], v8 offset:10752
    s_add_u32 m0, s12, 16384
    s_nop 0
    buffer_load_dwordx4 v10, s[40:43], s36 offen offset:0 sc1 lds
    ds_read_b128 a[232:235], v26 offset:4096
    v_add_lshl_u32 v0, v31, s59, 1
    v_mfma_f32_32x32x16_bf16 v[104:119], v[240:243], v[124:127], v[104:119]
    ds_read_b64_tr_b16 v[140:141], v9 offset:10240
    ds_read_b64_tr_b16 v[142:143], v9 offset:10752
    ds_read_b128 a[236:239], v27 offset:4096
    s_lshl_b32 s59, s55, 2
    s_waitcnt lgkmcnt(7)
    v_mfma_f32_32x32x16_bf16 v[88:103], v[244:247], v[128:131], v[88:103]
    ds_read_b64_tr_b16 v[120:121], v8 offset:12288
    ds_read_b64_tr_b16 v[122:123], v8 offset:12800
    s_waitcnt vmcnt(12)
    ds_read_b128 a[240:243], v24 offset:8192
    s_add_u32 s59, s59, s3
    v_mfma_f32_32x32x16_bf16 v[104:119], v[244:247], v[132:135], v[104:119]
    ds_read_b64_tr_b16 v[124:125], v9 offset:12288
    ds_read_b64_tr_b16 v[126:127], v9 offset:12800
    ds_read_b128 a[244:247], v25 offset:8192
    s_lshl_b32 s59, s59, 10
    s_waitcnt lgkmcnt(7)
    v_mfma_f32_32x32x16_bf16 v[88:103], v[248:251], v[136:139], v[88:103]
    ds_read_b128 a[248:251], v26 offset:8192
    s_add_u32 s59, s59, 1179648
    v_mfma_f32_32x32x16_bf16 v[104:119], v[248:251], v[140:143], v[104:119]
    ds_read_b128 a[252:255], v27 offset:8192
    v_and_b32 v19, 7, v1
    s_waitcnt lgkmcnt(3)
    v_mfma_f32_32x32x16_bf16 v[88:103], v[252:255], v[120:123], v[88:103]
    v_lshl_add_u32 v19, v19, 7, s59
    v_mfma_f32_32x32x16_bf16 v[104:119], v[252:255], v[124:127], v[104:119]
    s_waitcnt vmcnt(5)
    s_mov_b32 s64, 0
L_P3:
    v_xor_b32 v31, s52, v153
    v_xad_u32 v31, v155, s52, v31
    v_xad_u32 v31, v157, s52, v31
    v_xad_u32 v31, v159, s52, v31
    v_xad_u32 v31, v161, s52, v31
    v_xad_u32 v31, v163, s52, v31
    v_xad_u32 v31, v165, s52, v31
    v_xad_u32 v31, v167, s52, v31
    v_xad_u32 v31, v169, s52, v31
    v_xad_u32 v31, v171, s52, v31
    v_xad_u32 v31, v173, s52, v31
    v_xad_u32 v31, v175, s52, v31
    v_xad_u32 v31, v177, s52, v31
    v_xad_u32 v31, v179, s52, v31
    v_cmp_ne_u32_e64 vcc, 0, v31
    s_nop 0
    s_cbranch_vccz L_P3_x
    s_add_u32 s64, s64, 1
    s_cmp_gt_u32 s64, 65536
    s_cbranch_scc1 L_P3_x
    buffer_load_dwordx4 v[152:155], v10, s[40:43], s62 offen offset:0 sc1
    buffer_load_dwordx4 v[156:159], v10, s[40:43], s62 offen offset:1024 sc1
    buffer_load_dwordx4 v[160:163], v10, s[40:43], s62 offen offset:2048 sc1
    buffer_load_dwordx4 v[164:167], v10, s[40:43], s8 offen offset:3072 sc1
    buffer_load_dwordx4 v[168:171], v10, s[40:43], s65 offen offset:0 sc1
    buffer_load_dwordx4 v[172:175], v10, s[40:43], s65 offen offset:1024 sc1
    buffer_load_dwordx4 v[176:179], v10, s[40:43], s65 offen offset:2048 sc1
    s_waitcnt vmcnt(0)
    s_branch L_P3
L_P3_x:
    v_add_f32 v156, v156, v160
    v_add_f32 v158, v158, v162
    v_add_f32 v172, v172, v176
    v_add_f32 v174, v174, v178
    v_add_f32 v152, v152, v156
    v_add_f32 v154, v154, v158
    v_add_f32 v168, v168, v172
    v_add_f32 v170, v170, v174
    v_add_f32 v152, v152, v168
    v_add_f32 v154, v154, v170
    v_add_f32 v22, v152, v164
    v_add_f32 v23, v154, v166
    v_mul_f32 v22, 0x3a924925, v22
    v_mul_f32 v23, 0x3a924925, v23
    v_fma_f32 v23, -v22, v22, v23
    v_max_f32 v23, 0, v23
    v_cvt_pk_bf16_f32 v23, v22, v23
    v_lshlrev_b32 v22, 16, v23
    v_and_b32 v23, 0xffff0000, v23
    v_add_f32 v23, 0x3727c5ac, v23
    v_cvt_pk_bf16_f32 v23, v23, v23
    v_and_b32 v23, 0xffff0000, v23
    v_sqrt_f32 v23, v23
    s_nop 0
    v_cvt_pk_bf16_f32 v23, v23, v23
    v_and_b32 v23, 0xffff0000, v23
    v_rcp_f32 v20, v23
    s_waitcnt lgkmcnt(0)
    v_mul_f32 v21, -v22, v20
    v_mov_b32 v22, v20
    v_mov_b32_e64 v23, v21
    s_nop 0
    v_permlane32_swap_b32 v20, v22
    v_permlane32_swap_b32 v21, v23
    global_load_ushort v26, v0, s[28:29]
    v_mul_u32_u24 v8, 448, v0
    v_pk_fma_f32 v[56:57], v[56:57], v[20:21], v[20:21] op_sel:[0,0,1] op_sel_hi:[1,0,1]
    v_pk_fma_f32 v[58:59], v[58:59], v[20:21], v[20:21] op_sel:[0,0,1] op_sel_hi:[1,0,1]
    v_cvt_pk_bf16_f32 v120, v56, v57
    v_cvt_pk_bf16_f32 v121, v58, v59
    ds_write_b64 v15, v[120:121] offset:0
    v_pk_fma_f32 v[60:61], v[60:61], v[20:21], v[20:21] op_sel:[0,0,1] op_sel_hi:[1,0,1]
    v_pk_fma_f32 v[62:63], v[62:63], v[20:21], v[20:21] op_sel:[0,0,1] op_sel_hi:[1,0,1]
    v_cvt_pk_bf16_f32 v122, v60, v61
    v_cvt_pk_bf16_f32 v123, v62, v63
    ds_write_b64 v15, v[122:123] offset:16
    ds_read_b64_tr_b16 v[152:153], v16 offset:0
    ds_read_b64_tr_b16 v[154:155], v16 offset:288
    v_pk_fma_f32 v[64:65], v[64:65], v[20:21], v[20:21] op_sel:[0,0,1] op_sel_hi:[1,0,1]
    v_pk_fma_f32 v[66:67], v[66:67], v[20:21], v[20:21] op_sel:[0,0,1] op_sel_hi:[1,0,1]
    v_cvt_pk_bf16_f32 v124, v64, v65
    v_cvt_pk_bf16_f32 v125, v66, v67
    ds_write_b64 v15, v[124:125] offset:32
    v_pk_fma_f32 v[68:69], v[68:69], v[20:21], v[20:21] op_sel:[0,0,1] op_sel_hi:[1,0,1]
    v_pk_fma_f32 v[70:71], v[70:71], v[20:21], v[20:21] op_sel:[0,0,1] op_sel_hi:[1,0,1]
    v_cvt_pk_bf16_f32 v126, v68, v69
    v_cvt_pk_bf16_f32 v127, v70, v71
    ds_write_b64 v15, v[126:127] offset:48
    s_waitcnt lgkmcnt(2)
    buffer_store_dwordx4 v[152:155], v10, s[40:43], s9 offen offset:0 sc1
    ds_read_b64_tr_b16 v[156:157], v16 offset:32
    ds_read_b64_tr_b16 v[158:159], v16 offset:320
    v_pk_fma_f32 v[72:73], v[72:73], v[22:23], v[22:23] op_sel:[0,0,1] op_sel_hi:[1,0,1]
    v_pk_fma_f32 v[74:75], v[74:75], v[22:23], v[22:23] op_sel:[0,0,1] op_sel_hi:[1,0,1]
    v_cvt_pk_bf16_f32 v128, v72, v73
    v_cvt_pk_bf16_f32 v129, v74, v75
    ds_write_b64 v15, v[128:129] offset:2304
    v_pk_fma_f32 v[76:77], v[76:77], v[22:23], v[22:23] op_sel:[0,0,1] op_sel_hi:[1,0,1]
    v_pk_fma_f32 v[78:79], v[78:79], v[22:23], v[22:23] op_sel:[0,0,1] op_sel_hi:[1,0,1]
    v_cvt_pk_bf16_f32 v130, v76, v77
    v_cvt_pk_bf16_f32 v131, v78, v79
    ds_write_b64 v15, v[130:131] offset:2320
    s_waitcnt lgkmcnt(2)
    buffer_store_dwordx4 v[156:159], v10, s[40:43], s9 offen offset:1024 sc1
    ds_read_b64_tr_b16 v[160:161], v16 offset:2304
    ds_read_b64_tr_b16 v[162:163], v16 offset:2592
    v_pk_fma_f32 v[80:81], v[80:81], v[22:23], v[22:23] op_sel:[0,0,1] op_sel_hi:[1,0,1]
    v_pk_fma_f32 v[82:83], v[82:83], v[22:23], v[22:23] op_sel:[0,0,1] op_sel_hi:[1,0,1]
    v_cvt_pk_bf16_f32 v132, v80, v81
    v_cvt_pk_bf16_f32 v133, v82, v83
    ds_write_b64 v15, v[132:133] offset:2336
    v_pk_fma_f32 v[84:85], v[84:85], v[22:23], v[22:23] op_sel:[0,0,1] op_sel_hi:[1,0,1]
    v_pk_fma_f32 v[86:87], v[86:87], v[22:23], v[22:23] op_sel:[0,0,1] op_sel_hi:[1,0,1]
    v_cvt_pk_bf16_f32 v134, v84, v85
    v_cvt_pk_bf16_f32 v135, v86, v87
    ds_write_b64 v15, v[134:135] offset:2352
    s_waitcnt lgkmcnt(2)
    buffer_store_dwordx4 v[160:163], v10, s[40:43], s9 offen offset:2048 sc1
    ds_read_b64_tr_b16 v[164:165], v16 offset:2336
    ds_read_b64_tr_b16 v[166:167], v16 offset:2624
    s_waitcnt lgkmcnt(0)
    buffer_store_dwordx4 v[164:167], v10, s[40:43], s9 offen offset:3072 sc1
    v_mov_b32_e64 v31, s52
    s_mov_b64 exec, 1
    buffer_store_dword v31, off, s[40:43], s69 sc1
    s_mov_b64 exec, -1
    v_pk_fma_f32 v[88:89], v[40:41], v[32:33], v[88:89] op_sel:[0,0,0] op_sel_hi:[1,0,1] neg_lo:[0,1,0] neg_hi:[0,1,0]
    v_pk_fma_f32 v[90:91], v[42:43], v[32:33], v[90:91] op_sel:[0,0,0] op_sel_hi:[1,0,1] neg_lo:[0,1,0] neg_hi:[0,1,0]
    v_pk_fma_f32 v[92:93], v[44:45], v[32:33], v[92:93] op_sel:[0,0,0] op_sel_hi:[1,0,1] neg_lo:[0,1,0] neg_hi:[0,1,0]
    v_pk_fma_f32 v[94:95], v[46:47], v[32:33], v[94:95] op_sel:[0,0,0] op_sel_hi:[1,0,1] neg_lo:[0,1,0] neg_hi:[0,1,0]
    v_pk_fma_f32 v[96:97], v[48:49], v[32:33], v[96:97] op_sel:[0,0,0] op_sel_hi:[1,0,1] neg_lo:[0,1,0] neg_hi:[0,1,0]
    v_pk_fma_f32 v[98:99], v[50:51], v[32:33], v[98:99] op_sel:[0,0,0] op_sel_hi:[1,0,1] neg_lo:[0,1,0] neg_hi:[0,1,0]
    v_pk_fma_f32 v[100:101], v[52:53], v[32:33], v[100:101] op_sel:[0,0,0] op_sel_hi:[1,0,1] neg_lo:[0,1,0] neg_hi:[0,1,0]
    v_pk_fma_f32 v[102:103], v[54:55], v[32:33], v[102:103] op_sel:[0,0,0] op_sel_hi:[1,0,1] neg_lo:[0,1,0] neg_hi:[0,1,0]
    v_pk_mul_f32 v[192:193], v[88:89], v[88:89]
    v_pk_mul_f32 v[194:195], v[90:91], v[90:91]
    v_pk_mul_f32 v[196:197], v[92:93], v[92:93]
    v_pk_mul_f32 v[198:199], v[94:95], v[94:95]
    s_add_u32 m0, s12, 16384
    s_nop 0
    buffer_load_dwordx4 v10, s[40:43], s36 offen offset:1024 sc1 lds
    v_pk_mul_f32 v[200:201], v[96:97], v[96:97]
    v_pk_mul_f32 v[202:203], v[98:99], v[98:99]
    v_pk_mul_f32 v[204:205], v[100:101], v[100:101]
    v_pk_mul_f32 v[206:207], v[102:103], v[102:103]
    s_nop 0
    v_pk_fma_f32 v[192:193], v[192:193], v[34:35], v[34:35] op_sel:[0,1,0] op_sel_hi:[1,1,0]
    v_pk_fma_f32 v[194:195], v[194:195], v[34:35], v[34:35] op_sel:[0,1,0] op_sel_hi:[1,1,0]
    v_pk_fma_f32 v[196:197], v[196:197], v[34:35], v[34:35] op_sel:[0,1,0] op_sel_hi:[1,1,0]
    v_pk_fma_f32 v[198:199], v[198:199], v[34:35], v[34:35] op_sel:[0,1,0] op_sel_hi:[1,1,0]
    v_pk_fma_f32 v[200:201], v[200:201], v[34:35], v[34:35] op_sel:[0,1,0] op_sel_hi:[1,1,0]
    v_pk_fma_f32 v[202:203], v[202:203], v[34:35], v[34:35] op_sel:[0,1,0] op_sel_hi:[1,1,0]
    v_pk_fma_f32 v[204:205], v[204:205], v[34:35], v[34:35] op_sel:[0,1,0] op_sel_hi:[1,1,0]
    v_pk_fma_f32 v[206:207], v[206:207], v[34:35], v[34:35] op_sel:[0,1,0] op_sel_hi:[1,1,0]
    buffer_load_dwordx4 v10, s[40:43], s36 offen offset:2048 sc1 lds
    v_pk_mul_f32 v[192:193], v[192:193], v[88:89]
    v_pk_mul_f32 v[194:195], v[194:195], v[90:91]
    v_pk_mul_f32 v[196:197], v[196:197], v[92:93]
    v_pk_mul_f32 v[198:199], v[198:199], v[94:95]
    v_pk_mul_f32 v[200:201], v[200:201], v[96:97]
    v_pk_mul_f32 v[202:203], v[202:203], v[98:99]
    v_pk_mul_f32 v[204:205], v[204:205], v[100:101]
    v_pk_mul_f32 v[206:207], v[206:207], v[102:103]
    v_exp_f32 v192, v192
    v_exp_f32 v193, v193
    buffer_load_dwordx4 v10, s[40:43], s36 offen offset:3072 sc1 lds
    v_exp_f32 v194, v194
    v_exp_f32 v195, v195
    v_exp_f32 v196, v196
    v_exp_f32 v197, v197
    v_exp_f32 v198, v198
    v_exp_f32 v199, v199
    s_add_u32 m0, s12, 20480
    s_nop 0
    buffer_load_dwordx4 v10, s[40:43], s37 offen offset:0 sc1 lds
    v_exp_f32 v200, v200
    v_exp_f32 v201, v201
    v_exp_f32 v202, v202
    v_exp_f32 v203, v203
    v_exp_f32 v204, v204
    v_exp_f32 v205, v205
    buffer_load_dwordx4 v10, s[40:43], s37 offen offset:1024 sc1 lds
    v_exp_f32 v206, v206
    v_exp_f32_e64 v207, v207
    v_pk_fma_f32 v[192:193], v[192:193], v[32:33], v[32:33] op_sel:[0,1,1] op_sel_hi:[1,1,1]
    v_pk_fma_f32 v[194:195], v[194:195], v[32:33], v[32:33] op_sel:[0,1,1] op_sel_hi:[1,1,1]
    v_pk_fma_f32 v[196:197], v[196:197], v[32:33], v[32:33] op_sel:[0,1,1] op_sel_hi:[1,1,1]
    v_pk_fma_f32 v[198:199], v[198:199], v[32:33], v[32:33] op_sel:[0,1,1] op_sel_hi:[1,1,1]
    v_pk_fma_f32 v[200:201], v[200:201], v[32:33], v[32:33] op_sel:[0,1,1] op_sel_hi:[1,1,1]
    v_pk_fma_f32 v[202:203], v[202:203], v[32:33], v[32:33] op_sel:[0,1,1] op_sel_hi:[1,1,1]
    v_pk_fma_f32 v[204:205], v[204:205], v[32:33], v[32:33] op_sel:[0,1,1] op_sel_hi:[1,1,1]
    v_pk_fma_f32 v[206:207], v[206:207], v[32:33], v[32:33] op_sel:[0,1,1] op_sel_hi:[1,1,1]
    buffer_load_dwordx4 v10, s[40:43], s37 offen offset:2048 sc1 lds
    v_rcp_f32 v192, v192
    v_rcp_f32 v193, v193
    v_rcp_f32 v194, v194
    v_rcp_f32 v195, v195
    v_rcp_f32 v196, v196
    v_rcp_f32 v197, v197
    buffer_load_dwordx4 v10, s[40:43], s37 offen offset:3072 sc1 lds
    v_rcp_f32 v198, v198
    v_rcp_f32 v199, v199
    v_rcp_f32 v200, v200
    v_rcp_f32 v201, v201
    v_rcp_f32 v202, v202
    v_rcp_f32 v203, v203
    s_barrier
    s_add_u32 m0, s12, 0
    s_nop 0
    buffer_load_dwordx4 v10, s[40:43], s26 offen offset:0 sc1 lds
    v_rcp_f32 v204, v204
    v_rcp_f32 v205, v205
    v_rcp_f32 v206, v206
    v_rcp_f32_e64 v207, v207
    v_pk_mul_f32 v[88:89], v[88:89], v[192:193]
    v_pk_mul_f32 v[90:91], v[90:91], v[194:195]
    v_pk_mul_f32 v[92:93], v[92:93], v[196:197]
    v_pk_mul_f32 v[94:95], v[94:95], v[198:199]
    buffer_load_dwordx4 v10, s[40:43], s26 offen offset:1024 sc1 lds
    v_pk_mul_f32 v[96:97], v[96:97], v[200:201]
    v_pk_mul_f32 v[98:99], v[98:99], v[202:203]
    v_pk_mul_f32 v[100:101], v[100:101], v[204:205]
    v_pk_mul_f32 v[102:103], v[102:103], v[206:207]
    v_pk_fma_f32 v[104:105], v[40:41], v[36:37], v[104:105] op_sel:[0,0,0] op_sel_hi:[1,0,1] neg_lo:[0,1,0] neg_hi:[0,1,0]
    v_pk_fma_f32 v[106:107], v[42:43], v[36:37], v[106:107] op_sel:[0,0,0] op_sel_hi:[1,0,1] neg_lo:[0,1,0] neg_hi:[0,1,0]
    v_pk_fma_f32 v[108:109], v[44:45], v[36:37], v[108:109] op_sel:[0,0,0] op_sel_hi:[1,0,1] neg_lo:[0,1,0] neg_hi:[0,1,0]
    v_pk_fma_f32 v[110:111], v[46:47], v[36:37], v[110:111] op_sel:[0,0,0] op_sel_hi:[1,0,1] neg_lo:[0,1,0] neg_hi:[0,1,0]
    v_pk_fma_f32 v[112:113], v[48:49], v[36:37], v[112:113] op_sel:[0,0,0] op_sel_hi:[1,0,1] neg_lo:[0,1,0] neg_hi:[0,1,0]
    v_pk_fma_f32 v[114:115], v[50:51], v[36:37], v[114:115] op_sel:[0,0,0] op_sel_hi:[1,0,1] neg_lo:[0,1,0] neg_hi:[0,1,0]
    v_pk_fma_f32 v[116:117], v[52:53], v[36:37], v[116:117] op_sel:[0,0,0] op_sel_hi:[1,0,1] neg_lo:[0,1,0] neg_hi:[0,1,0]
    v_pk_fma_f32 v[118:119], v[54:55], v[36:37], v[118:119] op_sel:[0,0,0] op_sel_hi:[1,0,1] neg_lo:[0,1,0] neg_hi:[0,1,0]
    v_pk_mul_f32 v[192:193], v[104:105], v[104:105]
    v_pk_mul_f32 v[194:195], v[106:107], v[106:107]
    v_pk_mul_f32 v[196:197], v[108:109], v[108:109]
    v_pk_mul_f32 v[198:199], v[110:111], v[110:111]
    buffer_load_dwordx4 v10, s[40:43], s26 offen offset:2048 sc1 lds
    v_pk_mul_f32 v[200:201], v[112:113], v[112:113]
    v_pk_mul_f32 v[202:203], v[114:115], v[114:115]
    v_pk_mul_f32 v[204:205], v[116:117], v[116:117]
    v_pk_mul_f32 v[206:207], v[118:119], v[118:119]
    v_pk_fma_f32 v[192:193], v[192:193], v[38:39], v[38:39] op_sel:[0,1,0] op_sel_hi:[1,1,0]
    v_pk_fma_f32 v[194:195], v[194:195], v[38:39], v[38:39] op_sel:[0,1,0] op_sel_hi:[1,1,0]
    v_pk_fma_f32 v[196:197], v[196:197], v[38:39], v[38:39] op_sel:[0,1,0] op_sel_hi:[1,1,0]
    v_pk_fma_f32 v[198:199], v[198:199], v[38:39], v[38:39] op_sel:[0,1,0] op_sel_hi:[1,1,0]
    v_pk_fma_f32 v[200:201], v[200:201], v[38:39], v[38:39] op_sel:[0,1,0] op_sel_hi:[1,1,0]
    v_pk_fma_f32 v[202:203], v[202:203], v[38:39], v[38:39] op_sel:[0,1,0] op_sel_hi:[1,1,0]
    v_pk_fma_f32 v[204:205], v[204:205], v[38:39], v[38:39] op_sel:[0,1,0] op_sel_hi:[1,1,0]
    v_pk_fma_f32 v[206:207], v[206:207], v[38:39], v[38:39] op_sel:[0,1,0] op_sel_hi:[1,1,0]
    buffer_load_dwordx4 v10, s[40:43], s26 offen offset:3072 sc1 lds
    v_pk_mul_f32 v[192:193], v[192:193], v[104:105]
    v_pk_mul_f32 v[194:195], v[194:195], v[106:107]
    v_pk_mul_f32 v[196:197], v[196:197], v[108:109]
    v_pk_mul_f32 v[198:199], v[198:199], v[110:111]
    v_pk_mul_f32 v[200:201], v[200:201], v[112:113]
    v_pk_mul_f32 v[202:203], v[202:203], v[114:115]
    v_pk_mul_f32 v[204:205], v[204:205], v[116:117]
    v_pk_mul_f32 v[206:207], v[206:207], v[118:119]
    v_exp_f32 v192, v192
    v_exp_f32 v193, v193
    s_add_u32 m0, s12, 4096
    s_nop 0
    buffer_load_dwordx4 v10, s[40:43], s27 offen offset:0 sc1 lds
    v_exp_f32 v194, v194
    v_exp_f32 v195, v195
    v_exp_f32 v196, v196
    v_exp_f32 v197, v197
    v_exp_f32 v198, v198
    v_exp_f32 v199, v199
    buffer_load_dwordx4 v10, s[40:43], s27 offen offset:1024 sc1 lds
    v_exp_f32 v200, v200
    v_exp_f32 v201, v201
    v_exp_f32 v202, v202
    v_exp_f32 v203, v203
    v_exp_f32 v204, v204
    v_exp_f32 v205, v205
    buffer_load_dwordx4 v10, s[40:43], s27 offen offset:2048 sc1 lds
    v_exp_f32 v206, v206
    v_exp_f32_e64 v207, v207
    v_pk_fma_f32 v[192:193], v[192:193], v[36:37], v[36:37] op_sel:[0,1,1] op_sel_hi:[1,1,1]
    v_pk_fma_f32 v[194:195], v[194:195], v[36:37], v[36:37] op_sel:[0,1,1] op_sel_hi:[1,1,1]
    v_pk_fma_f32 v[196:197], v[196:197], v[36:37], v[36:37] op_sel:[0,1,1] op_sel_hi:[1,1,1]
    v_pk_fma_f32 v[198:199], v[198:199], v[36:37], v[36:37] op_sel:[0,1,1] op_sel_hi:[1,1,1]
    v_pk_fma_f32 v[200:201], v[200:201], v[36:37], v[36:37] op_sel:[0,1,1] op_sel_hi:[1,1,1]
    v_pk_fma_f32 v[202:203], v[202:203], v[36:37], v[36:37] op_sel:[0,1,1] op_sel_hi:[1,1,1]
    v_pk_fma_f32 v[204:205], v[204:205], v[36:37], v[36:37] op_sel:[0,1,1] op_sel_hi:[1,1,1]
    v_pk_fma_f32 v[206:207], v[206:207], v[36:37], v[36:37] op_sel:[0,1,1] op_sel_hi:[1,1,1]
    buffer_load_dwordx4 v10, s[40:43], s27 offen offset:3072 sc1 lds
    v_rcp_f32 v192, v192
    v_rcp_f32 v193, v193
    v_rcp_f32 v194, v194
    v_rcp_f32 v195, v195
    v_rcp_f32 v196, v196
    v_rcp_f32 v197, v197
    s_waitcnt vmcnt(16)
    v_mov_b32 v31, s52
    s_mov_b64 exec, 1
    buffer_store_dword v31, off, s[40:43], s10 sc1
    s_mov_b64 exec, -1
    v_rcp_f32 v198, v198
    v_rcp_f32 v199, v199
    v_rcp_f32 v200, v200
    v_rcp_f32 v201, v201
    v_rcp_f32 v202, v202
    v_rcp_f32 v203, v203
    s_add_u32 m0, s12, 8192
    s_nop 0
    buffer_load_dwordx4 v10, s[40:43], s34 offen offset:0 sc1 lds
    v_rcp_f32 v204, v204
    v_rcp_f32 v205, v205
    v_rcp_f32 v206, v206
    v_rcp_f32_e64 v207, v207
    v_pk_mul_f32 v[104:105], v[104:105], v[192:193]
    v_pk_mul_f32 v[106:107], v[106:107], v[194:195]
    v_pk_mul_f32 v[108:109], v[108:109], v[196:197]
    v_pk_mul_f32 v[110:111], v[110:111], v[198:199]
    buffer_load_dwordx4 v10, s[40:43], s34 offen offset:1024 sc1 lds
    v_pk_mul_f32 v[112:113], v[112:113], v[200:201]
    v_pk_mul_f32 v[114:115], v[114:115], v[202:203]
    v_pk_mul_f32 v[116:117], v[116:117], v[204:205]
    v_pk_mul_f32 v[118:119], v[118:119], v[206:207]
    v_and_b32 v31, 31, v1
    v_mul_u32_u24 v15, 80, v31
    v_add_u32 v15, v15, v28
    s_sub_u32 s59, s3, 0
    s_and_b32 s59, s59, 3
    s_mul_i32 s59, s59, 5120
    s_add_u32 s59, s59, 24576
    v_add_u32_e64 v15, s59, v15
    v_cvt_pk_bf16_f32 v144, v88, v89
    v_cvt_pk_bf16_f32 v145, v90, v91
    v_cvt_pk_bf16_f32 v148, v92, v93
    v_cvt_pk_bf16_f32 v149, v94, v95
    v_cvt_pk_bf16_f32 v146, v96, v97
    v_cvt_pk_bf16_f32 v147, v98, v99
    v_cvt_pk_bf16_f32 v150, v100, v101
    v_cvt_pk_bf16_f32 v151, v102, v103
    ds_write_b128 v15, v[144:147] offset:0
    ds_write_b128 v15, v[148:151] offset:32
    buffer_load_dword v25, v19, s[40:43], 0 offen sc1
    buffer_load_dwordx4 v10, s[40:43], s34 offen offset:2048 sc1 lds
    v_cvt_pk_bf16_f32 v152, v104, v105
    v_cvt_pk_bf16_f32 v153, v106, v107
    v_cvt_pk_bf16_f32 v156, v108, v109
    v_cvt_pk_bf16_f32 v157, v110, v111
    v_cvt_pk_bf16_f32 v154, v112, v113
    v_cvt_pk_bf16_f32 v155, v114, v115
    v_cvt_pk_bf16_f32 v158, v116, v117
    v_cvt_pk_bf16_f32 v159, v118, v119
    ds_write_b128 v15, v[152:155] offset:2560
    ds_write_b128 v15, v[156:159] offset:2592
    buffer_load_dwordx4 v10, s[40:43], s34 offen offset:3072 sc1 lds
    v_and_b32 v31, 15, v1
    s_lshl_b32 s59, s55, 2
    s_add_u32 s59, s59, s3
    s_lshl_b32 s62, s59, 12
    s_add_u32 s62, s62, 163840
    v_and_b32 v22, 31, v1
    v_lshl_add_u32 v22, v22, 7, s62
    v_lshrrev_b32 v9, 4, v1
    v_lshl_add_u32 v8, v9, 4, v8
    s_lshl_b32 s62, s3, 4
    v_add_u32 v16, s62, v31
    v_mul_u32_u24 v16, 80, v16
    v_lshl_add_u32 v16, v9, 4, v16
    s_lshl_b32 s62, s55, 7
    v_add_u32 v8, s62, v8
    s_mov_b32 m0, s23
    s_nop 0
    buffer_load_dwordx4 v10, s[40:43], s5 offen offset:0 sc1 lds
    buffer_load_dwordx4 v10, s[40:43], s5 offen offset:1024 sc1 lds
    buffer_load_dwordx4 v10, s[40:43], s5 offen offset:2048 sc1 lds
    buffer_load_dwordx4 v10, s[40:43], s5 offen offset:3072 sc1 lds
    s_waitcnt vmcnt(6)
    v_cmp_ne_u32 vcc, s52, v25
    s_nop 0
    s_cbranch_vccz L_PZ_x
    s_mov_b32 s59, 0
L_PZ:
    buffer_load_dword v31, v19, s[40:43], 0 offen sc1
    s_add_u32 s59, s59, 1
    s_waitcnt vmcnt(0)
    v_cmpx_ne_u32 vcc, s52, v31
    s_cmp_gt_u32 s59, 65536
    s_cbranch_scc1 L_PZ_y
    s_cbranch_vccnz L_PZ
L_PZ_y:
    s_mov_b64 exec, -1
L_PZ_x:
    s_mov_b32 s70, s53
    buffer_load_dwordx4 v[192:195], v10, s[40:43], s70 offen offset:0 sc1
    buffer_load_dwordx4 v[196:199], v10, s[40:43], s70 offen offset:1024 sc1
    buffer_load_dwordx4 v[200:203], v10, s[40:43], s70 offen offset:2048 sc1
    s_lshr_b32 s59, s54, 3
    s_mul_i32 s59, s59, 56
    s_and_b32 s62, s54, 7
    s_add_u32 s59, s59, s62
    s_lshl_b32 s59, s59, 14
    s_lshl_b32 s62, s3, 10
    buffer_load_dwordx4 v[204:207], v10, s[40:43], s70 offen offset:3072 sc1
    s_add_u32 s65, s62, 14692352
    s_and_b32 s62, s54, 3
    s_lshl_b32 s62, s62, 12
    s_xor_b32 s65, s65, s62
    s_add_u32 s64, s59, s65
    s_lshr_b32 s59, s54, 2
    s_add_u32 s70, s70, 20480
    buffer_load_dwordx4 v[208:211], v10, s[40:43], s70 offen offset:0 sc1
    s_mul_i32 s59, s59, 28
    s_and_b32 s62, s54, 3
    s_add_u32 s59, s59, s62
    s_add_u32 s59, s59, 24
    s_lshl_b32 s59, s59, 14
    s_add_u32 s65, s65, s59
    buffer_load_dwordx4 v[212:215], v10, s[40:43], s70 offen offset:1024 sc1
    s_lshl_b32 s59, s16, 5
    s_cmp_ge_u32 s16, 16384
    s_cselect_b32 s62, 65536, 0
    s_sub_u32 s59, s59, s62
    s_add_u32 s59, s59, s64
    s_cmp_eq_u32 s16, 12288
    s_cselect_b32 s26, s65, s59
    s_lshl_b32 s59, s17, 5
    buffer_load_dwordx4 v[216:219], v10, s[40:43], s70 offen offset:2048 sc1
    s_cmp_ge_u32 s17, 16384
    s_cselect_b32 s62, 65536, 0
    s_sub_u32 s59, s59, s62
    s_add_u32 s59, s59, s64
    s_cmp_eq_u32 s17, 12288
    s_cselect_b32 s27, s65, s59
    s_lshl_b32 s59, s18, 5
    s_cmp_ge_u32 s18, 16384
    s_cselect_b32 s62, 65536, 0
    buffer_load_dwordx4 v[220:223], v10, s[40:43], s70 offen offset:3072 sc1
    s_sub_u32 s59, s59, s62
    s_add_u32 s59, s59, s64
    s_cmp_eq_u32 s18, 12288
    s_cselect_b32 s34, s65, s59
    s_lshl_b32 s59, s19, 5
    s_cmp_ge_u32 s19, 16384
    s_cselect_b32 s62, 65536, 0
    s_sub_u32 s59, s59, s62
    s_mov_b32 s70, s56
    buffer_load_dwordx4 v[224:227], v10, s[40:43], s70 offen offset:0 sc1
    s_add_u32 s59, s59, s64
    s_cmp_eq_u32 s19, 12288
    s_cselect_b32 s35, s65, s59
    s_lshl_b32 s59, s20, 5
    s_cmp_ge_u32 s20, 16384
    s_cselect_b32 s62, 65536, 0
    s_sub_u32 s59, s59, s62
    s_add_u32 s59, s59, s64
    buffer_load_dwordx4 v[228:231], v10, s[40:43], s70 offen offset:1024 sc1
    s_cmp_eq_u32 s20, 12288
    s_cselect_b32 s36, s65, s59
    s_lshl_b32 s59, s21, 5
    s_cmp_ge_u32 s21, 16384
    s_cselect_b32 s62, 65536, 0
    s_sub_u32 s59, s59, s62
    s_add_u32 s59, s59, s64
    s_cmp_eq_u32 s21, 12288
    s_cselect_b32 s37, s65, s59
    buffer_load_dwordx4 v[232:235], v10, s[40:43], s70 offen offset:2048 sc1
    s_lshl_b32 s59, s22, 5
    s_cmp_ge_u32 s22, 16384
    s_cselect_b32 s62, 65536, 0
    s_sub_u32 s59, s59, s62
    s_add_u32 s59, s59, s64
    s_cmp_eq_u32 s22, 12288
    s_cselect_b32 s5, s65, s59
    s_add_u32 s17, s17, s13
    buffer_load_dwordx4 v[236:239], v10, s[40:43], s70 offen offset:3072 sc1
    s_add_u32 s18, s18, s13
    s_add_u32 s19, s19, s13
    s_add_u32 s20, s20, s13
    s_add_u32 s21, s21, s13
    s_add_u32 s22, s22, s13
    v_lshlrev_b32 v48, 16, v26
    v_mov_b32 v49, v48
    v_mov_b32 v50, v48
    v_mov_b32 v51, v48
    s_waitcnt vmcnt(11)
    s_nop 0
    v_mfma_f32_16x16x32_bf16 v[88:91], v[192:195], a[0:3], v[48:51]
    v_mfma_f32_16x16x32_bf16 v[96:99], v[192:195], a[64:67], 0
    s_add_u32 s70, s70, 20480
    buffer_load_dwordx4 v[240:243], v10, s[40:43], s70 offen offset:0 sc1
    v_mfma_f32_16x16x32_bf16 v[104:107], v[192:195], a[128:131], 0
    v_mfma_f32_16x16x32_bf16 v[112:115], v[192:195], a[192:195], 0
    s_waitcnt vmcnt(11)
    v_mfma_f32_16x16x32_bf16 v[92:95], v[196:199], a[0:3], v[48:51]
    v_mfma_f32_16x16x32_bf16 v[100:103], v[196:199], a[64:67], 0
    buffer_load_dwordx4 v[244:247], v10, s[40:43], s70 offen offset:1024 sc1
    v_mfma_f32_16x16x32_bf16 v[108:111], v[196:199], a[128:131], 0
    v_mfma_f32_16x16x32_bf16 v[116:119], v[196:199], a[192:195], 0
    v_max_u32 v23, v193, v197
    s_waitcnt vmcnt(11)
    v_mfma_f32_16x16x32_bf16 v[88:91], v[200:203], a[4:7], v[88:91]
    s_waitcnt lgkmcnt(0)
    v_mfma_f32_16x16x32_bf16 v[96:99], v[200:203], a[68:71], v[96:99]
    buffer_load_dwordx4 v[248:251], v10, s[40:43], s70 offen offset:2048 sc1
    v_mfma_f32_16x16x32_bf16 v[104:107], v[200:203], a[132:135], v[104:107]
    s_barrier
    v_mfma_f32_16x16x32_bf16 v[112:115], v[200:203], a[196:199], v[112:115]
    ds_read_b128 v[144:147], v16 offset:24576
    s_waitcnt vmcnt(11)
    v_mfma_f32_16x16x32_bf16 v[92:95], v[204:207], a[4:7], v[92:95]
    ds_read_b128 v[148:151], v16 offset:29696
    v_mfma_f32_16x16x32_bf16 v[100:103], v[204:207], a[68:71], v[100:103]
    buffer_load_dwordx4 v[252:255], v10, s[40:43], s70 offen offset:3072 sc1
    v_mfma_f32_16x16x32_bf16 v[108:111], v[204:207], a[132:135], v[108:111]
    ds_read_b128 v[152:155], v16 offset:34816
    v_mfma_f32_16x16x32_bf16 v[116:119], v[204:207], a[196:199], v[116:119]
    ds_read_b128 v[156:159], v16 offset:39936
    v_max3_u32 v23, v201, v205, v23
    s_waitcnt vmcnt(11)
    v_mfma_f32_16x16x32_bf16 v[88:91], v[208:211], a[8:11], v[88:91]
    s_add_u32 s59, s3, 1
    v_mfma_f32_16x16x32_bf16 v[96:99], v[208:211], a[72:75], v[96:99]
    s_mov_b32 s70, s57
    buffer_load_dwordx4 v[192:195], v10, s[40:43], s70 offen offset:0 sc1
    v_mfma_f32_16x16x32_bf16 v[104:107], v[208:211], a[136:139], v[104:107]
    s_and_b32 s59, s59, 3
    v_mfma_f32_16x16x32_bf16 v[112:115], v[208:211], a[200:203], v[112:115]
    s_mul_i32 s59, s59, 6144
    s_waitcnt vmcnt(11)
    v_mfma_f32_16x16x32_bf16 v[92:95], v[212:215], a[8:11], v[92:95]
    s_add_u32 s59, s59, 0
    v_mfma_f32_16x16x32_bf16 v[100:103], v[212:215], a[72:75], v[100:103]
    buffer_load_dwordx4 v[196:199], v10, s[40:43], s70 offen offset:1024 sc1
    v_mfma_f32_16x16x32_bf16 v[108:111], v[212:215], a[136:139], v[108:111]
    v_add_u32 v2, s59, v10
    v_mfma_f32_16x16x32_bf16 v[116:119], v[212:215], a[200:203], v[116:119]
    s_add_u32 s59, s3, 2
    v_max3_u32 v23, v209, v213, v23
    s_waitcnt vmcnt(11)
    v_mfma_f32_16x16x32_bf16 v[88:91], v[216:219], a[12:15], v[88:91]
    s_and_b32 s59, s59, 3
    v_mfma_f32_16x16x32_bf16 v[96:99], v[216:219], a[76:79], v[96:99]
    buffer_load_dwordx4 v[200:203], v10, s[40:43], s70 offen offset:2048 sc1
    v_mfma_f32_16x16x32_bf16 v[104:107], v[216:219], a[140:143], v[104:107]
    s_mul_i32 s59, s59, 6144
    v_mfma_f32_16x16x32_bf16 v[112:115], v[216:219], a[204:207], v[112:115]
    s_add_u32 s59, s59, 2048
    s_waitcnt vmcnt(11)
    v_mfma_f32_16x16x32_bf16 v[92:95], v[220:223], a[12:15], v[92:95]
    v_add_u32 v3, s59, v10
    v_mfma_f32_16x16x32_bf16 v[100:103], v[220:223], a[76:79], v[100:103]
    buffer_load_dwordx4 v[204:207], v10, s[40:43], s70 offen offset:3072 sc1
    v_mfma_f32_16x16x32_bf16 v[108:111], v[220:223], a[140:143], v[108:111]
    s_add_u32 s59, s3, 3
    v_mfma_f32_16x16x32_bf16 v[116:119], v[220:223], a[204:207], v[116:119]
    s_and_b32 s59, s59, 3
    v_max3_u32 v23, v217, v221, v23
    s_waitcnt vmcnt(11)
    v_mfma_f32_16x16x32_bf16 v[88:91], v[224:227], a[16:19], v[88:91]
    s_mul_i32 s59, s59, 6144
    v_mfma_f32_16x16x32_bf16 v[96:99], v[224:227], a[80:83], v[96:99]
    s_add_u32 s70, s70, 20480
    buffer_load_dwordx4 v[208:211], v10, s[40:43], s70 offen offset:0 sc1
    v_mfma_f32_16x16x32_bf16 v[104:107], v[224:227], a[144:147], v[104:107]
    s_add_u32 s59, s59, 4096
    buffer_load_dword v24, v22, s[40:43], 0 offen sc1
    v_mfma_f32_16x16x32_bf16 v[112:115], v[224:227], a[208:211], v[112:115]
    v_add_u32 v4, s59, v10
    s_waitcnt vmcnt(12)
    v_mfma_f32_16x16x32_bf16 v[92:95], v[228:231], a[16:19], v[92:95]
    s_mul_i32 s59, s3, 6144
    v_mfma_f32_16x16x32_bf16 v[100:103], v[228:231], a[80:83], v[100:103]
    buffer_load_dwordx4 v[212:215], v10, s[40:43], s70 offen offset:1024 sc1
    v_mfma_f32_16x16x32_bf16 v[108:111], v[228:231], a[144:147], v[108:111]
    v_add_u32 v5, s59, v10
    v_mfma_f32_16x16x32_bf16 v[116:119], v[228:231], a[208:211], v[116:119]
    v_add_u32 v6, 49152, v10
    v_max3_u32 v23, v225, v229, v23
    s_waitcnt vmcnt(12)
    v_mfma_f32_16x16x32_bf16 v[88:91], v[232:235], a[20:23], v[88:91]
    v_add_u32 v7, 114688, v10
    v_mfma_f32_16x16x32_bf16 v[96:99], v[232:235], a[84:87], v[96:99]
    buffer_load_dwordx4 v[216:219], v10, s[40:43], s70 offen offset:2048 sc1
    v_mfma_f32_16x16x32_bf16 v[104:107], v[232:235], a[148:151], v[104:107]
    v_lshlrev_b32 v32, 16, v180
    v_mfma_f32_16x16x32_bf16 v[112:115], v[232:235], a[212:215], v[112:115]
    v_and_b32 v33, 0xffff0000, v180
    s_waitcnt vmcnt(12)
    v_mfma_f32_16x16x32_bf16 v[92:95], v[236:239], a[20:23], v[92:95]
    v_lshlrev_b32 v34, 16, v181
    v_mfma_f32_16x16x32_bf16 v[100:103], v[236:239], a[84:87], v[100:103]
    buffer_load_dwordx4 v[220:223], v10, s[40:43], s70 offen offset:3072 sc1
    v_mfma_f32_16x16x32_bf16 v[108:111], v[236:239], a[148:151], v[108:111]
    v_and_b32 v35, 0xffff0000, v181
    v_mfma_f32_16x16x32_bf16 v[116:119], v[236:239], a[212:215], v[116:119]
    v_lshlrev_b32 v36, 16, v182
    v_max3_u32 v23, v233, v237, v23
    s_waitcnt vmcnt(12)
    v_mfma_f32_16x16x32_bf16 v[88:91], v[240:243], a[24:27], v[88:91]
    v_and_b32 v37, 0xffff0000, v182
    v_mfma_f32_16x16x32_bf16 v[96:99], v[240:243], a[88:91], v[96:99]
    s_mov_b32 s70, s60
    buffer_load_dwordx4 v[224:227], v10, s[40:43], s70 offen offset:0 sc1
    v_mfma_f32_16x16x32_bf16 v[104:107], v[240:243], a[152:155], v[104:107]
    v_lshlrev_b32 v38, 16, v183
    v_mfma_f32_16x16x32_bf16 v[112:115], v[240:243], a[216:219], v[112:115]
    v_and_b32 v39, 0xffff0000, v183
    s_waitcnt vmcnt(12)
    v_mfma_f32_16x16x32_bf16 v[92:95], v[244:247], a[24:27], v[92:95]
    v_lshlrev_b32 v40, 16, v184
    v_mfma_f32_16x16x32_bf16 v[100:103], v[244:247], a[88:91], v[100:103]
    buffer_load_dwordx4 v[228:231], v10, s[40:43], s70 offen offset:1024 sc1
    v_mfma_f32_16x16x32_bf16 v[108:111], v[244:247], a[152:155], v[108:111]
    v_and_b32 v41, 0xffff0000, v184
    v_mfma_f32_16x16x32_bf16 v[116:119], v[244:247], a[216:219], v[116:119]
    v_lshlrev_b32 v42, 16, v185
    v_max3_u32 v23, v241, v245, v23
    s_waitcnt vmcnt(12)
    v_mfma_f32_16x16x32_bf16 v[88:91], v[248:251], a[28:31], v[88:91]
    v_and_b32 v43, 0xffff0000, v185
    v_mfma_f32_16x16x32_bf16 v[96:99], v[248:251], a[92:95], v[96:99]
    buffer_load_dwordx4 v[232:235], v10, s[40:43], s70 offen offset:2048 sc1
    v_mfma_f32_16x16x32_bf16 v[104:107], v[248:251], a[156:159], v[104:107]
    v_lshlrev_b32 v44, 16, v186
    v_mfma_f32_16x16x32_bf16 v[112:115], v[248:251], a[220:223], v[112:115]
    v_and_b32 v45, 0xffff0000, v186
    s_waitcnt vmcnt(12)
    v_mfma_f32_16x16x32_bf16 v[92:95], v[252:255], a[28:31], v[92:95]
    v_lshlrev_b32 v46, 16, v187
    v_mfma_f32_16x16x32_bf16 v[100:103], v[252:255], a[92:95], v[100:103]
    buffer_load_dwordx4 v[236:239], v10, s[40:43], s70 offen offset:3072 sc1
    v_mfma_f32_16x16x32_bf16 v[108:111], v[252:255], a[156:159], v[108:111]
    v_and_b32 v47, 0xffff0000, v187
    v_mfma_f32_16x16x32_bf16 v[116:119], v[252:255], a[220:223], v[116:119]
    s_waitcnt lgkmcnt(0)
    v_max3_u32 v23, v249, v253, v23
    s_waitcnt vmcnt(12)
    v_mfma_f32_16x16x32_bf16 v[88:91], v[192:195], a[32:35], v[88:91]
    v_lshlrev_b32 v56, 16, v144
    v_mfma_f32_16x16x32_bf16 v[96:99], v[192:195], a[96:99], v[96:99]
    s_add_u32 s70, s70, 20480
    buffer_load_dwordx4 v[240:243], v10, s[40:43], s70 offen offset:0 sc1
    v_mfma_f32_16x16x32_bf16 v[104:107], v[192:195], a[160:163], v[104:107]
    v_and_b32 v57, 0xffff0000, v144
    v_mfma_f32_16x16x32_bf16 v[112:115], v[192:195], a[224:227], v[112:115]
    v_lshlrev_b32 v58, 16, v145
    s_waitcnt vmcnt(12)
    v_mfma_f32_16x16x32_bf16 v[92:95], v[196:199], a[32:35], v[92:95]
    v_and_b32 v59, 0xffff0000, v145
    v_mfma_f32_16x16x32_bf16 v[100:103], v[196:199], a[96:99], v[100:103]
    buffer_load_dwordx4 v[244:247], v10, s[40:43], s70 offen offset:1024 sc1
    v_mfma_f32_16x16x32_bf16 v[108:111], v[196:199], a[160:163], v[108:111]
    v_lshlrev_b32 v60, 16, v146
    v_mfma_f32_16x16x32_bf16 v[116:119], v[196:199], a[224:227], v[116:119]
    v_and_b32 v61, 0xffff0000, v146
    v_max3_u32 v23, v193, v197, v23
    s_waitcnt vmcnt(12)
    v_mfma_f32_16x16x32_bf16 v[88:91], v[200:203], a[36:39], v[88:91]
    v_lshlrev_b32 v62, 16, v147
    v_mfma_f32_16x16x32_bf16 v[96:99], v[200:203], a[100:103], v[96:99]
    buffer_load_dwordx4 v[248:251], v10, s[40:43], s70 offen offset:2048 sc1
    v_mfma_f32_16x16x32_bf16 v[104:107], v[200:203], a[164:167], v[104:107]
    v_and_b32 v63, 0xffff0000, v147
    v_mfma_f32_16x16x32_bf16 v[112:115], v[200:203], a[228:231], v[112:115]
    v_lshlrev_b32 v64, 16, v148
    s_waitcnt vmcnt(12)
    v_mfma_f32_16x16x32_bf16 v[92:95], v[204:207], a[36:39], v[92:95]
    v_and_b32 v65, 0xffff0000, v148
    v_mfma_f32_16x16x32_bf16 v[100:103], v[204:207], a[100:103], v[100:103]
    buffer_load_dwordx4 v[252:255], v10, s[40:43], s70 offen offset:3072 sc1
    v_mfma_f32_16x16x32_bf16 v[108:111], v[204:207], a[164:167], v[108:111]
    v_lshlrev_b32 v66, 16, v149
    v_mfma_f32_16x16x32_bf16 v[116:119], v[204:207], a[228:231], v[116:119]
    v_and_b32 v67, 0xffff0000, v149
    v_max3_u32 v23, v201, v205, v23
    s_waitcnt vmcnt(12)
    v_mfma_f32_16x16x32_bf16 v[88:91], v[208:211], a[40:43], v[88:91]
    v_lshlrev_b32 v68, 16, v150
    s_waitcnt vmcnt(11)
    v_cmp_ne_u32 vcc, s52, v24
    s_nop 0
    s_cbranch_vccz L_PZA_x
    s_mov_b32 s59, 0
L_PZA:
    buffer_load_dword v31, v22, s[40:43], 0 offen sc1
    s_add_u32 s59, s59, 1
    s_waitcnt vmcnt(0)
    v_cmpx_ne_u32 vcc, s52, v31
    s_cmp_gt_u32 s59, 65536
    s_cbranch_scc1 L_PZA_y
    s_cbranch_vccnz L_PZA
L_PZA_y:
    s_mov_b64 exec, -1
L_PZA_x:
    v_mfma_f32_16x16x32_bf16 v[96:99], v[208:211], a[104:107], v[96:99]
    s_xor_b32 s70, s61, 32768
    buffer_load_dwordx4 v[192:195], v10, s[40:43], s70 offen offset:0 sc1
    v_mfma_f32_16x16x32_bf16 v[104:107], v[208:211], a[168:171], v[104:107]
    v_and_b32 v69, 0xffff0000, v150
    v_mfma_f32_16x16x32_bf16 v[112:115], v[208:211], a[232:235], v[112:115]
    v_lshlrev_b32 v70, 16, v151
    s_waitcnt vmcnt(11)
    v_mfma_f32_16x16x32_bf16 v[92:95], v[212:215], a[40:43], v[92:95]
    v_and_b32 v71, 0xffff0000, v151
    v_mfma_f32_16x16x32_bf16 v[100:103], v[212:215], a[104:107], v[100:103]
    buffer_load_dwordx4 v[196:199], v10, s[40:43], s70 offen offset:1024 sc1
    v_mfma_f32_16x16x32_bf16 v[108:111], v[212:215], a[168:171], v[108:111]
    v_lshlrev_b32 v72, 16, v152
    v_mfma_f32_16x16x32_bf16 v[116:119], v[212:215], a[232:235], v[116:119]
    v_and_b32 v73, 0xffff0000, v152
    v_max3_u32 v23, v209, v213, v23
    s_waitcnt vmcnt(11)
    v_mfma_f32_16x16x32_bf16 v[88:91], v[216:219], a[44:47], v[88:91]
    v_lshlrev_b32 v74, 16, v153
    v_mfma_f32_16x16x32_bf16 v[96:99], v[216:219], a[108:111], v[96:99]
    buffer_load_dwordx4 v[200:203], v10, s[40:43], s70 offen offset:2048 sc1
    v_mfma_f32_16x16x32_bf16 v[104:107], v[216:219], a[172:175], v[104:107]
    v_and_b32 v75, 0xffff0000, v153
    v_mfma_f32_16x16x32_bf16 v[112:115], v[216:219], a[236:239], v[112:115]
    v_lshlrev_b32 v76, 16, v154
    s_waitcnt vmcnt(11)
    v_mfma_f32_16x16x32_bf16 v[92:95], v[220:223], a[44:47], v[92:95]
    v_and_b32 v77, 0xffff0000, v154
    v_mfma_f32_16x16x32_bf16 v[100:103], v[220:223], a[108:111], v[100:103]
    buffer_load_dwordx4 v[204:207], v10, s[40:43], s70 offen offset:3072 sc1
    v_mfma_f32_16x16x32_bf16 v[108:111], v[220:223], a[172:175], v[108:111]
    v_lshlrev_b32 v78, 16, v155
    v_mfma_f32_16x16x32_bf16 v[116:119], v[220:223], a[236:239], v[116:119]
    v_and_b32 v79, 0xffff0000, v155
    v_max3_u32 v23, v217, v221, v23
    s_waitcnt vmcnt(11)
    v_mfma_f32_16x16x32_bf16 v[88:91], v[224:227], a[48:51], v[88:91]
    v_lshlrev_b32 v80, 16, v156
    v_mfma_f32_16x16x32_bf16 v[96:99], v[224:227], a[112:115], v[96:99]
    s_xor_b32 s70, s70, 4096
    buffer_load_dwordx4 v[208:211], v10, s[40:43], s70 offen offset:0 sc1
    v_mfma_f32_16x16x32_bf16 v[104:107], v[224:227], a[176:179], v[104:107]
    v_and_b32 v81, 0xffff0000, v156
    v_mfma_f32_16x16x32_bf16 v[112:115], v[224:227], a[240:243], v[112:115]
    v_lshlrev_b32 v82, 16, v157
    s_waitcnt vmcnt(11)
    v_mfma_f32_16x16x32_bf16 v[92:95], v[228:231], a[48:51], v[92:95]
    v_and_b32 v83, 0xffff0000, v157
    v_mfma_f32_16x16x32_bf16 v[100:103], v[228:231], a[112:115], v[100:103]
    buffer_load_dwordx4 v[212:215], v10, s[40:43], s70 offen offset:1024 sc1
    v_mfma_f32_16x16x32_bf16 v[108:111], v[228:231], a[176:179], v[108:111]
    v_lshlrev_b32 v84, 16, v158
    v_mfma_f32_16x16x32_bf16 v[116:119], v[228:231], a[240:243], v[116:119]
    v_and_b32 v85, 0xffff0000, v158
    v_max3_u32 v23, v225, v229, v23
    s_waitcnt vmcnt(11)
    v_mfma_f32_16x16x32_bf16 v[88:91], v[232:235], a[52:55], v[88:91]
    v_lshlrev_b32 v86, 16, v159
    v_mfma_f32_16x16x32_bf16 v[96:99], v[232:235], a[116:119], v[96:99]
    buffer_load_dwordx4 v[216:219], v10, s[40:43], s70 offen offset:2048 sc1
    v_mfma_f32_16x16x32_bf16 v[104:107], v[232:235], a[180:183], v[104:107]
    v_and_b32 v87, 0xffff0000, v159
    v_mfma_f32_16x16x32_bf16 v[112:115], v[232:235], a[244:247], v[112:115]
    s_waitcnt vmcnt(11)
    v_mfma_f32_16x16x32_bf16 v[92:95], v[236:239], a[52:55], v[92:95]
    v_mfma_f32_16x16x32_bf16 v[100:103], v[236:239], a[116:119], v[100:103]
    buffer_load_dwordx4 v[220:223], v10, s[40:43], s70 offen offset:3072 sc1
    v_mfma_f32_16x16x32_bf16 v[108:111], v[236:239], a[180:183], v[108:111]
    v_mfma_f32_16x16x32_bf16 v[116:119], v[236:239], a[244:247], v[116:119]
    v_max3_u32 v23, v233, v237, v23
    s_waitcnt vmcnt(11)
    v_mfma_f32_16x16x32_bf16 v[88:91], v[240:243], a[56:59], v[88:91]
    v_mfma_f32_16x16x32_bf16 v[96:99], v[240:243], a[120:123], v[96:99]
    s_xor_b32 s70, s100, 32768
    buffer_load_dwordx4 v[224:227], v10, s[40:43], s70 offen offset:0 sc1
    v_mfma_f32_16x16x32_bf16 v[104:107], v[240:243], a[184:187], v[104:107]
    v_mfma_f32_16x16x32_bf16 v[112:115], v[240:243], a[248:251], v[112:115]
    s_waitcnt vmcnt(11)
    v_mfma_f32_16x16x32_bf16 v[92:95], v[244:247], a[56:59], v[92:95]
    v_mfma_f32_16x16x32_bf16 v[100:103], v[244:247], a[120:123], v[100:103]
    buffer_load_dwordx4 v[228:231], v10, s[40:43], s70 offen offset:1024 sc1
    v_mfma_f32_16x16x32_bf16 v[108:111], v[244:247], a[184:187], v[108:111]
    v_mfma_f32_16x16x32_bf16 v[116:119], v[244:247], a[248:251], v[116:119]
    v_max3_u32 v23, v241, v245, v23
    s_waitcnt vmcnt(11)
    v_mfma_f32_16x16x32_bf16 v[88:91], v[248:251], a[60:63], v[88:91]
    v_mfma_f32_16x16x32_bf16 v[96:99], v[248:251], a[124:127], v[96:99]
    buffer_load_dwordx4 v[232:235], v10, s[40:43], s70 offen offset:2048 sc1
    v_mfma_f32_16x16x32_bf16 v[104:107], v[248:251], a[188:191], v[104:107]
    v_mfma_f32_16x16x32_bf16 v[112:115], v[248:251], a[252:255], v[112:115]
    s_waitcnt vmcnt(11)
    v_mfma_f32_16x16x32_bf16 v[92:95], v[252:255], a[60:63], v[92:95]
    v_mfma_f32_16x16x32_bf16 v[100:103], v[252:255], a[124:127], v[100:103]
    buffer_load_dwordx4 v[236:239], v10, s[40:43], s70 offen offset:3072 sc1
    v_mfma_f32_16x16x32_bf16 v[108:111], v[252:255], a[188:191], v[108:111]
    v_mfma_f32_16x16x32_bf16 v[116:119], v[252:255], a[252:255], v[116:119]
    v_max3_u32 v23, v249, v253, v23
    v_cmp_le_u32 vcc, 0xffc00000, v23
    s_nop 0
    s_cbranch_vccnz L_ZBAD
L_ZOK:
    s_waitcnt vmcnt(11)
    v_mfma_f32_16x16x32_bf16 v[160:163], v[192:195], a[0:3], v[48:51]
    v_mfma_f32_16x16x32_bf16 v[168:171], v[192:195], a[64:67], 0
    s_xor_b32 s70, s70, 4096
    buffer_load_dwordx4 v[240:243], v10, s[40:43], s70 offen offset:0 sc1
    v_mfma_f32_16x16x32_bf16 v[176:179], v[192:195], a[128:131], 0
    v_mfma_f32_16x16x32_bf16 v[184:187], v[192:195], a[192:195], 0
    ds_write_b128 v2, v[96:99] offset:0
    s_waitcnt vmcnt(11)
    v_mfma_f32_16x16x32_bf16 v[164:167], v[196:199], a[0:3], v[48:51]
    v_mfma_f32_16x16x32_bf16 v[172:175], v[196:199], a[64:67], 0
    buffer_load_dwordx4 v[244:247], v10, s[40:43], s70 offen offset:1024 sc1
    v_mfma_f32_16x16x32_bf16 v[180:183], v[196:199], a[128:131], 0
    v_mfma_f32_16x16x32_bf16 v[188:191], v[196:199], a[192:195], 0
    ds_write_b128 v2, v[100:103] offset:1024
    s_waitcnt vmcnt(11)
    v_mfma_f32_16x16x32_bf16 v[160:163], v[200:203], a[4:7], v[160:163]
    v_mfma_f32_16x16x32_bf16 v[168:171], v[200:203], a[68:71], v[168:171]
    buffer_load_dwordx4 v[248:251], v10, s[40:43], s70 offen offset:2048 sc1
    v_mfma_f32_16x16x32_bf16 v[176:179], v[200:203], a[132:135], v[176:179]
    v_mfma_f32_16x16x32_bf16 v[184:187], v[200:203], a[196:199], v[184:187]
    ds_write_b128 v3, v[104:107] offset:0
    s_waitcnt vmcnt(11)
    v_mfma_f32_16x16x32_bf16 v[164:167], v[204:207], a[4:7], v[164:167]
    v_mfma_f32_16x16x32_bf16 v[172:175], v[204:207], a[68:71], v[172:175]
    buffer_load_dwordx4 v[252:255], v10, s[40:43], s70 offen offset:3072 sc1
    v_mfma_f32_16x16x32_bf16 v[180:183], v[204:207], a[132:135], v[180:183]
    v_mfma_f32_16x16x32_bf16 v[188:191], v[204:207], a[196:199], v[188:191]
    ds_write_b128 v3, v[108:111] offset:1024
    s_waitcnt vmcnt(11)
    v_mfma_f32_16x16x32_bf16 v[160:163], v[208:211], a[8:11], v[160:163]
    v_mfma_f32_16x16x32_bf16 v[168:171], v[208:211], a[72:75], v[168:171]
    s_xor_b32 s70, s101, 32768
    buffer_load_dwordx4 v[192:195], v10, s[40:43], s70 offen offset:0 sc1
    v_mfma_f32_16x16x32_bf16 v[176:179], v[208:211], a[136:139], v[176:179]
    v_mfma_f32_16x16x32_bf16 v[184:187], v[208:211], a[200:203], v[184:187]
    ds_write_b128 v4, v[112:115] offset:0
    s_waitcnt vmcnt(11)
    v_mfma_f32_16x16x32_bf16 v[164:167], v[212:215], a[8:11], v[164:167]
    v_mfma_f32_16x16x32_bf16 v[172:175], v[212:215], a[72:75], v[172:175]
    buffer_load_dwordx4 v[196:199], v10, s[40:43], s70 offen offset:1024 sc1
    v_mfma_f32_16x16x32_bf16 v[180:183], v[212:215], a[136:139], v[180:183]
    v_mfma_f32_16x16x32_bf16 v[188:191], v[212:215], a[200:203], v[188:191]
    ds_write_b128 v4, v[116:119] offset:1024
    s_waitcnt vmcnt(11)
    v_mfma_f32_16x16x32_bf16 v[160:163], v[216:219], a[12:15], v[160:163]
    v_mfma_f32_16x16x32_bf16 v[168:171], v[216:219], a[76:79], v[168:171]
    buffer_load_dwordx4 v[200:203], v10, s[40:43], s70 offen offset:2048 sc1
    v_mfma_f32_16x16x32_bf16 v[176:179], v[216:219], a[140:143], v[176:179]
    v_mfma_f32_16x16x32_bf16 v[184:187], v[216:219], a[204:207], v[184:187]
    s_waitcnt vmcnt(11)
    v_mfma_f32_16x16x32_bf16 v[164:167], v[220:223], a[12:15], v[164:167]
    v_mfma_f32_16x16x32_bf16 v[172:175], v[220:223], a[76:79], v[172:175]
    buffer_load_dwordx4 v[204:207], v10, s[40:43], s70 offen offset:3072 sc1
    v_mfma_f32_16x16x32_bf16 v[180:183], v[220:223], a[140:143], v[180:183]
    v_mfma_f32_16x16x32_bf16 v[188:191], v[220:223], a[204:207], v[188:191]
    s_waitcnt vmcnt(11)
    v_mfma_f32_16x16x32_bf16 v[160:163], v[224:227], a[16:19], v[160:163]
    v_mfma_f32_16x16x32_bf16 v[168:171], v[224:227], a[80:83], v[168:171]
    s_xor_b32 s70, s70, 4096
    buffer_load_dwordx4 v[208:211], v10, s[40:43], s70 offen offset:0 sc1
    v_mfma_f32_16x16x32_bf16 v[176:179], v[224:227], a[144:147], v[176:179]
    v_mfma_f32_16x16x32_bf16 v[184:187], v[224:227], a[208:211], v[184:187]
    s_waitcnt vmcnt(11)
    v_mfma_f32_16x16x32_bf16 v[164:167], v[228:231], a[16:19], v[164:167]
    v_mfma_f32_16x16x32_bf16 v[172:175], v[228:231], a[80:83], v[172:175]
    buffer_load_dwordx4 v[212:215], v10, s[40:43], s70 offen offset:1024 sc1
    v_mfma_f32_16x16x32_bf16 v[180:183], v[228:231], a[144:147], v[180:183]
    v_mfma_f32_16x16x32_bf16 v[188:191], v[228:231], a[208:211], v[188:191]
    s_waitcnt lgkmcnt(0)
    s_waitcnt vmcnt(11)
    v_mfma_f32_16x16x32_bf16 v[160:163], v[232:235], a[20:23], v[160:163]
    s_barrier
    v_mfma_f32_16x16x32_bf16 v[168:171], v[232:235], a[84:87], v[168:171]
    buffer_load_dwordx4 v[216:219], v10, s[40:43], s70 offen offset:2048 sc1
    ds_read_b128 v[136:139], v5 offset:0
    v_mfma_f32_16x16x32_bf16 v[176:179], v[232:235], a[148:151], v[176:179]
    v_mfma_f32_16x16x32_bf16 v[184:187], v[232:235], a[212:215], v[184:187]
    ds_read_b128 v[140:143], v5 offset:1024
    s_waitcnt vmcnt(11)
    v_mfma_f32_16x16x32_bf16 v[164:167], v[236:239], a[20:23], v[164:167]
    v_mfma_f32_16x16x32_bf16 v[172:175], v[236:239], a[84:87], v[172:175]
    buffer_load_dwordx4 v[220:223], v10, s[40:43], s70 offen offset:3072 sc1
    ds_read_b128 v[144:147], v5 offset:2048
    v_mfma_f32_16x16x32_bf16 v[180:183], v[236:239], a[148:151], v[180:183]
    v_mfma_f32_16x16x32_bf16 v[188:191], v[236:239], a[212:215], v[188:191]
    ds_read_b128 v[148:151], v5 offset:3072
    s_waitcnt vmcnt(11)
    v_mfma_f32_16x16x32_bf16 v[160:163], v[240:243], a[24:27], v[160:163]
    v_mfma_f32_16x16x32_bf16 v[168:171], v[240:243], a[88:91], v[168:171]
    s_xor_b32 s70, s68, 32768
    buffer_load_dwordx4 v[224:227], v10, s[40:43], s70 offen offset:0 sc1
    ds_read_b128 v[152:155], v5 offset:4096
    v_mfma_f32_16x16x32_bf16 v[176:179], v[240:243], a[152:155], v[176:179]
    v_mfma_f32_16x16x32_bf16 v[184:187], v[240:243], a[216:219], v[184:187]
    ds_read_b128 v[156:159], v5 offset:5120
    s_waitcnt vmcnt(11)
    v_mfma_f32_16x16x32_bf16 v[164:167], v[244:247], a[24:27], v[164:167]
    v_mfma_f32_16x16x32_bf16 v[172:175], v[244:247], a[88:91], v[172:175]
    buffer_load_dwordx4 v[228:231], v10, s[40:43], s70 offen offset:1024 sc1
    v_mfma_f32_16x16x32_bf16 v[180:183], v[244:247], a[152:155], v[180:183]
    v_mfma_f32_16x16x32_bf16 v[188:191], v[244:247], a[216:219], v[188:191]
    s_waitcnt vmcnt(11)
    v_mfma_f32_16x16x32_bf16 v[160:163], v[248:251], a[28:31], v[160:163]
    v_mfma_f32_16x16x32_bf16 v[168:171], v[248:251], a[92:95], v[168:171]
    buffer_load_dwordx4 v[232:235], v10, s[40:43], s70 offen offset:2048 sc1
    v_mfma_f32_16x16x32_bf16 v[176:179], v[248:251], a[156:159], v[176:179]
    v_mfma_f32_16x16x32_bf16 v[184:187], v[248:251], a[220:223], v[184:187]
    s_waitcnt lgkmcnt(0)
    s_waitcnt vmcnt(11)
    v_mfma_f32_16x16x32_bf16 v[164:167], v[252:255], a[28:31], v[164:167]
    v_add_f32 v136, v136, v144
    v_mfma_f32_16x16x32_bf16 v[172:175], v[252:255], a[92:95], v[172:175]
    buffer_load_dwordx4 v[236:239], v10, s[40:43], s70 offen offset:3072 sc1
    v_add_f32 v137, v137, v145
    v_mfma_f32_16x16x32_bf16 v[180:183], v[252:255], a[156:159], v[180:183]
    v_add_f32 v138, v138, v146
    v_mfma_f32_16x16x32_bf16 v[188:191], v[252:255], a[220:223], v[188:191]
    v_add_f32 v139, v139, v147
    s_waitcnt vmcnt(11)
    v_mfma_f32_16x16x32_bf16 v[160:163], v[192:195], a[32:35], v[160:163]
    v_add_f32 v140, v140, v148
    v_mfma_f32_16x16x32_bf16 v[168:171], v[192:195], a[96:99], v[168:171]
    s_xor_b32 s70, s70, 4096
    buffer_load_dwordx4 v[240:243], v10, s[40:43], s70 offen offset:0 sc1
    v_add_f32 v141, v141, v149
    v_mfma_f32_16x16x32_bf16 v[176:179], v[192:195], a[160:163], v[176:179]
    v_add_f32 v142, v142, v150
    v_mfma_f32_16x16x32_bf16 v[184:187], v[192:195], a[224:227], v[184:187]
    v_add_f32 v143, v143, v151
    s_waitcnt vmcnt(11)
    v_mfma_f32_16x16x32_bf16 v[164:167], v[196:199], a[32:35], v[164:167]
    v_add_f32 v152, v152, v88
    v_mfma_f32_16x16x32_bf16 v[172:175], v[196:199], a[96:99], v[172:175]
    buffer_load_dwordx4 v[244:247], v10, s[40:43], s70 offen offset:1024 sc1
    v_add_f32 v153, v153, v89
    v_mfma_f32_16x16x32_bf16 v[180:183], v[196:199], a[160:163], v[180:183]
    v_add_f32 v154, v154, v90
    v_mfma_f32_16x16x32_bf16 v[188:191], v[196:199], a[224:227], v[188:191]
    v_add_f32 v155, v155, v91
    s_waitcnt vmcnt(11)
    v_mfma_f32_16x16x32_bf16 v[160:163], v[200:203], a[36:39], v[160:163]
    v_add_f32 v156, v156, v92
    v_mfma_f32_16x16x32_bf16 v[168:171], v[200:203], a[100:103], v[168:171]
    buffer_load_dwordx4 v[248:251], v10, s[40:43], s70 offen offset:2048 sc1
    v_add_f32 v157, v157, v93
    v_mfma_f32_16x16x32_bf16 v[176:179], v[200:203], a[164:167], v[176:179]
    v_add_f32 v158, v158, v94
    v_mfma_f32_16x16x32_bf16 v[184:187], v[200:203], a[228:231], v[184:187]
    v_add_f32 v159, v159, v95
    s_waitcnt vmcnt(11)
    v_mfma_f32_16x16x32_bf16 v[164:167], v[204:207], a[36:39], v[164:167]
    v_add_f32 v136, v136, v152
    v_mfma_f32_16x16x32_bf16 v[172:175], v[204:207], a[100:103], v[172:175]
    buffer_load_dwordx4 v[252:255], v10, s[40:43], s70 offen offset:3072 sc1
    v_add_f32 v137, v137, v153
    v_mfma_f32_16x16x32_bf16 v[180:183], v[204:207], a[164:167], v[180:183]
    v_add_f32 v138, v138, v154
    v_mfma_f32_16x16x32_bf16 v[188:191], v[204:207], a[228:231], v[188:191]
    v_add_f32 v139, v139, v155
    s_waitcnt vmcnt(11)
    v_mfma_f32_16x16x32_bf16 v[160:163], v[208:211], a[40:43], v[160:163]
    v_add_f32 v140, v140, v156
    v_mfma_f32_16x16x32_bf16 v[168:171], v[208:211], a[104:107], v[168:171]
    s_xor_b32 s70, s61, 65536
    buffer_load_dwordx4 v[192:195], v10, s[40:43], s70 offen offset:0 sc1
    v_add_f32 v141, v141, v157
    v_mfma_f32_16x16x32_bf16 v[176:179], v[208:211], a[168:171], v[176:179]
    v_add_f32 v142, v142, v158
    v_mfma_f32_16x16x32_bf16 v[184:187], v[208:211], a[232:235], v[184:187]
    v_add_f32 v143, v143, v159
    s_waitcnt vmcnt(11)
    v_mfma_f32_16x16x32_bf16 v[164:167], v[212:215], a[40:43], v[164:167]
    v_mul_f32 v136, v136, v56
    v_mfma_f32_16x16x32_bf16 v[172:175], v[212:215], a[104:107], v[172:175]
    buffer_load_dwordx4 v[196:199], v10, s[40:43], s70 offen offset:1024 sc1
    v_mul_f32 v137, v137, v57
    v_mfma_f32_16x16x32_bf16 v[180:183], v[212:215], a[168:171], v[180:183]
    v_mul_f32 v138, v138, v58
    v_mfma_f32_16x16x32_bf16 v[188:191], v[212:215], a[232:235], v[188:191]
    v_mul_f32 v139, v139, v59
    s_waitcnt vmcnt(11)
    v_mfma_f32_16x16x32_bf16 v[160:163], v[216:219], a[44:47], v[160:163]
    v_mul_f32 v140, v140, v60
    v_mfma_f32_16x16x32_bf16 v[168:171], v[216:219], a[108:111], v[168:171]
    buffer_load_dwordx4 v[200:203], v10, s[40:43], s70 offen offset:2048 sc1
    v_mul_f32 v141, v141, v61
    v_mfma_f32_16x16x32_bf16 v[176:179], v[216:219], a[172:175], v[176:179]
    v_mul_f32 v142, v142, v62
    v_mfma_f32_16x16x32_bf16 v[184:187], v[216:219], a[236:239], v[184:187]
    v_mul_f32 v143, v143, v63
    s_waitcnt vmcnt(11)
    v_mfma_f32_16x16x32_bf16 v[164:167], v[220:223], a[44:47], v[164:167]
    v_cvt_pk_bf16_f32 v120, v136, v137
    v_mfma_f32_16x16x32_bf16 v[172:175], v[220:223], a[108:111], v[172:175]
    buffer_load_dwordx4 v[204:207], v10, s[40:43], s70 offen offset:3072 sc1
    v_cvt_pk_bf16_f32 v121, v138, v139
    v_mfma_f32_16x16x32_bf16 v[180:183], v[220:223], a[172:175], v[180:183]
    v_cvt_pk_bf16_f32 v122, v140, v141
    v_mfma_f32_16x16x32_bf16 v[188:191], v[220:223], a[236:239], v[188:191]
    v_cvt_pk_bf16_f32 v123, v142, v143
    s_waitcnt vmcnt(11)
    v_mfma_f32_16x16x32_bf16 v[160:163], v[224:227], a[48:51], v[160:163]
    buffer_store_dwordx4 v[120:123], v10, s[40:43], s67 offen offset:0 sc1
    v_mfma_f32_16x16x32_bf16 v[168:171], v[224:227], a[112:115], v[168:171]
    s_xor_b32 s70, s70, 4096
    buffer_load_dwordx4 v[208:211], v10, s[40:43], s70 offen offset:0 sc1
    v_mfma_f32_16x16x32_bf16 v[176:179], v[224:227], a[176:179], v[176:179]
    v_mfma_f32_16x16x32_bf16 v[184:187], v[224:227], a[240:243], v[184:187]
    s_waitcnt vmcnt(12)
    v_mfma_f32_16x16x32_bf16 v[164:167], v[228:231], a[48:51], v[164:167]
    v_mfma_f32_16x16x32_bf16 v[172:175], v[228:231], a[112:115], v[172:175]
    buffer_load_dwordx4 v[212:215], v10, s[40:43], s70 offen offset:1024 sc1
    v_mfma_f32_16x16x32_bf16 v[180:183], v[228:231], a[176:179], v[180:183]
    v_mfma_f32_16x16x32_bf16 v[188:191], v[228:231], a[240:243], v[188:191]
    s_waitcnt vmcnt(12)
    v_mfma_f32_16x16x32_bf16 v[160:163], v[232:235], a[52:55], v[160:163]
    v_mfma_f32_16x16x32_bf16 v[168:171], v[232:235], a[116:119], v[168:171]
    buffer_load_dwordx4 v[216:219], v10, s[40:43], s70 offen offset:2048 sc1
    v_mfma_f32_16x16x32_bf16 v[176:179], v[232:235], a[180:183], v[176:179]
    v_mfma_f32_16x16x32_bf16 v[184:187], v[232:235], a[244:247], v[184:187]
    s_waitcnt vmcnt(12)
    v_mfma_f32_16x16x32_bf16 v[164:167], v[236:239], a[52:55], v[164:167]
    v_mfma_f32_16x16x32_bf16 v[172:175], v[236:239], a[116:119], v[172:175]
    buffer_load_dwordx4 v[220:223], v10, s[40:43], s70 offen offset:3072 sc1
    v_mfma_f32_16x16x32_bf16 v[180:183], v[236:239], a[180:183], v[180:183]
    v_mfma_f32_16x16x32_bf16 v[188:191], v[236:239], a[244:247], v[188:191]
    s_waitcnt vmcnt(12)
    v_mfma_f32_16x16x32_bf16 v[160:163], v[240:243], a[56:59], v[160:163]
    v_mfma_f32_16x16x32_bf16 v[168:171], v[240:243], a[120:123], v[168:171]
    s_xor_b32 s70, s100, 65536
    buffer_load_dwordx4 v[224:227], v10, s[40:43], s70 offen offset:0 sc1
    v_mfma_f32_16x16x32_bf16 v[176:179], v[240:243], a[184:187], v[176:179]
    v_mfma_f32_16x16x32_bf16 v[184:187], v[240:243], a[248:251], v[184:187]
    s_waitcnt vmcnt(12)
    v_mfma_f32_16x16x32_bf16 v[164:167], v[244:247], a[56:59], v[164:167]
    v_mfma_f32_16x16x32_bf16 v[172:175], v[244:247], a[120:123], v[172:175]
    buffer_load_dwordx4 v[228:231], v10, s[40:43], s70 offen offset:1024 sc1
    v_mfma_f32_16x16x32_bf16 v[180:183], v[244:247], a[184:187], v[180:183]
    v_mfma_f32_16x16x32_bf16 v[188:191], v[244:247], a[248:251], v[188:191]
    s_waitcnt vmcnt(12)
    v_mfma_f32_16x16x32_bf16 v[160:163], v[248:251], a[60:63], v[160:163]
    v_mfma_f32_16x16x32_bf16 v[168:171], v[248:251], a[124:127], v[168:171]
    buffer_load_dwordx4 v[232:235], v10, s[40:43], s70 offen offset:2048 sc1
    v_mfma_f32_16x16x32_bf16 v[176:179], v[248:251], a[188:191], v[176:179]
    v_mfma_f32_16x16x32_bf16 v[184:187], v[248:251], a[252:255], v[184:187]
    s_waitcnt vmcnt(12)
    v_mfma_f32_16x16x32_bf16 v[164:167], v[252:255], a[60:63], v[164:167]
    v_mfma_f32_16x16x32_bf16 v[172:175], v[252:255], a[124:127], v[172:175]
    buffer_load_dwordx4 v[236:239], v10, s[40:43], s70 offen offset:3072 sc1
    v_mfma_f32_16x16x32_bf16 v[180:183], v[252:255], a[188:191], v[180:183]
    v_mfma_f32_16x16x32_bf16 v[188:191], v[252:255], a[252:255], v[188:191]
    s_waitcnt vmcnt(12)
    v_mfma_f32_16x16x32_bf16 v[88:91], v[192:195], a[0:3], v[48:51]
    v_mfma_f32_16x16x32_bf16 v[96:99], v[192:195], a[64:67], 0
    s_xor_b32 s70, s70, 4096
    buffer_load_dwordx4 v[240:243], v10, s[40:43], s70 offen offset:0 sc1
    v_mfma_f32_16x16x32_bf16 v[104:107], v[192:195], a[128:131], 0
    v_mfma_f32_16x16x32_bf16 v[112:115], v[192:195], a[192:195], 0
    ds_write_b128 v2, v[168:171] offset:24576
    s_waitcnt vmcnt(12)
    v_mfma_f32_16x16x32_bf16 v[92:95], v[196:199], a[0:3], v[48:51]
    v_mfma_f32_16x16x32_bf16 v[100:103], v[196:199], a[64:67], 0
    buffer_load_dwordx4 v[244:247], v10, s[40:43], s70 offen offset:1024 sc1
    v_mfma_f32_16x16x32_bf16 v[108:111], v[196:199], a[128:131], 0
    v_mfma_f32_16x16x32_bf16 v[116:119], v[196:199], a[192:195], 0
    ds_write_b128 v2, v[172:175] offset:25600
    s_waitcnt vmcnt(12)
    v_mfma_f32_16x16x32_bf16 v[88:91], v[200:203], a[4:7], v[88:91]
    v_mfma_f32_16x16x32_bf16 v[96:99], v[200:203], a[68:71], v[96:99]
    buffer_load_dwordx4 v[248:251], v10, s[40:43], s70 offen offset:2048 sc1
    v_mfma_f32_16x16x32_bf16 v[104:107], v[200:203], a[132:135], v[104:107]
    v_mfma_f32_16x16x32_bf16 v[112:115], v[200:203], a[196:199], v[112:115]
    ds_write_b128 v3, v[176:179] offset:24576
    s_waitcnt vmcnt(12)
    v_mfma_f32_16x16x32_bf16 v[92:95], v[204:207], a[4:7], v[92:95]
    v_mfma_f32_16x16x32_bf16 v[100:103], v[204:207], a[68:71], v[100:103]
    buffer_load_dwordx4 v[252:255], v10, s[40:43], s70 offen offset:3072 sc1
    v_mfma_f32_16x16x32_bf16 v[108:111], v[204:207], a[132:135], v[108:111]
    v_mfma_f32_16x16x32_bf16 v[116:119], v[204:207], a[196:199], v[116:119]
    ds_write_b128 v3, v[180:183] offset:25600
    s_waitcnt vmcnt(11)
    v_mfma_f32_16x16x32_bf16 v[88:91], v[208:211], a[8:11], v[88:91]
    v_mfma_f32_16x16x32_bf16 v[96:99], v[208:211], a[72:75], v[96:99]
    s_xor_b32 s70, s101, 65536
    buffer_load_dwordx4 v[192:195], v10, s[40:43], s70 offen offset:0 sc1
    v_mfma_f32_16x16x32_bf16 v[104:107], v[208:211], a[136:139], v[104:107]
    v_mfma_f32_16x16x32_bf16 v[112:115], v[208:211], a[200:203], v[112:115]
    ds_write_b128 v4, v[184:187] offset:24576
    s_waitcnt vmcnt(11)
    v_mfma_f32_16x16x32_bf16 v[92:95], v[212:215], a[8:11], v[92:95]
    v_mfma_f32_16x16x32_bf16 v[100:103], v[212:215], a[72:75], v[100:103]
    buffer_load_dwordx4 v[196:199], v10, s[40:43], s70 offen offset:1024 sc1
    v_mfma_f32_16x16x32_bf16 v[108:111], v[212:215], a[136:139], v[108:111]
    v_mfma_f32_16x16x32_bf16 v[116:119], v[212:215], a[200:203], v[116:119]
    ds_write_b128 v4, v[188:191] offset:25600
    s_waitcnt vmcnt(11)
    v_mfma_f32_16x16x32_bf16 v[88:91], v[216:219], a[12:15], v[88:91]
    v_mfma_f32_16x16x32_bf16 v[96:99], v[216:219], a[76:79], v[96:99]
    buffer_load_dwordx4 v[200:203], v10, s[40:43], s70 offen offset:2048 sc1
    v_mfma_f32_16x16x32_bf16 v[104:107], v[216:219], a[140:143], v[104:107]
    v_mfma_f32_16x16x32_bf16 v[112:115], v[216:219], a[204:207], v[112:115]
    s_waitcnt vmcnt(11)
    v_mfma_f32_16x16x32_bf16 v[92:95], v[220:223], a[12:15], v[92:95]
    v_mfma_f32_16x16x32_bf16 v[100:103], v[220:223], a[76:79], v[100:103]
    buffer_load_dwordx4 v[204:207], v10, s[40:43], s70 offen offset:3072 sc1
    v_mfma_f32_16x16x32_bf16 v[108:111], v[220:223], a[140:143], v[108:111]
    v_mfma_f32_16x16x32_bf16 v[116:119], v[220:223], a[204:207], v[116:119]
    s_waitcnt vmcnt(11)
    v_mfma_f32_16x16x32_bf16 v[88:91], v[224:227], a[16:19], v[88:91]
    v_mfma_f32_16x16x32_bf16 v[96:99], v[224:227], a[80:83], v[96:99]
    s_xor_b32 s70, s70, 4096
    buffer_load_dwordx4 v[208:211], v10, s[40:43], s70 offen offset:0 sc1
    v_mfma_f32_16x16x32_bf16 v[104:107], v[224:227], a[144:147], v[104:107]
    v_mfma_f32_16x16x32_bf16 v[112:115], v[224:227], a[208:211], v[112:115]
    s_waitcnt vmcnt(11)
    v_mfma_f32_16x16x32_bf16 v[92:95], v[228:231], a[16:19], v[92:95]
    v_mfma_f32_16x16x32_bf16 v[100:103], v[228:231], a[80:83], v[100:103]
    buffer_load_dwordx4 v[212:215], v10, s[40:43], s70 offen offset:1024 sc1
    v_mfma_f32_16x16x32_bf16 v[108:111], v[228:231], a[144:147], v[108:111]
    v_mfma_f32_16x16x32_bf16 v[116:119], v[228:231], a[208:211], v[116:119]
    s_waitcnt lgkmcnt(0)
    s_waitcnt vmcnt(11)
    v_mfma_f32_16x16x32_bf16 v[88:91], v[232:235], a[20:23], v[88:91]
    s_barrier
    v_mfma_f32_16x16x32_bf16 v[96:99], v[232:235], a[84:87], v[96:99]
    buffer_load_dwordx4 v[216:219], v10, s[40:43], s70 offen offset:2048 sc1
    ds_read_b128 v[136:139], v5 offset:24576
    v_mfma_f32_16x16x32_bf16 v[104:107], v[232:235], a[148:151], v[104:107]
    v_mfma_f32_16x16x32_bf16 v[112:115], v[232:235], a[212:215], v[112:115]
    ds_read_b128 v[140:143], v5 offset:25600
    s_waitcnt vmcnt(11)
    v_mfma_f32_16x16x32_bf16 v[92:95], v[236:239], a[20:23], v[92:95]
    v_mfma_f32_16x16x32_bf16 v[100:103], v[236:239], a[84:87], v[100:103]
    buffer_load_dwordx4 v[220:223], v10, s[40:43], s70 offen offset:3072 sc1
    ds_read_b128 v[144:147], v5 offset:26624
    v_mfma_f32_16x16x32_bf16 v[108:111], v[236:239], a[148:151], v[108:111]
    v_mfma_f32_16x16x32_bf16 v[116:119], v[236:239], a[212:215], v[116:119]
    ds_read_b128 v[148:151], v5 offset:27648
    s_waitcnt vmcnt(11)
    v_mfma_f32_16x16x32_bf16 v[88:91], v[240:243], a[24:27], v[88:91]
    v_mfma_f32_16x16x32_bf16 v[96:99], v[240:243], a[88:91], v[96:99]
    s_xor_b32 s70, s68, 65536
    buffer_load_dwordx4 v[224:227], v10, s[40:43], s70 offen offset:0 sc1
    ds_read_b128 v[152:155], v5 offset:28672
    v_mfma_f32_16x16x32_bf16 v[104:107], v[240:243], a[152:155], v[104:107]
    v_mfma_f32_16x16x32_bf16 v[112:115], v[240:243], a[216:219], v[112:115]
    ds_read_b128 v[156:159], v5 offset:29696
    s_waitcnt vmcnt(11)
    v_mfma_f32_16x16x32_bf16 v[92:95], v[244:247], a[24:27], v[92:95]
    v_mfma_f32_16x16x32_bf16 v[100:103], v[244:247], a[88:91], v[100:103]
    buffer_load_dwordx4 v[228:231], v10, s[40:43], s70 offen offset:1024 sc1
    v_mfma_f32_16x16x32_bf16 v[108:111], v[244:247], a[152:155], v[108:111]
    v_mfma_f32_16x16x32_bf16 v[116:119], v[244:247], a[216:219], v[116:119]
    s_waitcnt vmcnt(11)
    v_mfma_f32_16x16x32_bf16 v[88:91], v[248:251], a[28:31], v[88:91]
    v_mfma_f32_16x16x32_bf16 v[96:99], v[248:251], a[92:95], v[96:99]
    buffer_load_dwordx4 v[232:235], v10, s[40:43], s70 offen offset:2048 sc1
    v_mfma_f32_16x16x32_bf16 v[104:107], v[248:251], a[156:159], v[104:107]
    v_mfma_f32_16x16x32_bf16 v[112:115], v[248:251], a[220:223], v[112:115]
    s_waitcnt lgkmcnt(0)
    s_waitcnt vmcnt(11)
    v_mfma_f32_16x16x32_bf16 v[92:95], v[252:255], a[28:31], v[92:95]
    v_add_f32 v136, v136, v144
    v_mfma_f32_16x16x32_bf16 v[100:103], v[252:255], a[92:95], v[100:103]
    buffer_load_dwordx4 v[236:239], v10, s[40:43], s70 offen offset:3072 sc1
    v_add_f32 v137, v137, v145
    v_mfma_f32_16x16x32_bf16 v[108:111], v[252:255], a[156:159], v[108:111]
    v_add_f32 v138, v138, v146
    v_mfma_f32_16x16x32_bf16 v[116:119], v[252:255], a[220:223], v[116:119]
    v_add_f32 v139, v139, v147
    s_waitcnt vmcnt(11)
    v_mfma_f32_16x16x32_bf16 v[88:91], v[192:195], a[32:35], v[88:91]
    v_add_f32 v140, v140, v148
    v_mfma_f32_16x16x32_bf16 v[96:99], v[192:195], a[96:99], v[96:99]
    s_xor_b32 s70, s70, 4096
    buffer_load_dwordx4 v[240:243], v10, s[40:43], s70 offen offset:0 sc1
    v_add_f32 v141, v141, v149
    v_mfma_f32_16x16x32_bf16 v[104:107], v[192:195], a[160:163], v[104:107]
    v_add_f32 v142, v142, v150
    v_mfma_f32_16x16x32_bf16 v[112:115], v[192:195], a[224:227], v[112:115]
    v_add_f32 v143, v143, v151
    s_waitcnt vmcnt(11)
    v_mfma_f32_16x16x32_bf16 v[92:95], v[196:199], a[32:35], v[92:95]
    v_add_f32 v152, v152, v160
    v_mfma_f32_16x16x32_bf16 v[100:103], v[196:199], a[96:99], v[100:103]
    buffer_load_dwordx4 v[244:247], v10, s[40:43], s70 offen offset:1024 sc1
    v_add_f32 v153, v153, v161
    v_mfma_f32_16x16x32_bf16 v[108:111], v[196:199], a[160:163], v[108:111]
    v_add_f32 v154, v154, v162
    v_mfma_f32_16x16x32_bf16 v[116:119], v[196:199], a[224:227], v[116:119]
    v_add_f32 v155, v155, v163
    s_waitcnt vmcnt(11)
    v_mfma_f32_16x16x32_bf16 v[88:91], v[200:203], a[36:39], v[88:91]
    v_add_f32 v156, v156, v164
    v_mfma_f32_16x16x32_bf16 v[96:99], v[200:203], a[100:103], v[96:99]
    buffer_load_dwordx4 v[248:251], v10, s[40:43], s70 offen offset:2048 sc1
    v_add_f32 v157, v157, v165
    v_mfma_f32_16x16x32_bf16 v[104:107], v[200:203], a[164:167], v[104:107]
    v_add_f32 v158, v158, v166
    v_mfma_f32_16x16x32_bf16 v[112:115], v[200:203], a[228:231], v[112:115]
    v_add_f32 v159, v159, v167
    s_waitcnt vmcnt(11)
    v_mfma_f32_16x16x32_bf16 v[92:95], v[204:207], a[36:39], v[92:95]
    v_add_f32 v136, v136, v152
    v_mfma_f32_16x16x32_bf16 v[100:103], v[204:207], a[100:103], v[100:103]
    buffer_load_dwordx4 v[252:255], v10, s[40:43], s70 offen offset:3072 sc1
    v_add_f32 v137, v137, v153
    v_mfma_f32_16x16x32_bf16 v[108:111], v[204:207], a[164:167], v[108:111]
    v_add_f32 v138, v138, v154
    v_mfma_f32_16x16x32_bf16 v[116:119], v[204:207], a[228:231], v[116:119]
    v_add_f32 v139, v139, v155
    s_waitcnt vmcnt(11)
    v_mfma_f32_16x16x32_bf16 v[88:91], v[208:211], a[40:43], v[88:91]
    v_add_f32 v140, v140, v156
    v_mfma_f32_16x16x32_bf16 v[96:99], v[208:211], a[104:107], v[96:99]
    s_xor_b32 s70, s61, 98304
    buffer_load_dwordx4 v[192:195], v10, s[40:43], s70 offen offset:0 sc1
    v_add_f32 v141, v141, v157
    v_mfma_f32_16x16x32_bf16 v[104:107], v[208:211], a[168:171], v[104:107]
    v_add_f32 v142, v142, v158
    v_mfma_f32_16x16x32_bf16 v[112:115], v[208:211], a[232:235], v[112:115]
    v_add_f32 v143, v143, v159
    s_waitcnt vmcnt(11)
    v_mfma_f32_16x16x32_bf16 v[92:95], v[212:215], a[40:43], v[92:95]
    v_mul_f32 v136, v136, v64
    v_mfma_f32_16x16x32_bf16 v[100:103], v[212:215], a[104:107], v[100:103]
    buffer_load_dwordx4 v[196:199], v10, s[40:43], s70 offen offset:1024 sc1
    v_mul_f32 v137, v137, v65
    v_mfma_f32_16x16x32_bf16 v[108:111], v[212:215], a[168:171], v[108:111]
    v_mul_f32 v138, v138, v66
    v_mfma_f32_16x16x32_bf16 v[116:119], v[212:215], a[232:235], v[116:119]
    v_mul_f32 v139, v139, v67
    s_waitcnt vmcnt(11)
    v_mfma_f32_16x16x32_bf16 v[88:91], v[216:219], a[44:47], v[88:91]
    v_mul_f32 v140, v140, v68
    v_mfma_f32_16x16x32_bf16 v[96:99], v[216:219], a[108:111], v[96:99]
    buffer_load_dwordx4 v[200:203], v10, s[40:43], s70 offen offset:2048 sc1
    v_mul_f32 v141, v141, v69
    v_mfma_f32_16x16x32_bf16 v[104:107], v[216:219], a[172:175], v[104:107]
    v_mul_f32 v142, v142, v70
    v_mfma_f32_16x16x32_bf16 v[112:115], v[216:219], a[236:239], v[112:115]
    v_mul_f32 v143, v143, v71
    s_waitcnt vmcnt(11)
    v_mfma_f32_16x16x32_bf16 v[92:95], v[220:223], a[44:47], v[92:95]
    v_cvt_pk_bf16_f32 v124, v136, v137
    v_mfma_f32_16x16x32_bf16 v[100:103], v[220:223], a[108:111], v[100:103]
    buffer_load_dwordx4 v[204:207], v10, s[40:43], s70 offen offset:3072 sc1
    v_cvt_pk_bf16_f32 v125, v138, v139
    v_mfma_f32_16x16x32_bf16 v[108:111], v[220:223], a[172:175], v[108:111]
    v_cvt_pk_bf16_f32 v126, v140, v141
    v_mfma_f32_16x16x32_bf16 v[116:119], v[220:223], a[236:239], v[116:119]
    v_cvt_pk_bf16_f32 v127, v142, v143
    s_waitcnt vmcnt(11)
    v_mfma_f32_16x16x32_bf16 v[88:91], v[224:227], a[48:51], v[88:91]
    buffer_store_dwordx4 v[124:127], v10, s[40:43], s67 offen offset:1024 sc1
    v_mfma_f32_16x16x32_bf16 v[96:99], v[224:227], a[112:115], v[96:99]
    s_xor_b32 s70, s70, 4096
    buffer_load_dwordx4 v[208:211], v10, s[40:43], s70 offen offset:0 sc1
    v_mfma_f32_16x16x32_bf16 v[104:107], v[224:227], a[176:179], v[104:107]
    v_mfma_f32_16x16x32_bf16 v[112:115], v[224:227], a[240:243], v[112:115]
    s_waitcnt vmcnt(12)
    v_mfma_f32_16x16x32_bf16 v[92:95], v[228:231], a[48:51], v[92:95]
    v_mfma_f32_16x16x32_bf16 v[100:103], v[228:231], a[112:115], v[100:103]
    buffer_load_dwordx4 v[212:215], v10, s[40:43], s70 offen offset:1024 sc1
    v_mfma_f32_16x16x32_bf16 v[108:111], v[228:231], a[176:179], v[108:111]
    v_mfma_f32_16x16x32_bf16 v[116:119], v[228:231], a[240:243], v[116:119]
    s_waitcnt vmcnt(12)
    v_mfma_f32_16x16x32_bf16 v[88:91], v[232:235], a[52:55], v[88:91]
    v_mfma_f32_16x16x32_bf16 v[96:99], v[232:235], a[116:119], v[96:99]
    buffer_load_dwordx4 v[216:219], v10, s[40:43], s70 offen offset:2048 sc1
    v_mfma_f32_16x16x32_bf16 v[104:107], v[232:235], a[180:183], v[104:107]
    v_mfma_f32_16x16x32_bf16 v[112:115], v[232:235], a[244:247], v[112:115]
    s_waitcnt vmcnt(12)
    v_mfma_f32_16x16x32_bf16 v[92:95], v[236:239], a[52:55], v[92:95]
    v_mfma_f32_16x16x32_bf16 v[100:103], v[236:239], a[116:119], v[100:103]
    buffer_load_dwordx4 v[220:223], v10, s[40:43], s70 offen offset:3072 sc1
    v_mfma_f32_16x16x32_bf16 v[108:111], v[236:239], a[180:183], v[108:111]
    v_mfma_f32_16x16x32_bf16 v[116:119], v[236:239], a[244:247], v[116:119]
    s_waitcnt vmcnt(12)
    v_mfma_f32_16x16x32_bf16 v[88:91], v[240:243], a[56:59], v[88:91]
    v_mfma_f32_16x16x32_bf16 v[96:99], v[240:243], a[120:123], v[96:99]
    s_xor_b32 s70, s100, 98304
    buffer_load_dwordx4 v[224:227], v10, s[40:43], s70 offen offset:0 sc1
    v_mfma_f32_16x16x32_bf16 v[104:107], v[240:243], a[184:187], v[104:107]
    v_mfma_f32_16x16x32_bf16 v[112:115], v[240:243], a[248:251], v[112:115]
    s_waitcnt vmcnt(12)
    v_mfma_f32_16x16x32_bf16 v[92:95], v[244:247], a[56:59], v[92:95]
    v_mfma_f32_16x16x32_bf16 v[100:103], v[244:247], a[120:123], v[100:103]
    buffer_load_dwordx4 v[228:231], v10, s[40:43], s70 offen offset:1024 sc1
    v_mfma_f32_16x16x32_bf16 v[108:111], v[244:247], a[184:187], v[108:111]
    v_mfma_f32_16x16x32_bf16 v[116:119], v[244:247], a[248:251], v[116:119]
    s_waitcnt vmcnt(12)
    v_mfma_f32_16x16x32_bf16 v[88:91], v[248:251], a[60:63], v[88:91]
    v_mfma_f32_16x16x32_bf16 v[96:99], v[248:251], a[124:127], v[96:99]
    buffer_load_dwordx4 v[232:235], v10, s[40:43], s70 offen offset:2048 sc1
    v_mfma_f32_16x16x32_bf16 v[104:107], v[248:251], a[188:191], v[104:107]
    v_mfma_f32_16x16x32_bf16 v[112:115], v[248:251], a[252:255], v[112:115]
    s_waitcnt vmcnt(12)
    v_mfma_f32_16x16x32_bf16 v[92:95], v[252:255], a[60:63], v[92:95]
    v_mfma_f32_16x16x32_bf16 v[100:103], v[252:255], a[124:127], v[100:103]
    buffer_load_dwordx4 v[236:239], v10, s[40:43], s70 offen offset:3072 sc1
    v_mfma_f32_16x16x32_bf16 v[108:111], v[252:255], a[188:191], v[108:111]
    v_mfma_f32_16x16x32_bf16 v[116:119], v[252:255], a[252:255], v[116:119]
    s_waitcnt vmcnt(12)
    v_mfma_f32_16x16x32_bf16 v[160:163], v[192:195], a[0:3], v[48:51]
    v_mfma_f32_16x16x32_bf16 v[168:171], v[192:195], a[64:67], 0
    s_xor_b32 s70, s70, 4096
    buffer_load_dwordx4 v[240:243], v10, s[40:43], s70 offen offset:0 sc1
    v_mfma_f32_16x16x32_bf16 v[176:179], v[192:195], a[128:131], 0
    v_mfma_f32_16x16x32_bf16 v[184:187], v[192:195], a[192:195], 0
    ds_write_b128 v2, v[96:99] offset:0
    s_waitcnt vmcnt(12)
    v_mfma_f32_16x16x32_bf16 v[164:167], v[196:199], a[0:3], v[48:51]
    v_mfma_f32_16x16x32_bf16 v[172:175], v[196:199], a[64:67], 0
    buffer_load_dwordx4 v[244:247], v10, s[40:43], s70 offen offset:1024 sc1
    v_mfma_f32_16x16x32_bf16 v[180:183], v[196:199], a[128:131], 0
    ds_write_b128 v2, v[100:103] offset:1024
    v_mfma_f32_16x16x32_bf16 v[188:191], v[196:199], a[192:195], 0
    s_waitcnt vmcnt(12)
    v_mfma_f32_16x16x32_bf16 v[160:163], v[200:203], a[4:7], v[160:163]
    v_mfma_f32_16x16x32_bf16 v[168:171], v[200:203], a[68:71], v[168:171]
    buffer_load_dwordx4 v[248:251], v10, s[40:43], s70 offen offset:2048 sc1
    ds_write_b128 v3, v[104:107] offset:0
    v_mfma_f32_16x16x32_bf16 v[176:179], v[200:203], a[132:135], v[176:179]
    v_mfma_f32_16x16x32_bf16 v[184:187], v[200:203], a[196:199], v[184:187]
    s_waitcnt vmcnt(12)
    v_mfma_f32_16x16x32_bf16 v[164:167], v[204:207], a[4:7], v[164:167]
    ds_write_b128 v3, v[108:111] offset:1024
    v_mfma_f32_16x16x32_bf16 v[172:175], v[204:207], a[68:71], v[172:175]
    buffer_load_dwordx4 v[252:255], v10, s[40:43], s70 offen offset:3072 sc1
    v_mfma_f32_16x16x32_bf16 v[180:183], v[204:207], a[132:135], v[180:183]
    v_mfma_f32_16x16x32_bf16 v[188:191], v[204:207], a[196:199], v[188:191]
    ds_write_b128 v4, v[112:115] offset:0
    s_waitcnt vmcnt(11)
    v_mfma_f32_16x16x32_bf16 v[160:163], v[208:211], a[8:11], v[160:163]
    v_mfma_f32_16x16x32_bf16 v[168:171], v[208:211], a[72:75], v[168:171]
    s_xor_b32 s70, s101, 98304
    buffer_load_dwordx4 v[192:195], v10, s[40:43], s70 offen offset:0 sc1
    v_mfma_f32_16x16x32_bf16 v[176:179], v[208:211], a[136:139], v[176:179]
    ds_write_b128 v4, v[116:119] offset:1024
    v_mfma_f32_16x16x32_bf16 v[184:187], v[208:211], a[200:203], v[184:187]
    s_waitcnt vmcnt(11)
    v_mfma_f32_16x16x32_bf16 v[164:167], v[212:215], a[8:11], v[164:167]
    v_mfma_f32_16x16x32_bf16 v[172:175], v[212:215], a[72:75], v[172:175]
    buffer_load_dwordx4 v[196:199], v10, s[40:43], s70 offen offset:1024 sc1
    v_mfma_f32_16x16x32_bf16 v[180:183], v[212:215], a[136:139], v[180:183]
    v_mfma_f32_16x16x32_bf16 v[188:191], v[212:215], a[200:203], v[188:191]
    s_waitcnt vmcnt(11)
    v_mfma_f32_16x16x32_bf16 v[160:163], v[216:219], a[12:15], v[160:163]
    v_mfma_f32_16x16x32_bf16 v[168:171], v[216:219], a[76:79], v[168:171]
    buffer_load_dwordx4 v[200:203], v10, s[40:43], s70 offen offset:2048 sc1
    v_mfma_f32_16x16x32_bf16 v[176:179], v[216:219], a[140:143], v[176:179]
    v_mfma_f32_16x16x32_bf16 v[184:187], v[216:219], a[204:207], v[184:187]
    s_waitcnt vmcnt(11)
    v_mfma_f32_16x16x32_bf16 v[164:167], v[220:223], a[12:15], v[164:167]
    v_mfma_f32_16x16x32_bf16 v[172:175], v[220:223], a[76:79], v[172:175]
    buffer_load_dwordx4 v[204:207], v10, s[40:43], s70 offen offset:3072 sc1
    s_waitcnt lgkmcnt(0)
    v_mfma_f32_16x16x32_bf16 v[180:183], v[220:223], a[140:143], v[180:183]
    s_barrier
    v_mfma_f32_16x16x32_bf16 v[188:191], v[220:223], a[204:207], v[188:191]
    ds_read_b128 v[136:139], v5 offset:0
    s_waitcnt vmcnt(11)
    v_mfma_f32_16x16x32_bf16 v[160:163], v[224:227], a[16:19], v[160:163]
    v_mfma_f32_16x16x32_bf16 v[168:171], v[224:227], a[80:83], v[168:171]
    s_xor_b32 s70, s70, 4096
    buffer_load_dwordx4 v[208:211], v10, s[40:43], s70 offen offset:0 sc1
    ds_read_b128 v[140:143], v5 offset:1024
    v_mfma_f32_16x16x32_bf16 v[176:179], v[224:227], a[144:147], v[176:179]
    v_mfma_f32_16x16x32_bf16 v[184:187], v[224:227], a[208:211], v[184:187]
    ds_read_b128 v[144:147], v5 offset:2048
    s_waitcnt vmcnt(11)
    v_mfma_f32_16x16x32_bf16 v[164:167], v[228:231], a[16:19], v[164:167]
    v_mfma_f32_16x16x32_bf16 v[172:175], v[228:231], a[80:83], v[172:175]
    buffer_load_dwordx4 v[212:215], v10, s[40:43], s70 offen offset:1024 sc1
    ds_read_b128 v[148:151], v5 offset:3072
    v_mfma_f32_16x16x32_bf16 v[180:183], v[228:231], a[144:147], v[180:183]
    v_mfma_f32_16x16x32_bf16 v[188:191], v[228:231], a[208:211], v[188:191]
    ds_read_b128 v[152:155], v5 offset:4096
    s_waitcnt vmcnt(11)
    v_mfma_f32_16x16x32_bf16 v[160:163], v[232:235], a[20:23], v[160:163]
    v_mfma_f32_16x16x32_bf16 v[168:171], v[232:235], a[84:87], v[168:171]
    buffer_load_dwordx4 v[216:219], v10, s[40:43], s70 offen offset:2048 sc1
    ds_read_b128 v[156:159], v5 offset:5120
    v_mfma_f32_16x16x32_bf16 v[176:179], v[232:235], a[148:151], v[176:179]
    v_mfma_f32_16x16x32_bf16 v[184:187], v[232:235], a[212:215], v[184:187]
    s_waitcnt vmcnt(11)
    v_mfma_f32_16x16x32_bf16 v[164:167], v[236:239], a[20:23], v[164:167]
    v_mfma_f32_16x16x32_bf16 v[172:175], v[236:239], a[84:87], v[172:175]
    buffer_load_dwordx4 v[220:223], v10, s[40:43], s70 offen offset:3072 sc1
    v_mfma_f32_16x16x32_bf16 v[180:183], v[236:239], a[148:151], v[180:183]
    v_mfma_f32_16x16x32_bf16 v[188:191], v[236:239], a[212:215], v[188:191]
    s_waitcnt vmcnt(11)
    v_mfma_f32_16x16x32_bf16 v[160:163], v[240:243], a[24:27], v[160:163]
    v_mfma_f32_16x16x32_bf16 v[168:171], v[240:243], a[88:91], v[168:171]
    s_xor_b32 s70, s68, 98304
    buffer_load_dwordx4 v[224:227], v10, s[40:43], s70 offen offset:0 sc1
    s_waitcnt lgkmcnt(0)
    v_mfma_f32_16x16x32_bf16 v[176:179], v[240:243], a[152:155], v[176:179]
    v_add_f32 v136, v136, v144
    v_mfma_f32_16x16x32_bf16 v[184:187], v[240:243], a[216:219], v[184:187]
    v_add_f32 v137, v137, v145
    s_waitcnt vmcnt(11)
    v_mfma_f32_16x16x32_bf16 v[164:167], v[244:247], a[24:27], v[164:167]
    v_add_f32 v138, v138, v146
    v_mfma_f32_16x16x32_bf16 v[172:175], v[244:247], a[88:91], v[172:175]
    buffer_load_dwordx4 v[228:231], v10, s[40:43], s70 offen offset:1024 sc1
    v_add_f32 v139, v139, v147
    v_mfma_f32_16x16x32_bf16 v[180:183], v[244:247], a[152:155], v[180:183]
    v_add_f32 v140, v140, v148
    v_mfma_f32_16x16x32_bf16 v[188:191], v[244:247], a[216:219], v[188:191]
    v_add_f32 v141, v141, v149
    s_waitcnt vmcnt(11)
    v_mfma_f32_16x16x32_bf16 v[160:163], v[248:251], a[28:31], v[160:163]
    v_add_f32 v142, v142, v150
    v_mfma_f32_16x16x32_bf16 v[168:171], v[248:251], a[92:95], v[168:171]
    buffer_load_dwordx4 v[232:235], v10, s[40:43], s70 offen offset:2048 sc1
    v_add_f32 v143, v143, v151
    v_mfma_f32_16x16x32_bf16 v[176:179], v[248:251], a[156:159], v[176:179]
    v_add_f32 v152, v152, v88
    v_mfma_f32_16x16x32_bf16 v[184:187], v[248:251], a[220:223], v[184:187]
    v_add_f32 v153, v153, v89
    s_waitcnt vmcnt(11)
    v_mfma_f32_16x16x32_bf16 v[164:167], v[252:255], a[28:31], v[164:167]
    v_add_f32 v154, v154, v90
    v_mfma_f32_16x16x32_bf16 v[172:175], v[252:255], a[92:95], v[172:175]
    buffer_load_dwordx4 v[236:239], v10, s[40:43], s70 offen offset:3072 sc1
    v_add_f32 v155, v155, v91
    v_mfma_f32_16x16x32_bf16 v[180:183], v[252:255], a[156:159], v[180:183]
    v_add_f32 v156, v156, v92
    v_mfma_f32_16x16x32_bf16 v[188:191], v[252:255], a[220:223], v[188:191]
    v_add_f32 v157, v157, v93
    s_waitcnt vmcnt(11)
    v_mfma_f32_16x16x32_bf16 v[160:163], v[192:195], a[32:35], v[160:163]
    v_add_f32 v158, v158, v94
    v_mfma_f32_16x16x32_bf16 v[168:171], v[192:195], a[96:99], v[168:171]
    s_xor_b32 s70, s70, 4096
    buffer_load_dwordx4 v[240:243], v10, s[40:43], s70 offen offset:0 sc1
    v_add_f32 v159, v159, v95
    v_mfma_f32_16x16x32_bf16 v[176:179], v[192:195], a[160:163], v[176:179]
    v_add_f32 v136, v136, v152
    v_mfma_f32_16x16x32_bf16 v[184:187], v[192:195], a[224:227], v[184:187]
    v_add_f32 v137, v137, v153
    s_waitcnt vmcnt(11)
    v_mfma_f32_16x16x32_bf16 v[164:167], v[196:199], a[32:35], v[164:167]
    v_add_f32 v138, v138, v154
    v_mfma_f32_16x16x32_bf16 v[172:175], v[196:199], a[96:99], v[172:175]
    buffer_load_dwordx4 v[244:247], v10, s[40:43], s70 offen offset:1024 sc1
    v_add_f32 v139, v139, v155
    v_mfma_f32_16x16x32_bf16 v[180:183], v[196:199], a[160:163], v[180:183]
    v_add_f32 v140, v140, v156
    v_mfma_f32_16x16x32_bf16 v[188:191], v[196:199], a[224:227], v[188:191]
    v_add_f32 v141, v141, v157
    s_waitcnt vmcnt(11)
    v_mfma_f32_16x16x32_bf16 v[160:163], v[200:203], a[36:39], v[160:163]
    v_add_f32 v142, v142, v158
    v_mfma_f32_16x16x32_bf16 v[168:171], v[200:203], a[100:103], v[168:171]
    buffer_load_dwordx4 v[248:251], v10, s[40:43], s70 offen offset:2048 sc1
    v_add_f32 v143, v143, v159
    v_mfma_f32_16x16x32_bf16 v[176:179], v[200:203], a[164:167], v[176:179]
    v_mul_f32 v136, v136, v72
    v_mfma_f32_16x16x32_bf16 v[184:187], v[200:203], a[228:231], v[184:187]
    v_mul_f32 v137, v137, v73
    s_waitcnt vmcnt(11)
    v_mfma_f32_16x16x32_bf16 v[164:167], v[204:207], a[36:39], v[164:167]
    v_mul_f32 v138, v138, v74
    v_mfma_f32_16x16x32_bf16 v[172:175], v[204:207], a[100:103], v[172:175]
    buffer_load_dwordx4 v[252:255], v10, s[40:43], s70 offen offset:3072 sc1
    v_mul_f32 v139, v139, v75
    v_mfma_f32_16x16x32_bf16 v[180:183], v[204:207], a[164:167], v[180:183]
    v_mul_f32 v140, v140, v76
    v_mfma_f32_16x16x32_bf16 v[188:191], v[204:207], a[228:231], v[188:191]
    v_mul_f32 v141, v141, v77
    s_waitcnt vmcnt(11)
    v_mfma_f32_16x16x32_bf16 v[160:163], v[208:211], a[40:43], v[160:163]
    v_mul_f32 v142, v142, v78
    v_mfma_f32_16x16x32_bf16 v[168:171], v[208:211], a[104:107], v[168:171]
    v_mul_f32 v143, v143, v79
    buffer_load_dwordx4 v[104:107], v10, s[40:43], s17 offen offset:0 sc1
    v_mfma_f32_16x16x32_bf16 v[176:179], v[208:211], a[168:171], v[176:179]
    v_cvt_pk_bf16_f32 v128, v136, v137
    v_mfma_f32_16x16x32_bf16 v[184:187], v[208:211], a[232:235], v[184:187]
    v_cvt_pk_bf16_f32 v129, v138, v139
    s_waitcnt vmcnt(11)
    v_mfma_f32_16x16x32_bf16 v[164:167], v[212:215], a[40:43], v[164:167]
    v_cvt_pk_bf16_f32 v130, v140, v141
    v_mfma_f32_16x16x32_bf16 v[172:175], v[212:215], a[104:107], v[172:175]
    v_cvt_pk_bf16_f32 v131, v142, v143
    buffer_load_dwordx4 v[108:111], v10, s[40:43], s18 offen offset:0 sc1
    v_mfma_f32_16x16x32_bf16 v[180:183], v[212:215], a[168:171], v[180:183]
    buffer_store_dwordx4 v[128:131], v10, s[40:43], s67 offen offset:2048 sc1
    v_mfma_f32_16x16x32_bf16 v[188:191], v[212:215], a[232:235], v[188:191]
    s_waitcnt vmcnt(12)
    v_mfma_f32_16x16x32_bf16 v[160:163], v[216:219], a[44:47], v[160:163]
    v_mfma_f32_16x16x32_bf16 v[168:171], v[216:219], a[108:111], v[168:171]
    buffer_load_dwordx4 v[112:115], v10, s[40:43], s19 offen offset:0 sc1
    v_mfma_f32_16x16x32_bf16 v[176:179], v[216:219], a[172:175], v[176:179]
    v_mfma_f32_16x16x32_bf16 v[184:187], v[216:219], a[236:239], v[184:187]
    s_waitcnt vmcnt(12)
    v_mfma_f32_16x16x32_bf16 v[164:167], v[220:223], a[44:47], v[164:167]
    v_mfma_f32_16x16x32_bf16 v[172:175], v[220:223], a[108:111], v[172:175]
    buffer_load_dwordx4 v[116:119], v10, s[40:43], s20 offen offset:0 sc1
    v_mfma_f32_16x16x32_bf16 v[180:183], v[220:223], a[172:175], v[180:183]
    v_mfma_f32_16x16x32_bf16 v[188:191], v[220:223], a[236:239], v[188:191]
    s_waitcnt vmcnt(12)
    v_mfma_f32_16x16x32_bf16 v[160:163], v[224:227], a[48:51], v[160:163]
    v_mfma_f32_16x16x32_bf16 v[168:171], v[224:227], a[112:115], v[168:171]
    buffer_load_dwordx4 v[56:59], v10, s[40:43], s21 offen offset:0 sc1
    v_mfma_f32_16x16x32_bf16 v[176:179], v[224:227], a[176:179], v[176:179]
    v_mfma_f32_16x16x32_bf16 v[184:187], v[224:227], a[240:243], v[184:187]
    s_waitcnt vmcnt(12)
    v_mfma_f32_16x16x32_bf16 v[164:167], v[228:231], a[48:51], v[164:167]
    v_mfma_f32_16x16x32_bf16 v[172:175], v[228:231], a[112:115], v[172:175]
    buffer_load_dwordx4 v[60:63], v10, s[40:43], s22 offen offset:0 sc1
    v_mfma_f32_16x16x32_bf16 v[180:183], v[228:231], a[176:179], v[180:183]
    v_mfma_f32_16x16x32_bf16 v[188:191], v[228:231], a[240:243], v[188:191]
    s_waitcnt vmcnt(12)
    v_mfma_f32_16x16x32_bf16 v[160:163], v[232:235], a[52:55], v[160:163]
    v_mfma_f32_16x16x32_bf16 v[168:171], v[232:235], a[116:119], v[168:171]
    buffer_load_dwordx4 v[208:211], v10, s[40:43], s17 offen offset:1024 sc1
    v_mfma_f32_16x16x32_bf16 v[176:179], v[232:235], a[180:183], v[176:179]
    v_mfma_f32_16x16x32_bf16 v[184:187], v[232:235], a[244:247], v[184:187]
    s_waitcnt vmcnt(11)
    v_mfma_f32_16x16x32_bf16 v[160:163], v[240:243], a[56:59], v[160:163]
    v_mfma_f32_16x16x32_bf16 v[168:171], v[240:243], a[120:123], v[168:171]
    buffer_load_dwordx4 v[212:215], v10, s[40:43], s18 offen offset:1024 sc1
    v_mfma_f32_16x16x32_bf16 v[176:179], v[240:243], a[184:187], v[176:179]
    v_mfma_f32_16x16x32_bf16 v[184:187], v[240:243], a[248:251], v[184:187]
    s_waitcnt vmcnt(10)
    v_mfma_f32_16x16x32_bf16 v[160:163], v[248:251], a[60:63], v[160:163]
    v_mfma_f32_16x16x32_bf16 v[168:171], v[248:251], a[124:127], v[168:171]
    buffer_load_dwordx4 v[216:219], v10, s[40:43], s19 offen offset:1024 sc1
    v_mfma_f32_16x16x32_bf16 v[176:179], v[248:251], a[188:191], v[176:179]
    v_mfma_f32_16x16x32_bf16 v[184:187], v[248:251], a[252:255], v[184:187]
    v_mfma_f32_16x16x32_bf16 v[164:167], v[236:239], a[52:55], v[164:167]
    v_mfma_f32_16x16x32_bf16 v[172:175], v[236:239], a[116:119], v[172:175]
    buffer_load_dwordx4 v[220:223], v10, s[40:43], s20 offen offset:1024 sc1
    v_mfma_f32_16x16x32_bf16 v[180:183], v[236:239], a[180:183], v[180:183]
    v_mfma_f32_16x16x32_bf16 v[188:191], v[236:239], a[244:247], v[188:191]
    ds_write_b128 v2, v[168:171] offset:24576
    v_mfma_f32_16x16x32_bf16 v[164:167], v[244:247], a[56:59], v[164:167]
    v_mfma_f32_16x16x32_bf16 v[172:175], v[244:247], a[120:123], v[172:175]
    buffer_load_dwordx4 v[224:227], v10, s[40:43], s21 offen offset:1024 sc1
    ds_write_b128 v3, v[176:179] offset:24576
    v_mfma_f32_16x16x32_bf16 v[180:183], v[244:247], a[184:187], v[180:183]
    v_mfma_f32_16x16x32_bf16 v[188:191], v[244:247], a[248:251], v[188:191]
    ds_write_b128 v4, v[184:187] offset:24576
    s_waitcnt vmcnt(12)
    v_mfma_f32_16x16x32_bf16 v[164:167], v[252:255], a[60:63], v[164:167]
    v_mfma_f32_16x16x32_bf16 v[172:175], v[252:255], a[124:127], v[172:175]
    buffer_load_dwordx4 v[228:231], v10, s[40:43], s22 offen offset:1024 sc1
    v_mfma_f32_16x16x32_bf16 v[180:183], v[252:255], a[188:191], v[180:183]
    v_mfma_f32_16x16x32_bf16 v[188:191], v[252:255], a[252:255], v[188:191]
    s_nop 4
    ds_write_b128 v2, v[172:175] offset:25600
    s_nop 0
    ds_write_b128 v3, v[180:183] offset:25600
    ds_write_b128 v4, v[188:191] offset:25600
    s_waitcnt lgkmcnt(0)
    s_barrier
    ds_read_b128 v[136:139], v5 offset:24576
    ds_read_b128 v[140:143], v5 offset:25600
    ds_read_b128 v[144:147], v5 offset:26624
    ds_read_b128 v[148:151], v5 offset:27648
    ds_read_b128 v[152:155], v5 offset:28672
    ds_read_b128 v[156:159], v5 offset:29696
    s_mov_b32 s44, s32
    s_mov_b32 s45, s33
    s_mov_b32 s46, 1835008
    s_waitcnt lgkmcnt(2)
    v_pk_add_f32 v[136:137], v[136:137], v[144:145]
    v_pk_add_f32 v[138:139], v[138:139], v[146:147]
    v_pk_add_f32 v[140:141], v[140:141], v[148:149]
    v_pk_add_f32 v[142:143], v[142:143], v[150:151]
    s_waitcnt lgkmcnt(0)
    v_pk_add_f32 v[152:153], v[152:153], v[160:161]
    v_pk_add_f32 v[154:155], v[154:155], v[162:163]
    v_pk_add_f32 v[156:157], v[156:157], v[164:165]
    v_pk_add_f32 v[158:159], v[158:159], v[166:167]
    ds_read_b128 v[160:163], v6 offset:0
    ds_read_b128 v[164:167], v6 offset:1024
    ds_read_b128 v[168:171], v6 offset:2048
    ds_read_b128 v[172:175], v6 offset:3072
    v_pk_add_f32 v[136:137], v[136:137], v[152:153]
    v_pk_add_f32 v[138:139], v[138:139], v[154:155]
    v_pk_add_f32 v[140:141], v[140:141], v[156:157]
    v_pk_add_f32 v[142:143], v[142:143], v[158:159]
    v_pk_mul_f32 v[136:137], v[136:137], v[80:81]
    v_pk_mul_f32 v[138:139], v[138:139], v[82:83]
    v_pk_mul_f32 v[140:141], v[140:141], v[84:85]
    v_pk_mul_f32 v[142:143], v[142:143], v[86:87]
    v_cvt_pk_bf16_f32 v132, v136, v137
    v_cvt_pk_bf16_f32 v133, v138, v139
    v_cvt_pk_bf16_f32 v134, v140, v141
    v_cvt_pk_bf16_f32 v135, v142, v143
    buffer_store_dwordx4 v[132:135], v10, s[40:43], s26 offen sc1
    ds_read_b128 v[176:179], v6 offset:4096
    ds_read_b128 v[180:183], v6 offset:5120
    ds_read_b128 v[184:187], v6 offset:6144
    ds_read_b128 v[188:191], v6 offset:7168
    s_waitcnt lgkmcnt(4)
    v_mfma_f32_16x16x32_bf16 v[88:91], v[160:163], v[120:123], v[32:35]
    ds_read_b128 v[192:195], v6 offset:8192
    v_mfma_f32_16x16x32_bf16 v[92:95], v[164:167], v[120:123], v[36:39]
    ds_read_b128 v[196:199], v6 offset:9216
    buffer_load_dwordx4 v[232:235], v10, s[40:43], s17 offen offset:2048 sc1
    v_mfma_f32_16x16x32_bf16 v[96:99], v[168:171], v[120:123], v[40:43]
    ds_read_b128 v[200:203], v6 offset:10240
    v_mfma_f32_16x16x32_bf16 v[100:103], v[172:175], v[120:123], v[44:47]
    ds_read_b128 v[204:207], v6 offset:11264
    s_waitcnt lgkmcnt(4)
    v_mfma_f32_16x16x32_bf16 v[88:91], v[176:179], v[124:127], v[88:91]
    ds_read_b128 v[160:163], v6 offset:12288
    v_mfma_f32_16x16x32_bf16 v[92:95], v[180:183], v[124:127], v[92:95]
    ds_read_b128 v[164:167], v6 offset:13312
    buffer_load_dwordx4 v[236:239], v10, s[40:43], s18 offen offset:2048 sc1
    v_mfma_f32_16x16x32_bf16 v[96:99], v[184:187], v[124:127], v[96:99]
    ds_read_b128 v[168:171], v6 offset:14336
    v_mfma_f32_16x16x32_bf16 v[100:103], v[188:191], v[124:127], v[100:103]
    ds_read_b128 v[172:175], v6 offset:15360
    s_waitcnt lgkmcnt(4)
    v_mfma_f32_16x16x32_bf16 v[88:91], v[192:195], v[128:131], v[88:91]
    ds_read_b128 v[176:179], v6 offset:16384
    v_mfma_f32_16x16x32_bf16 v[92:95], v[196:199], v[128:131], v[92:95]
    ds_read_b128 v[180:183], v6 offset:17408
    buffer_load_dwordx4 v[240:243], v10, s[40:43], s19 offen offset:2048 sc1
    v_mfma_f32_16x16x32_bf16 v[96:99], v[200:203], v[128:131], v[96:99]
    ds_read_b128 v[184:187], v6 offset:18432
    v_mfma_f32_16x16x32_bf16 v[100:103], v[204:207], v[128:131], v[100:103]
    ds_read_b128 v[188:191], v6 offset:19456
    s_waitcnt lgkmcnt(4)
    v_mfma_f32_16x16x32_bf16 v[88:91], v[160:163], v[132:135], v[88:91]
    ds_read_b128 v[192:195], v6 offset:32768
    v_mfma_f32_16x16x32_bf16 v[92:95], v[164:167], v[132:135], v[92:95]
    ds_read_b128 v[196:199], v6 offset:33792
    buffer_load_dwordx4 v[244:247], v10, s[40:43], s20 offen offset:2048 sc1
    v_mfma_f32_16x16x32_bf16 v[96:99], v[168:171], v[132:135], v[96:99]
    ds_read_b128 v[200:203], v6 offset:34816
    v_mfma_f32_16x16x32_bf16 v[100:103], v[172:175], v[132:135], v[100:103]
    ds_read_b128 v[204:207], v6 offset:35840
    s_waitcnt vmcnt(14)
    v_max3_u32 v31, v105, v109, v113
    s_waitcnt vmcnt(11)
    v_max3_u32 v31, v117, v57, v31
    v_max_u32 v31, v61, v31
    v_cmp_le_u32 vcc, 0xffc00000, v31
    s_nop 0
    s_cbranch_vccnz L_G0_B
L_G0_OK:
    s_waitcnt lgkmcnt(4)
    v_mfma_f32_16x16x32_bf16 v[88:91], v[176:179], v[104:107], v[88:91]
    ds_read_b128 v[160:163], v6 offset:49152
    v_mfma_f32_16x16x32_bf16 v[92:95], v[180:183], v[104:107], v[92:95]
    ds_read_b128 v[164:167], v6 offset:50176
    buffer_load_dwordx4 v[248:251], v10, s[40:43], s21 offen offset:2048 sc1
    v_mfma_f32_16x16x32_bf16 v[96:99], v[184:187], v[104:107], v[96:99]
    ds_read_b128 v[168:171], v6 offset:51200
    v_mfma_f32_16x16x32_bf16 v[100:103], v[188:191], v[104:107], v[100:103]
    ds_read_b128 v[172:175], v6 offset:52224
    s_waitcnt lgkmcnt(4)
    v_mfma_f32_16x16x32_bf16 v[88:91], v[192:195], v[108:111], v[88:91]
    ds_read_b128 v[176:179], v7 offset:0
    v_mfma_f32_16x16x32_bf16 v[92:95], v[196:199], v[108:111], v[92:95]
    ds_read_b128 v[180:183], v7 offset:1024
    buffer_load_dwordx4 v[252:255], v10, s[40:43], s22 offen offset:2048 sc1
    v_mfma_f32_16x16x32_bf16 v[96:99], v[200:203], v[108:111], v[96:99]
    ds_read_b128 v[184:187], v7 offset:2048
    v_mfma_f32_16x16x32_bf16 v[100:103], v[204:207], v[108:111], v[100:103]
    ds_read_b128 v[188:191], v7 offset:3072
    s_waitcnt lgkmcnt(4)
    v_mfma_f32_16x16x32_bf16 v[88:91], v[160:163], v[112:115], v[88:91]
    ds_read_b128 v[192:195], v7 offset:16384
    v_mfma_f32_16x16x32_bf16 v[92:95], v[164:167], v[112:115], v[92:95]
    ds_read_b128 v[196:199], v7 offset:17408
    v_mfma_f32_16x16x32_bf16 v[96:99], v[168:171], v[112:115], v[96:99]
    ds_read_b128 v[200:203], v7 offset:18432
    v_mfma_f32_16x16x32_bf16 v[100:103], v[172:175], v[112:115], v[100:103]
    ds_read_b128 v[204:207], v7 offset:19456
    s_waitcnt lgkmcnt(4)
    v_mfma_f32_16x16x32_bf16 v[88:91], v[176:179], v[116:119], v[88:91]
    ds_read_b128 v[160:163], v7 offset:32768
    v_mfma_f32_16x16x32_bf16 v[92:95], v[180:183], v[116:119], v[92:95]
    ds_read_b128 v[164:167], v7 offset:33792
    v_mfma_f32_16x16x32_bf16 v[96:99], v[184:187], v[116:119], v[96:99]
    ds_read_b128 v[168:171], v7 offset:34816
    v_mfma_f32_16x16x32_bf16 v[100:103], v[188:191], v[116:119], v[100:103]
    ds_read_b128 v[172:175], v7 offset:35840
    s_waitcnt lgkmcnt(4)
    v_mfma_f32_16x16x32_bf16 v[88:91], v[192:195], v[56:59], v[88:91]
    ds_read_b128 v[176:179], v6 offset:20480
    v_mfma_f32_16x16x32_bf16 v[92:95], v[196:199], v[56:59], v[92:95]
    ds_read_b128 v[180:183], v6 offset:21504
    v_mfma_f32_16x16x32_bf16 v[96:99], v[200:203], v[56:59], v[96:99]
    ds_read_b128 v[184:187], v6 offset:22528
    v_mfma_f32_16x16x32_bf16 v[100:103], v[204:207], v[56:59], v[100:103]
    ds_read_b128 v[188:191], v6 offset:23552
    s_waitcnt lgkmcnt(4)
    v_mfma_f32_16x16x32_bf16 v[88:91], v[160:163], v[60:63], v[88:91]
    ds_read_b128 v[192:195], v6 offset:36864
    v_mfma_f32_16x16x32_bf16 v[92:95], v[164:167], v[60:63], v[92:95]
    ds_read_b128 v[196:199], v6 offset:37888
    v_mfma_f32_16x16x32_bf16 v[96:99], v[168:171], v[60:63], v[96:99]
    ds_read_b128 v[200:203], v6 offset:38912
    v_mfma_f32_16x16x32_bf16 v[100:103], v[172:175], v[60:63], v[100:103]
    ds_read_b128 v[204:207], v6 offset:39936
    s_waitcnt vmcnt(10)
    v_max3_u32 v31, v209, v213, v217
    s_waitcnt vmcnt(7)
    v_max3_u32 v31, v221, v225, v31
    v_max_u32 v31, v229, v31
    v_cmp_le_u32 vcc, 0xffc00000, v31
    s_nop 0
    s_cbranch_vccnz L_G1_B
L_G1_OK:
    s_waitcnt lgkmcnt(4)
    v_mfma_f32_16x16x32_bf16 v[88:91], v[176:179], v[208:211], v[88:91]
    ds_read_b128 v[160:163], v6 offset:53248
    v_mfma_f32_16x16x32_bf16 v[92:95], v[180:183], v[208:211], v[92:95]
    ds_read_b128 v[164:167], v6 offset:54272
    v_mfma_f32_16x16x32_bf16 v[96:99], v[184:187], v[208:211], v[96:99]
    ds_read_b128 v[168:171], v6 offset:55296
    v_mfma_f32_16x16x32_bf16 v[100:103], v[188:191], v[208:211], v[100:103]
    ds_read_b128 v[172:175], v6 offset:56320
    s_waitcnt lgkmcnt(4)
    v_mfma_f32_16x16x32_bf16 v[88:91], v[192:195], v[212:215], v[88:91]
    ds_read_b128 v[176:179], v7 offset:4096
    v_mfma_f32_16x16x32_bf16 v[92:95], v[196:199], v[212:215], v[92:95]
    ds_read_b128 v[180:183], v7 offset:5120
    v_mfma_f32_16x16x32_bf16 v[96:99], v[200:203], v[212:215], v[96:99]
    ds_read_b128 v[184:187], v7 offset:6144
    v_mfma_f32_16x16x32_bf16 v[100:103], v[204:207], v[212:215], v[100:103]
    ds_read_b128 v[188:191], v7 offset:7168
    s_waitcnt lgkmcnt(4)
    v_mfma_f32_16x16x32_bf16 v[88:91], v[160:163], v[216:219], v[88:91]
    ds_read_b128 v[192:195], v7 offset:20480
    v_mfma_f32_16x16x32_bf16 v[92:95], v[164:167], v[216:219], v[92:95]
    ds_read_b128 v[196:199], v7 offset:21504
    v_mfma_f32_16x16x32_bf16 v[96:99], v[168:171], v[216:219], v[96:99]
    ds_read_b128 v[200:203], v7 offset:22528
    v_mfma_f32_16x16x32_bf16 v[100:103], v[172:175], v[216:219], v[100:103]
    ds_read_b128 v[204:207], v7 offset:23552
    s_waitcnt lgkmcnt(4)
    v_mfma_f32_16x16x32_bf16 v[88:91], v[176:179], v[220:223], v[88:91]
    ds_read_b128 v[160:163], v7 offset:36864
    v_mfma_f32_16x16x32_bf16 v[92:95], v[180:183], v[220:223], v[92:95]
    ds_read_b128 v[164:167], v7 offset:37888
    v_mfma_f32_16x16x32_bf16 v[96:99], v[184:187], v[220:223], v[96:99]
    ds_read_b128 v[168:171], v7 offset:38912
    v_mfma_f32_16x16x32_bf16 v[100:103], v[188:191], v[220:223], v[100:103]
    ds_read_b128 v[172:175], v7 offset:39936
    s_waitcnt lgkmcnt(4)
    v_mfma_f32_16x16x32_bf16 v[88:91], v[192:195], v[224:227], v[88:91]
    ds_read_b128 v[176:179], v6 offset:24576
    v_mfma_f32_16x16x32_bf16 v[92:95], v[196:199], v[224:227], v[92:95]
    ds_read_b128 v[180:183], v6 offset:25600
    v_mfma_f32_16x16x32_bf16 v[96:99], v[200:203], v[224:227], v[96:99]
    ds_read_b128 v[184:187], v6 offset:26624
    v_mfma_f32_16x16x32_bf16 v[100:103], v[204:207], v[224:227], v[100:103]
    ds_read_b128 v[188:191], v6 offset:27648
    s_waitcnt lgkmcnt(4)
    v_mfma_f32_16x16x32_bf16 v[88:91], v[160:163], v[228:231], v[88:91]
    ds_read_b128 v[192:195], v6 offset:40960
    v_mfma_f32_16x16x32_bf16 v[92:95], v[164:167], v[228:231], v[92:95]
    ds_read_b128 v[196:199], v6 offset:41984
    v_mfma_f32_16x16x32_bf16 v[96:99], v[168:171], v[228:231], v[96:99]
    ds_read_b128 v[200:203], v6 offset:43008
    v_mfma_f32_16x16x32_bf16 v[100:103], v[172:175], v[228:231], v[100:103]
    ds_read_b128 v[204:207], v6 offset:44032
    s_waitcnt vmcnt(3)
    v_max3_u32 v31, v233, v237, v241
    s_waitcnt vmcnt(0)
    v_max3_u32 v31, v245, v249, v31
    v_max_u32 v31, v253, v31
    v_cmp_le_u32 vcc, 0xffc00000, v31
    s_nop 0
    s_cbranch_vccnz L_G2_B
L_G2_OK:
    s_waitcnt lgkmcnt(4)
    v_mfma_f32_16x16x32_bf16 v[88:91], v[176:179], v[232:235], v[88:91]
    ds_read_b128 v[160:163], v6 offset:57344
    v_mfma_f32_16x16x32_bf16 v[92:95], v[180:183], v[232:235], v[92:95]
    ds_read_b128 v[164:167], v6 offset:58368
    buffer_load_dwordx4 v[136:139], v10, s[40:43], s27 offen sc1
    buffer_load_dwordx4 v[140:143], v10, s[40:43], s34 offen sc1
    buffer_load_dwordx4 v[144:147], v10, s[40:43], s35 offen sc1
    buffer_load_dwordx4 v[148:151], v10, s[40:43], s36 offen sc1
    buffer_load_dwordx4 v[152:155], v10, s[40:43], s37 offen sc1
    buffer_load_dwordx4 v[156:159], v10, s[40:43], s5 offen sc1
    v_mfma_f32_16x16x32_bf16 v[96:99], v[184:187], v[232:235], v[96:99]
    ds_read_b128 v[168:171], v6 offset:59392
    v_mfma_f32_16x16x32_bf16 v[100:103], v[188:191], v[232:235], v[100:103]
    ds_read_b128 v[172:175], v6 offset:60416
    s_waitcnt lgkmcnt(4)
    v_mfma_f32_16x16x32_bf16 v[88:91], v[192:195], v[236:239], v[88:91]
    ds_read_b128 v[176:179], v7 offset:8192
    v_mfma_f32_16x16x32_bf16 v[92:95], v[196:199], v[236:239], v[92:95]
    ds_read_b128 v[180:183], v7 offset:9216
    v_mfma_f32_16x16x32_bf16 v[96:99], v[200:203], v[236:239], v[96:99]
    ds_read_b128 v[184:187], v7 offset:10240
    v_mfma_f32_16x16x32_bf16 v[100:103], v[204:207], v[236:239], v[100:103]
    ds_read_b128 v[188:191], v7 offset:11264
    s_waitcnt lgkmcnt(4)
    v_mfma_f32_16x16x32_bf16 v[88:91], v[160:163], v[240:243], v[88:91]
    ds_read_b128 v[192:195], v7 offset:24576
    v_mfma_f32_16x16x32_bf16 v[92:95], v[164:167], v[240:243], v[92:95]
    ds_read_b128 v[196:199], v7 offset:25600
    v_mfma_f32_16x16x32_bf16 v[96:99], v[168:171], v[240:243], v[96:99]
    ds_read_b128 v[200:203], v7 offset:26624
    v_mfma_f32_16x16x32_bf16 v[100:103], v[172:175], v[240:243], v[100:103]
    ds_read_b128 v[204:207], v7 offset:27648
    s_waitcnt lgkmcnt(4)
    v_mfma_f32_16x16x32_bf16 v[88:91], v[176:179], v[244:247], v[88:91]
    ds_read_b128 v[160:163], v7 offset:40960
    v_mfma_f32_16x16x32_bf16 v[92:95], v[180:183], v[244:247], v[92:95]
    ds_read_b128 v[164:167], v7 offset:41984
    v_mfma_f32_16x16x32_bf16 v[96:99], v[184:187], v[244:247], v[96:99]
    ds_read_b128 v[168:171], v7 offset:43008
    v_mfma_f32_16x16x32_bf16 v[100:103], v[188:191], v[244:247], v[100:103]
    ds_read_b128 v[172:175], v7 offset:44032
    s_waitcnt lgkmcnt(4)
    v_mfma_f32_16x16x32_bf16 v[88:91], v[192:195], v[248:251], v[88:91]
    ds_read_b128 v[176:179], v6 offset:28672
    v_mfma_f32_16x16x32_bf16 v[92:95], v[196:199], v[248:251], v[92:95]
    ds_read_b128 v[180:183], v6 offset:29696
    v_mfma_f32_16x16x32_bf16 v[96:99], v[200:203], v[248:251], v[96:99]
    ds_read_b128 v[184:187], v6 offset:30720
    v_mfma_f32_16x16x32_bf16 v[100:103], v[204:207], v[248:251], v[100:103]
    ds_read_b128 v[188:191], v6 offset:31744
    s_waitcnt lgkmcnt(4)
    v_mfma_f32_16x16x32_bf16 v[88:91], v[160:163], v[252:255], v[88:91]
    ds_read_b128 v[192:195], v6 offset:45056
    v_mfma_f32_16x16x32_bf16 v[92:95], v[164:167], v[252:255], v[92:95]
    ds_read_b128 v[196:199], v6 offset:46080
    v_mfma_f32_16x16x32_bf16 v[96:99], v[168:171], v[252:255], v[96:99]
    ds_read_b128 v[200:203], v6 offset:47104
    v_mfma_f32_16x16x32_bf16 v[100:103], v[172:175], v[252:255], v[100:103]
    ds_read_b128 v[204:207], v6 offset:48128
    s_waitcnt vmcnt(3)
    v_max3_u32 v31, v137, v141, v145
    s_waitcnt vmcnt(0)
    v_max3_u32 v31, v149, v153, v31
    v_max_u32_e64 v31, v157, v31
    v_cmp_le_u32 vcc, 0xffc00000, v31
    s_nop 0
    s_cbranch_vccnz L_G3_B
L_G3_OK:
    s_waitcnt lgkmcnt(4)
    v_mfma_f32_16x16x32_bf16 v[88:91], v[176:179], v[136:139], v[88:91]
    ds_read_b128 v[160:163], v6 offset:61440
    v_mfma_f32_16x16x32_bf16 v[92:95], v[180:183], v[136:139], v[92:95]
    ds_read_b128 v[164:167], v6 offset:62464
    v_mfma_f32_16x16x32_bf16 v[96:99], v[184:187], v[136:139], v[96:99]
    ds_read_b128 v[168:171], v6 offset:63488
    v_mfma_f32_16x16x32_bf16 v[100:103], v[188:191], v[136:139], v[100:103]
    ds_read_b128 v[172:175], v6 offset:64512
    s_waitcnt lgkmcnt(4)
    v_mfma_f32_16x16x32_bf16 v[88:91], v[192:195], v[140:143], v[88:91]
    ds_read_b128 v[176:179], v7 offset:12288
    v_mfma_f32_16x16x32_bf16 v[92:95], v[196:199], v[140:143], v[92:95]
    ds_read_b128 v[180:183], v7 offset:13312
    v_mfma_f32_16x16x32_bf16 v[96:99], v[200:203], v[140:143], v[96:99]
    ds_read_b128 v[184:187], v7 offset:14336
    v_mfma_f32_16x16x32_bf16 v[100:103], v[204:207], v[140:143], v[100:103]
    ds_read_b128 v[188:191], v7 offset:15360
    s_waitcnt lgkmcnt(4)
    v_mfma_f32_16x16x32_bf16 v[88:91], v[160:163], v[144:147], v[88:91]
    ds_read_b128 v[192:195], v7 offset:28672
    v_mfma_f32_16x16x32_bf16 v[92:95], v[164:167], v[144:147], v[92:95]
    ds_read_b128 v[196:199], v7 offset:29696
    v_mfma_f32_16x16x32_bf16 v[96:99], v[168:171], v[144:147], v[96:99]
    ds_read_b128 v[200:203], v7 offset:30720
    v_mfma_f32_16x16x32_bf16 v[100:103], v[172:175], v[144:147], v[100:103]
    ds_read_b128 v[204:207], v7 offset:31744
    s_waitcnt lgkmcnt(4)
    v_mfma_f32_16x16x32_bf16 v[88:91], v[176:179], v[148:151], v[88:91]
    ds_read_b128 v[160:163], v7 offset:45056
    v_mfma_f32_16x16x32_bf16 v[92:95], v[180:183], v[148:151], v[92:95]
    ds_read_b128 v[164:167], v7 offset:46080
    v_mfma_f32_16x16x32_bf16 v[96:99], v[184:187], v[148:151], v[96:99]
    ds_read_b128 v[168:171], v7 offset:47104
    v_mfma_f32_16x16x32_bf16 v[100:103], v[188:191], v[148:151], v[100:103]
    ds_read_b128 v[172:175], v7 offset:48128
    s_waitcnt lgkmcnt(4)
    v_mfma_f32_16x16x32_bf16 v[88:91], v[192:195], v[152:155], v[88:91]
    v_mfma_f32_16x16x32_bf16 v[92:95], v[196:199], v[152:155], v[92:95]
    v_mfma_f32_16x16x32_bf16 v[96:99], v[200:203], v[152:155], v[96:99]
    v_mfma_f32_16x16x32_bf16 v[100:103], v[204:207], v[152:155], v[100:103]
    s_waitcnt lgkmcnt(0)
    v_mfma_f32_16x16x32_bf16 v[88:91], v[160:163], v[156:159], v[88:91]
    v_mfma_f32_16x16x32_bf16 v[92:95], v[164:167], v[156:159], v[92:95]
    v_mfma_f32_16x16x32_bf16 v[96:99], v[168:171], v[156:159], v[96:99]
    v_mfma_f32_16x16x32_bf16 v[100:103], v[172:175], v[156:159], v[100:103]
    s_nop 4
    v_cvt_pk_bf16_f32 v32, v88, v89
    v_cvt_pk_bf16_f32 v33, v90, v91
    v_cvt_pk_bf16_f32 v34, v92, v93
    v_cvt_pk_bf16_f32 v35, v94, v95
    v_cvt_pk_bf16_f32 v36, v96, v97
    v_cvt_pk_bf16_f32 v37, v98, v99
    v_cvt_pk_bf16_f32 v38, v100, v101
    v_cvt_pk_bf16_f32 v39, v102, v103
    buffer_store_dwordx4 v[32:35], v8, s[44:47], 0 offen offset:0
    buffer_store_dwordx4 v[36:39], v8, s[44:47], 0 offen offset:64
L_FIN:
L_END:
    s_endpgm
L_XS2:
    s_waitcnt vmcnt(5)
    ds_read_b32 v240, v22 offset:0
    ds_read_b32 v242, v22 offset:4
    ds_read_b32 v244, v22 offset:8
    ds_read_b32 v246, v22 offset:12
    ds_read_b32 v248, v23 offset:0
    ds_read_b32 v250, v23 offset:4
    ds_read_b32 v252, v23 offset:8
    ds_read_b32 v254, v23 offset:12
    v_readfirstlane_b32 s52, v20
    s_nop 0
    s_add_u32 s52, s52, 1
    s_or_b32 s52, s52, 0xffc00000
    v_mov_b32 v241, s52
    v_mov_b32 v243, s52
    v_mov_b32 v245, s52
    v_mov_b32 v247, s52
    v_mov_b32 v249, s52
    v_mov_b32 v251, s52
    v_mov_b32 v253, s52
    v_mov_b32 v255, s52
    s_waitcnt lgkmcnt(4)
    buffer_store_dwordx2 v[240:241], v21, s[40:43], s70 offen sc1
    s_add_u32 s70, s70, 16384
    buffer_store_dwordx2 v[242:243], v21, s[40:43], s70 offen sc1
    s_add_u32 s70, s70, 16384
    buffer_store_dwordx2 v[244:245], v21, s[40:43], s70 offen sc1
    s_add_u32 s70, s70, 16384
    buffer_store_dwordx2 v[246:247], v21, s[40:43], s70 offen sc1
    s_add_u32 s70, s70, 16384
    s_add_u32 s70, s70, 196608
    s_waitcnt lgkmcnt(0)
    buffer_store_dwordx2 v[248:249], v21, s[40:43], s70 offen sc1
    s_add_u32 s70, s70, 16384
    buffer_store_dwordx2 v[250:251], v21, s[40:43], s70 offen sc1
    s_add_u32 s70, s70, 16384
    buffer_store_dwordx2 v[252:253], v21, s[40:43], s70 offen sc1
    s_add_u32 s70, s70, 16384
    buffer_store_dwordx2 v[254:255], v21, s[40:43], s70 offen sc1
    s_waitcnt vmcnt(11)
    v_dot2_f32_bf16 v176, v2, s58, 0
    v_dot2_f32_bf16 v177, v2, v2, 0
    v_dot2_f32_bf16 v178, v6, s58, 0
    v_dot2_f32_bf16 v179, v6, v6, 0
    v_dot2_f32_bf16 v176, v3, s58, v176
    v_dot2_f32_bf16 v177, v3, v3, v177
    v_dot2_f32_bf16 v178, v7, s58, v178
    v_dot2_f32_bf16 v179, v7, v7, v179
    v_dot2_f32_bf16 v176, v4, s58, v176
    v_dot2_f32_bf16 v177, v4, v4, v177
    v_dot2_f32_bf16 v178, v8, s58, v178
    v_dot2_f32_bf16 v179, v8, v8, v179
    v_dot2_f32_bf16 v176, v5, s58, v176
    v_dot2_f32_bf16 v177, v5, v5, v177
    v_dot2_f32_bf16 v178, v9, s58, v178
    v_dot2_f32_bf16 v179, v9, v9, v179
    s_nop 1
    v_permlane32_swap_b32 v176, v178
    v_permlane32_swap_b32 v177, v179
    v_add_f32_e64 v176, v176, v178
    v_add_f32 v177, v177, v179
    s_nop 0
    v_add_f32_dpp v176, v176, v176 row_shr:1 row_mask:0xf bank_mask:0xf bound_ctrl:0
    v_add_f32_dpp v177, v177, v177 row_shr:1 row_mask:0xf bank_mask:0xf bound_ctrl:0
    s_nop 0
    v_add_f32_dpp v176, v176, v176 row_shr:2 row_mask:0xf bank_mask:0xf bound_ctrl:0
    v_add_f32_dpp v177, v177, v177 row_shr:2 row_mask:0xf bank_mask:0xf bound_ctrl:0
    s_nop 0
    v_add_f32_dpp v176, v176, v176 row_shr:4 row_mask:0xf bank_mask:0xf bound_ctrl:0
    v_add_f32_dpp v177, v177, v177 row_shr:4 row_mask:0xf bank_mask:0xf bound_ctrl:0
    s_nop 0
    v_add_f32_dpp v176, v176, v176 row_shr:8 row_mask:0xf bank_mask:0xf bound_ctrl:0
    v_add_f32_dpp v177, v177, v177 row_shr:8 row_mask:0xf bank_mask:0xf bound_ctrl:0
    s_nop 0
    v_add_f32_dpp v176, v176, v176 row_bcast:15 row_mask:0xa bank_mask:0xf
    v_add_f32_dpp v177, v177, v177 row_bcast:15 row_mask:0xa bank_mask:0xf
    v_mul_f32 v176, 0x3b124925, v176
    v_mul_f32 v177, 0x3b124925, v177
    v_fma_f32 v177, -v176, v176, v177
    v_max_f32 v177, 0, v177
    v_cvt_pk_bf16_f32 v177, v177, v177
    v_and_b32 v177, 0xffff0000, v177
    v_add_f32 v177, 0x3727c5ac, v177
    v_cvt_pk_bf16_f32 v177, v177, v177
    v_and_b32 v177, 0xffff0000, v177
    v_sqrt_f32 v177, v177
    v_lshrrev_b32 v20, 5, v0
    v_lshlrev_b32 v20, 3, v20
    v_cvt_pk_bf16_f32 v178, v176, v177
    v_mov_b32 v179, s52
    s_mov_b32 exec_lo, 0x80000000
    s_mov_b32 exec_hi, 0x80000000
    buffer_store_dwordx2 v[178:179], v20, s[40:43], s65 offen sc1
    s_mov_b64 exec, -1
    s_branch L_XS2R
L_HBAD:
    v_min_u32 v31, 55, v1
    v_sub_u32 v31, v31, v1
    v_cmp_eq_u32 vcc, 0, v31
    v_readfirstlane_b32 s59, v19
    s_nop 1
    v_mov_b32 v31, s59
    v_cndmask_b32 v31, v31, v19, vcc
    v_add_u32 v88, 1015808, v31
    s_lshr_b32 s59, s48, 7
    s_add_u32 s59, s59, s54
    v_lshrrev_b32 v31, 4, v1
    v_add_lshl_u32 v143, v31, s59, 8
    v_and_b32_e64 v142, 15, v1
    v_lshlrev_b32_e64 v142, 4, v142
    v_lshl_or_b32 v31, v31, 14, v142
    s_movk_i32 s59, 0x1f00
    v_lshlrev_b32 v142, 8, v1
    v_and_b32 v142, 0x3000, v142
    v_add_u32_e64 v143, v143, v142
    v_and_b32 v142, 0x2000, v142
    v_or_b32_e64 v31, v31, v142
    v_and_or_b32 v136, v143, s59, v31
    v_add_u32 v143, 1024, v143
    v_and_or_b32 v137, v143, s59, v31
    v_add_u32 v143, 1024, v143
    v_and_or_b32 v138, v143, s59, v31
    v_add_u32 v143, 1024, v143
    v_and_or_b32 v139, v143, s59, v31
    v_add_u32 v143, 1024, v143
    v_and_or_b32 v140, v143, s59, v31
    v_add_u32 v143, 1024, v143
    v_and_or_b32 v141, v143, s59, v31
    v_add_u32 v143, 1024, v143
    v_and_or_b32 v142, v143, s59, v31
    v_add_u32 v143, 1024, v143
    v_and_or_b32 v143, v143, s59, v31
    s_mov_b32 s59, 0
L_PH2:
    buffer_load_dword v31, v88, s[40:43], 0 offen sc1
    s_add_u32 s59, s59, 1
    s_waitcnt vmcnt(0)
    v_cmpx_ne_u32_e64 vcc, s52, v31
    s_cmp_gt_u32 s59, 65536
    s_cbranch_scc1 L_PH2_y
    s_cbranch_vccnz L_PH2
L_PH2_y:
    s_mov_b64 exec, -1
L_PH2_x:
    s_mov_b32 m0, s64
    s_mov_b32 s59, s6
    buffer_load_dwordx4 v136, s[40:43], s59 offen offset:0 sc1 lds
    s_add_u32 s59, s59, 64512
    buffer_load_dwordx4 v137, s[40:43], s59 offen offset:1024 sc1 lds
    s_add_u32 s59, s59, 64512
    buffer_load_dwordx4 v138, s[40:43], s59 offen offset:2048 sc1 lds
    s_add_u32 s59, s59, 64512
    buffer_load_dwordx4 v139, s[40:43], s59 offen offset:3072 sc1 lds
    s_add_u32 s59, s59, 68608
    s_add_u32 m0, m0, 4096
    s_nop 0
    buffer_load_dwordx4 v140, s[40:43], s59 offen offset:0 sc1 lds
    s_add_u32 s59, s59, 64512
    buffer_load_dwordx4 v141, s[40:43], s59 offen offset:1024 sc1 lds
    s_add_u32 s59, s59, 64512
    buffer_load_dwordx4 v142, s[40:43], s59 offen offset:2048 sc1 lds
    s_add_u32 s59, s59, 64512
    buffer_load_dwordx4 v143, s[40:43], s59 offen offset:3072 sc1 lds
    s_add_u32 s59, s59, 68608
    s_add_u32 m0, m0, 4096
    s_nop 0
    buffer_load_dwordx4 v136, s[40:43], s59 offen offset:0 sc1 lds
    s_add_u32 s59, s59, 64512
    buffer_load_dwordx4 v137, s[40:43], s59 offen offset:1024 sc1 lds
    s_add_u32 s59, s59, 64512
    buffer_load_dwordx4 v138, s[40:43], s59 offen offset:2048 sc1 lds
    s_add_u32 s59, s59, 64512
    buffer_load_dwordx4 v139, s[40:43], s59 offen offset:3072 sc1 lds
    s_add_u32 s59, s59, 68608
    s_add_u32 m0, m0, 4096
    s_nop 0
    buffer_load_dwordx4 v140, s[40:43], s59 offen offset:0 sc1 lds
    s_add_u32 s59, s59, 64512
    buffer_load_dwordx4 v141, s[40:43], s59 offen offset:1024 sc1 lds
    s_waitcnt vmcnt(0)
    ds_read_b64_tr_b16 v[88:89], v2 offset:0
    ds_read_b64_tr_b16 v[90:91], v2 offset:512
    ds_read_b64_tr_b16 v[92:93], v3 offset:0
    ds_read_b64_tr_b16 v[94:95], v3 offset:512
    ds_read_b64_tr_b16 v[96:97], v2 offset:2048
    ds_read_b64_tr_b16 v[98:99], v2 offset:2560
    ds_read_b64_tr_b16 v[100:101], v3 offset:2048
    ds_read_b64_tr_b16 v[102:103], v3 offset:2560
    ds_read_b64_tr_b16 v[104:105], v2 offset:4096
    ds_read_b64_tr_b16 v[106:107], v2 offset:4608
    ds_read_b64_tr_b16 v[108:109], v3 offset:4096
    ds_read_b64_tr_b16 v[110:111], v3 offset:4608
    ds_read_b64_tr_b16 v[112:113], v2 offset:6144
    ds_read_b64_tr_b16 v[114:115], v2 offset:6656
    ds_read_b64_tr_b16 v[116:117], v3 offset:6144
    ds_read_b64_tr_b16 v[118:119], v3 offset:6656
    ds_read_b64_tr_b16 v[120:121], v2 offset:8192
    ds_read_b64_tr_b16 v[122:123], v2 offset:8704
    ds_read_b64_tr_b16 v[124:125], v3 offset:8192
    ds_read_b64_tr_b16 v[126:127], v3 offset:8704
    ds_read_b64_tr_b16 v[128:129], v2 offset:10240
    ds_read_b64_tr_b16 v[130:131], v2 offset:10752
    ds_read_b64_tr_b16 v[132:133], v3 offset:10240
    ds_read_b64_tr_b16 v[134:135], v3 offset:10752
    ds_read_b64_tr_b16 v[136:137], v2 offset:12288
    ds_read_b64_tr_b16 v[138:139], v2 offset:12800
    ds_read_b64_tr_b16 v[140:141], v3 offset:12288
    ds_read_b64_tr_b16 v[142:143], v3 offset:12800
    s_waitcnt lgkmcnt(15)
    v_dot2_f32_bf16 v20, v88, s58, 0
    v_dot2_f32_bf16 v21, v88, v88, 0
    v_dot2_f32_bf16 v22, v92, s58, 0
    v_dot2_f32_bf16 v23, v92, v92, 0
    v_dot2_f32_bf16 v20, v89, s58, v20
    v_dot2_f32_bf16 v21, v89, v89, v21
    s_nop 0
    v_dot2_f32_bf16 v22, v93, s58, v22
    v_dot2_f32_bf16 v23, v93, v93, v23
    v_dot2_f32_bf16 v20, v90, s58, v20
    v_dot2_f32_bf16 v21, v90, v90, v21
    v_dot2_f32_bf16 v22, v94, s58, v22
    v_dot2_f32_bf16 v23, v94, v94, v23
    v_dot2_f32_bf16 v20, v91, s58, v20
    v_dot2_f32_bf16 v21, v91, v91, v21
    v_dot2_f32_bf16 v22, v95, s58, v22
    v_dot2_f32_bf16 v23, v95, v95, v23
    v_dot2_f32_bf16 v20, v96, s58, v20
    v_dot2_f32_bf16 v21, v96, v96, v21
    v_dot2_f32_bf16 v22, v100, s58, v22
    v_dot2_f32_bf16 v23, v100, v100, v23
    v_dot2_f32_bf16 v20, v97, s58, v20
    v_dot2_f32_bf16 v21, v97, v97, v21
    v_dot2_f32_bf16 v22, v101, s58, v22
    v_dot2_f32_bf16 v23, v101, v101, v23
    v_dot2_f32_bf16 v20, v98, s58, v20
    v_dot2_f32_bf16 v21, v98, v98, v21
    v_dot2_f32_bf16 v22, v102, s58, v22
    v_dot2_f32_bf16 v23, v102, v102, v23
    v_dot2_f32_bf16 v20, v99, s58, v20
    v_dot2_f32_bf16 v21, v99, v99, v21
    v_dot2_f32_bf16 v22, v103, s58, v22
    v_dot2_f32_bf16 v23, v103, v103, v23
    v_dot2_f32_bf16 v20, v104, s58, v20
    v_dot2_f32_bf16 v21, v104, v104, v21
    v_dot2_f32_bf16 v22, v108, s58, v22
    v_dot2_f32_bf16 v23, v108, v108, v23
    v_dot2_f32_bf16 v20, v105, s58, v20
    v_dot2_f32_bf16 v21, v105, v105, v21
    v_dot2_f32_bf16 v22, v109, s58, v22
    v_dot2_f32_bf16 v23, v109, v109, v23
    v_dot2_f32_bf16 v20, v106, s58, v20
    v_dot2_f32_bf16 v21, v106, v106, v21
    v_dot2_f32_bf16 v22, v110, s58, v22
    v_dot2_f32_bf16 v23, v110, v110, v23
    v_dot2_f32_bf16 v20, v107, s58, v20
    v_dot2_f32_bf16 v21, v107, v107, v21
    v_dot2_f32_bf16 v22, v111, s58, v22
    v_dot2_f32_bf16 v23, v111, v111, v23
    s_waitcnt lgkmcnt(12)
    v_dot2_f32_bf16 v20, v112, s58, v20
    v_dot2_f32_bf16 v21, v112, v112, v21
    v_dot2_f32_bf16 v22, v116, s58, v22
    v_dot2_f32_bf16 v23, v116, v116, v23
    v_dot2_f32_bf16 v20, v113, s58, v20
    s_nop 0
    v_dot2_f32_bf16 v21, v113, v113, v21
    v_dot2_f32_bf16 v22, v117, s58, v22
    v_dot2_f32_bf16 v23, v117, v117, v23
    v_dot2_f32_bf16 v20, v114, s58, v20
    v_dot2_f32_bf16 v21, v114, v114, v21
    v_dot2_f32_bf16 v22, v118, s58, v22
    v_dot2_f32_bf16 v23, v118, v118, v23
    v_dot2_f32_bf16 v20, v115, s58, v20
    s_nop 0
    v_dot2_f32_bf16 v21, v115, v115, v21
    v_dot2_f32_bf16 v22, v119, s58, v22
    v_dot2_f32_bf16 v23, v119, v119, v23
    s_waitcnt lgkmcnt(8)
    v_dot2_f32_bf16 v20, v120, s58, v20
    v_dot2_f32_bf16 v21, v120, v120, v21
    v_dot2_f32_bf16 v22, v124, s58, v22
    v_dot2_f32_bf16 v23, v124, v124, v23
    v_dot2_f32_bf16 v20, v121, s58, v20
    v_dot2_f32_bf16 v21, v121, v121, v21
    v_dot2_f32_bf16 v22, v125, s58, v22
    v_dot2_f32_bf16 v23, v125, v125, v23
    v_dot2_f32_bf16 v20, v122, s58, v20
    v_dot2_f32_bf16 v21, v122, v122, v21
    v_dot2_f32_bf16 v22, v126, s58, v22
    v_dot2_f32_bf16 v23, v126, v126, v23
    v_dot2_f32_bf16 v20, v123, s58, v20
    v_dot2_f32_bf16 v21, v123, v123, v21
    v_dot2_f32_bf16 v22, v127, s58, v22
    v_dot2_f32_bf16 v23, v127, v127, v23
    s_waitcnt lgkmcnt(4)
    v_dot2_f32_bf16 v20, v128, s58, v20
    v_dot2_f32_bf16 v21, v128, v128, v21
    v_dot2_f32_bf16 v22, v132, s58, v22
    v_dot2_f32_bf16 v23, v132, v132, v23
    s_nop 0
    v_dot2_f32_bf16 v20, v129, s58, v20
    v_dot2_f32_bf16 v21, v129, v129, v21
    v_dot2_f32_bf16 v22, v133, s58, v22
    v_dot2_f32_bf16 v23, v133, v133, v23
    v_dot2_f32_bf16 v20, v130, s58, v20
    v_dot2_f32_bf16 v21, v130, v130, v21
    v_dot2_f32_bf16 v22, v134, s58, v22
    v_dot2_f32_bf16 v23, v134, v134, v23
    v_dot2_f32_bf16 v20, v131, s58, v20
    v_dot2_f32_bf16 v21, v131, v131, v21
    v_dot2_f32_bf16 v22, v135, s58, v22
    v_dot2_f32_bf16 v23, v135, v135, v23
    s_waitcnt lgkmcnt(0)
    v_dot2_f32_bf16 v20, v136, s58, v20
    v_dot2_f32_bf16 v21, v136, v136, v21
    v_dot2_f32_bf16 v22, v140, s58, v22
    v_dot2_f32_bf16 v23, v140, v140, v23
    v_dot2_f32_bf16 v20, v137, s58, v20
    v_dot2_f32_bf16 v21, v137, v137, v21
    s_nop 0
    v_dot2_f32_bf16 v22, v141, s58, v22
    v_dot2_f32_bf16 v23, v141, v141, v23
    v_dot2_f32_bf16 v20, v138, s58, v20
    v_dot2_f32_bf16 v21, v138, v138, v21
    v_dot2_f32_bf16 v22, v142, s58, v22
    v_dot2_f32_bf16 v23, v142, v142, v23
    v_dot2_f32_bf16 v20, v139, s58, v20
    v_dot2_f32_bf16 v21, v139, v139, v21
    v_dot2_f32_bf16 v22, v143, s58, v22
    v_dot2_f32_bf16 v23, v143, v143, v23
    s_branch L_HOK
L_ZBAD:
    s_waitcnt vmcnt(0)
    s_mov_b32 s71, s53
    buffer_load_dwordx4 v[120:123], v10, s[40:43], s71 offen offset:0 sc1
    buffer_load_dwordx4 v[124:127], v10, s[40:43], s71 offen offset:1024 sc1
    buffer_load_dwordx4 v[128:131], v10, s[40:43], s71 offen offset:2048 sc1
    buffer_load_dwordx4 v[132:135], v10, s[40:43], s71 offen offset:3072 sc1
    s_waitcnt vmcnt(0)
    v_mfma_f32_16x16x32_bf16 v[88:91], v[120:123], a[0:3], v[48:51]
    v_mfma_f32_16x16x32_bf16 v[96:99], v[120:123], a[64:67], 0
    v_mfma_f32_16x16x32_bf16 v[104:107], v[120:123], a[128:131], 0
    v_mfma_f32_16x16x32_bf16 v[112:115], v[120:123], a[192:195], 0
    v_mfma_f32_16x16x32_bf16 v[92:95], v[124:127], a[0:3], v[48:51]
    v_mfma_f32_16x16x32_bf16 v[100:103], v[124:127], a[64:67], 0
    v_mfma_f32_16x16x32_bf16 v[108:111], v[124:127], a[128:131], 0
    v_mfma_f32_16x16x32_bf16 v[116:119], v[124:127], a[192:195], 0
    v_mfma_f32_16x16x32_bf16 v[88:91], v[128:131], a[4:7], v[88:91]
    v_mfma_f32_16x16x32_bf16 v[96:99], v[128:131], a[68:71], v[96:99]
    v_mfma_f32_16x16x32_bf16 v[104:107], v[128:131], a[132:135], v[104:107]
    v_mfma_f32_16x16x32_bf16 v[112:115], v[128:131], a[196:199], v[112:115]
    v_mfma_f32_16x16x32_bf16 v[92:95], v[132:135], a[4:7], v[92:95]
    v_mfma_f32_16x16x32_bf16 v[100:103], v[132:135], a[68:71], v[100:103]
    v_mfma_f32_16x16x32_bf16 v[108:111], v[132:135], a[132:135], v[108:111]
    v_mfma_f32_16x16x32_bf16 v[116:119], v[132:135], a[196:199], v[116:119]
    s_nop 7
    s_nop 7
    s_add_u32 s71, s71, 20480
    buffer_load_dwordx4 v[120:123], v10, s[40:43], s71 offen offset:0 sc1
    buffer_load_dwordx4 v[124:127], v10, s[40:43], s71 offen offset:1024 sc1
    buffer_load_dwordx4 v[128:131], v10, s[40:43], s71 offen offset:2048 sc1
    buffer_load_dwordx4 v[132:135], v10, s[40:43], s71 offen offset:3072 sc1
    s_waitcnt vmcnt(0)
    v_mfma_f32_16x16x32_bf16 v[88:91], v[120:123], a[8:11], v[88:91]
    v_mfma_f32_16x16x32_bf16 v[96:99], v[120:123], a[72:75], v[96:99]
    v_mfma_f32_16x16x32_bf16 v[104:107], v[120:123], a[136:139], v[104:107]
    v_mfma_f32_16x16x32_bf16 v[112:115], v[120:123], a[200:203], v[112:115]
    v_mfma_f32_16x16x32_bf16 v[92:95], v[124:127], a[8:11], v[92:95]
    v_mfma_f32_16x16x32_bf16 v[100:103], v[124:127], a[72:75], v[100:103]
    v_mfma_f32_16x16x32_bf16 v[108:111], v[124:127], a[136:139], v[108:111]
    v_mfma_f32_16x16x32_bf16 v[116:119], v[124:127], a[200:203], v[116:119]
    v_mfma_f32_16x16x32_bf16 v[88:91], v[128:131], a[12:15], v[88:91]
    v_mfma_f32_16x16x32_bf16 v[96:99], v[128:131], a[76:79], v[96:99]
    v_mfma_f32_16x16x32_bf16 v[104:107], v[128:131], a[140:143], v[104:107]
    v_mfma_f32_16x16x32_bf16 v[112:115], v[128:131], a[204:207], v[112:115]
    v_mfma_f32_16x16x32_bf16 v[92:95], v[132:135], a[12:15], v[92:95]
    v_mfma_f32_16x16x32_bf16 v[100:103], v[132:135], a[76:79], v[100:103]
    v_mfma_f32_16x16x32_bf16 v[108:111], v[132:135], a[140:143], v[108:111]
    v_mfma_f32_16x16x32_bf16 v[116:119], v[132:135], a[204:207], v[116:119]
    s_nop 7
    s_nop 7
    s_mov_b32 s71, s56
    buffer_load_dwordx4 v[120:123], v10, s[40:43], s71 offen offset:0 sc1
    buffer_load_dwordx4 v[124:127], v10, s[40:43], s71 offen offset:1024 sc1
    buffer_load_dwordx4 v[128:131], v10, s[40:43], s71 offen offset:2048 sc1
    buffer_load_dwordx4 v[132:135], v10, s[40:43], s71 offen offset:3072 sc1
    s_waitcnt vmcnt(0)
    v_mfma_f32_16x16x32_bf16 v[88:91], v[120:123], a[16:19], v[88:91]
    v_mfma_f32_16x16x32_bf16 v[96:99], v[120:123], a[80:83], v[96:99]
    v_mfma_f32_16x16x32_bf16 v[104:107], v[120:123], a[144:147], v[104:107]
    v_mfma_f32_16x16x32_bf16 v[112:115], v[120:123], a[208:211], v[112:115]
    v_mfma_f32_16x16x32_bf16 v[92:95], v[124:127], a[16:19], v[92:95]
    v_mfma_f32_16x16x32_bf16 v[100:103], v[124:127], a[80:83], v[100:103]
    v_mfma_f32_16x16x32_bf16 v[108:111], v[124:127], a[144:147], v[108:111]
    v_mfma_f32_16x16x32_bf16 v[116:119], v[124:127], a[208:211], v[116:119]
    v_mfma_f32_16x16x32_bf16 v[88:91], v[128:131], a[20:23], v[88:91]
    v_mfma_f32_16x16x32_bf16 v[96:99], v[128:131], a[84:87], v[96:99]
    v_mfma_f32_16x16x32_bf16 v[104:107], v[128:131], a[148:151], v[104:107]
    v_mfma_f32_16x16x32_bf16 v[112:115], v[128:131], a[212:215], v[112:115]
    v_mfma_f32_16x16x32_bf16 v[92:95], v[132:135], a[20:23], v[92:95]
    v_mfma_f32_16x16x32_bf16 v[100:103], v[132:135], a[84:87], v[100:103]
    v_mfma_f32_16x16x32_bf16 v[108:111], v[132:135], a[148:151], v[108:111]
    v_mfma_f32_16x16x32_bf16 v[116:119], v[132:135], a[212:215], v[116:119]
    s_nop 7
    s_nop 7
    s_add_u32 s71, s71, 20480
    buffer_load_dwordx4 v[120:123], v10, s[40:43], s71 offen offset:0 sc1
    buffer_load_dwordx4 v[124:127], v10, s[40:43], s71 offen offset:1024 sc1
    buffer_load_dwordx4 v[128:131], v10, s[40:43], s71 offen offset:2048 sc1
    buffer_load_dwordx4 v[132:135], v10, s[40:43], s71 offen offset:3072 sc1
    s_waitcnt vmcnt(0)
    v_mfma_f32_16x16x32_bf16 v[88:91], v[120:123], a[24:27], v[88:91]
    v_mfma_f32_16x16x32_bf16 v[96:99], v[120:123], a[88:91], v[96:99]
    v_mfma_f32_16x16x32_bf16 v[104:107], v[120:123], a[152:155], v[104:107]
    v_mfma_f32_16x16x32_bf16 v[112:115], v[120:123], a[216:219], v[112:115]
    v_mfma_f32_16x16x32_bf16 v[92:95], v[124:127], a[24:27], v[92:95]
    v_mfma_f32_16x16x32_bf16 v[100:103], v[124:127], a[88:91], v[100:103]
    v_mfma_f32_16x16x32_bf16 v[108:111], v[124:127], a[152:155], v[108:111]
    v_mfma_f32_16x16x32_bf16 v[116:119], v[124:127], a[216:219], v[116:119]
    v_mfma_f32_16x16x32_bf16 v[88:91], v[128:131], a[28:31], v[88:91]
    v_mfma_f32_16x16x32_bf16 v[96:99], v[128:131], a[92:95], v[96:99]
    v_mfma_f32_16x16x32_bf16 v[104:107], v[128:131], a[156:159], v[104:107]
    v_mfma_f32_16x16x32_bf16 v[112:115], v[128:131], a[220:223], v[112:115]
    v_mfma_f32_16x16x32_bf16 v[92:95], v[132:135], a[28:31], v[92:95]
    v_mfma_f32_16x16x32_bf16 v[100:103], v[132:135], a[92:95], v[100:103]
    v_mfma_f32_16x16x32_bf16 v[108:111], v[132:135], a[156:159], v[108:111]
    v_mfma_f32_16x16x32_bf16 v[116:119], v[132:135], a[220:223], v[116:119]
    s_nop 7
    s_nop 7
    s_mov_b32 s71, s57
    buffer_load_dwordx4 v[120:123], v10, s[40:43], s71 offen offset:0 sc1
    buffer_load_dwordx4 v[124:127], v10, s[40:43], s71 offen offset:1024 sc1
    buffer_load_dwordx4 v[128:131], v10, s[40:43], s71 offen offset:2048 sc1
    buffer_load_dwordx4 v[132:135], v10, s[40:43], s71 offen offset:3072 sc1
    s_waitcnt vmcnt(0)
    v_mfma_f32_16x16x32_bf16 v[88:91], v[120:123], a[32:35], v[88:91]
    v_mfma_f32_16x16x32_bf16 v[96:99], v[120:123], a[96:99], v[96:99]
    v_mfma_f32_16x16x32_bf16 v[104:107], v[120:123], a[160:163], v[104:107]
    v_mfma_f32_16x16x32_bf16 v[112:115], v[120:123], a[224:227], v[112:115]
    v_mfma_f32_16x16x32_bf16 v[92:95], v[124:127], a[32:35], v[92:95]
    v_mfma_f32_16x16x32_bf16 v[100:103], v[124:127], a[96:99], v[100:103]
    v_mfma_f32_16x16x32_bf16 v[108:111], v[124:127], a[160:163], v[108:111]
    v_mfma_f32_16x16x32_bf16 v[116:119], v[124:127], a[224:227], v[116:119]
    v_mfma_f32_16x16x32_bf16 v[88:91], v[128:131], a[36:39], v[88:91]
    v_mfma_f32_16x16x32_bf16 v[96:99], v[128:131], a[100:103], v[96:99]
    v_mfma_f32_16x16x32_bf16 v[104:107], v[128:131], a[164:167], v[104:107]
    v_mfma_f32_16x16x32_bf16 v[112:115], v[128:131], a[228:231], v[112:115]
    v_mfma_f32_16x16x32_bf16 v[92:95], v[132:135], a[36:39], v[92:95]
    v_mfma_f32_16x16x32_bf16 v[100:103], v[132:135], a[100:103], v[100:103]
    v_mfma_f32_16x16x32_bf16 v[108:111], v[132:135], a[164:167], v[108:111]
    v_mfma_f32_16x16x32_bf16 v[116:119], v[132:135], a[228:231], v[116:119]
    s_nop 7
    s_nop 7
    s_add_u32 s71, s71, 20480
    buffer_load_dwordx4 v[120:123], v10, s[40:43], s71 offen offset:0 sc1
    buffer_load_dwordx4 v[124:127], v10, s[40:43], s71 offen offset:1024 sc1
    buffer_load_dwordx4 v[128:131], v10, s[40:43], s71 offen offset:2048 sc1
    buffer_load_dwordx4 v[132:135], v10, s[40:43], s71 offen offset:3072 sc1
    s_waitcnt vmcnt(0)
    v_mfma_f32_16x16x32_bf16 v[88:91], v[120:123], a[40:43], v[88:91]
    v_mfma_f32_16x16x32_bf16 v[96:99], v[120:123], a[104:107], v[96:99]
    v_mfma_f32_16x16x32_bf16 v[104:107], v[120:123], a[168:171], v[104:107]
    v_mfma_f32_16x16x32_bf16 v[112:115], v[120:123], a[232:235], v[112:115]
    v_mfma_f32_16x16x32_bf16 v[92:95], v[124:127], a[40:43], v[92:95]
    v_mfma_f32_16x16x32_bf16 v[100:103], v[124:127], a[104:107], v[100:103]
    v_mfma_f32_16x16x32_bf16 v[108:111], v[124:127], a[168:171], v[108:111]
    v_mfma_f32_16x16x32_bf16 v[116:119], v[124:127], a[232:235], v[116:119]
    v_mfma_f32_16x16x32_bf16 v[88:91], v[128:131], a[44:47], v[88:91]
    v_mfma_f32_16x16x32_bf16 v[96:99], v[128:131], a[108:111], v[96:99]
    v_mfma_f32_16x16x32_bf16 v[104:107], v[128:131], a[172:175], v[104:107]
    v_mfma_f32_16x16x32_bf16 v[112:115], v[128:131], a[236:239], v[112:115]
    v_mfma_f32_16x16x32_bf16 v[92:95], v[132:135], a[44:47], v[92:95]
    v_mfma_f32_16x16x32_bf16 v[100:103], v[132:135], a[108:111], v[100:103]
    v_mfma_f32_16x16x32_bf16 v[108:111], v[132:135], a[172:175], v[108:111]
    v_mfma_f32_16x16x32_bf16 v[116:119], v[132:135], a[236:239], v[116:119]
    s_nop 7
    s_nop 7
    s_mov_b32 s71, s60
    buffer_load_dwordx4 v[120:123], v10, s[40:43], s71 offen offset:0 sc1
    buffer_load_dwordx4 v[124:127], v10, s[40:43], s71 offen offset:1024 sc1
    buffer_load_dwordx4 v[128:131], v10, s[40:43], s71 offen offset:2048 sc1
    buffer_load_dwordx4 v[132:135], v10, s[40:43], s71 offen offset:3072 sc1
    s_waitcnt vmcnt(0)
    v_mfma_f32_16x16x32_bf16 v[88:91], v[120:123], a[48:51], v[88:91]
    v_mfma_f32_16x16x32_bf16 v[96:99], v[120:123], a[112:115], v[96:99]
    v_mfma_f32_16x16x32_bf16 v[104:107], v[120:123], a[176:179], v[104:107]
    v_mfma_f32_16x16x32_bf16 v[112:115], v[120:123], a[240:243], v[112:115]
    v_mfma_f32_16x16x32_bf16 v[92:95], v[124:127], a[48:51], v[92:95]
    v_mfma_f32_16x16x32_bf16 v[100:103], v[124:127], a[112:115], v[100:103]
    v_mfma_f32_16x16x32_bf16 v[108:111], v[124:127], a[176:179], v[108:111]
    v_mfma_f32_16x16x32_bf16 v[116:119], v[124:127], a[240:243], v[116:119]
    v_mfma_f32_16x16x32_bf16 v[88:91], v[128:131], a[52:55], v[88:91]
    v_mfma_f32_16x16x32_bf16 v[96:99], v[128:131], a[116:119], v[96:99]
    v_mfma_f32_16x16x32_bf16 v[104:107], v[128:131], a[180:183], v[104:107]
    v_mfma_f32_16x16x32_bf16 v[112:115], v[128:131], a[244:247], v[112:115]
    v_mfma_f32_16x16x32_bf16 v[92:95], v[132:135], a[52:55], v[92:95]
    v_mfma_f32_16x16x32_bf16 v[100:103], v[132:135], a[116:119], v[100:103]
    v_mfma_f32_16x16x32_bf16 v[108:111], v[132:135], a[180:183], v[108:111]
    v_mfma_f32_16x16x32_bf16 v[116:119], v[132:135], a[244:247], v[116:119]
    s_nop 7
    s_nop 7
    s_add_u32 s71, s71, 20480
    buffer_load_dwordx4 v[120:123], v10, s[40:43], s71 offen offset:0 sc1
    buffer_load_dwordx4 v[124:127], v10, s[40:43], s71 offen offset:1024 sc1
    buffer_load_dwordx4 v[128:131], v10, s[40:43], s71 offen offset:2048 sc1
    buffer_load_dwordx4 v[132:135], v10, s[40:43], s71 offen offset:3072 sc1
    s_waitcnt vmcnt(0)
    v_mfma_f32_16x16x32_bf16 v[88:91], v[120:123], a[56:59], v[88:91]
    v_mfma_f32_16x16x32_bf16 v[96:99], v[120:123], a[120:123], v[96:99]
    v_mfma_f32_16x16x32_bf16 v[104:107], v[120:123], a[184:187], v[104:107]
    v_mfma_f32_16x16x32_bf16 v[112:115], v[120:123], a[248:251], v[112:115]
    v_mfma_f32_16x16x32_bf16 v[92:95], v[124:127], a[56:59], v[92:95]
    v_mfma_f32_16x16x32_bf16 v[100:103], v[124:127], a[120:123], v[100:103]
    v_mfma_f32_16x16x32_bf16 v[108:111], v[124:127], a[184:187], v[108:111]
    v_mfma_f32_16x16x32_bf16 v[116:119], v[124:127], a[248:251], v[116:119]
    v_mfma_f32_16x16x32_bf16 v[88:91], v[128:131], a[60:63], v[88:91]
    v_mfma_f32_16x16x32_bf16 v[96:99], v[128:131], a[124:127], v[96:99]
    v_mfma_f32_16x16x32_bf16 v[104:107], v[128:131], a[188:191], v[104:107]
    v_mfma_f32_16x16x32_bf16 v[112:115], v[128:131], a[252:255], v[112:115]
    v_mfma_f32_16x16x32_bf16 v[92:95], v[132:135], a[60:63], v[92:95]
    v_mfma_f32_16x16x32_bf16 v[100:103], v[132:135], a[124:127], v[100:103]
    v_mfma_f32_16x16x32_bf16 v[108:111], v[132:135], a[188:191], v[108:111]
    v_mfma_f32_16x16x32_bf16 v[116:119], v[132:135], a[252:255], v[116:119]
    s_nop 7
    s_nop 7
    s_branch L_ZOK
L_G0_B:
    s_mov_b32 s59, 0
L_G0_R:
    buffer_load_dwordx4 v[104:107], v10, s[40:43], s17 offen offset:0 sc1
    buffer_load_dwordx4 v[108:111], v10, s[40:43], s18 offen offset:0 sc1
    buffer_load_dwordx4 v[112:115], v10, s[40:43], s19 offen offset:0 sc1
    buffer_load_dwordx4 v[116:119], v10, s[40:43], s20 offen offset:0 sc1
    buffer_load_dwordx4 v[56:59], v10, s[40:43], s21 offen offset:0 sc1
    buffer_load_dwordx4 v[60:63], v10, s[40:43], s22 offen offset:0 sc1
L_G0_C:
    s_waitcnt vmcnt(0)
    v_max3_u32 v31, v105, v109, v113
    v_max3_u32 v31, v117, v57, v31
    v_max_u32_e64 v31, v61, v31
    v_cmp_le_u32 vcc, 0xffc00000, v31
    s_add_u32 s59, s59, 1
    s_cmp_gt_u32 s59, 4096
    s_cbranch_scc1 L_G0_OK
    s_cbranch_vccnz L_G0_R
    s_branch L_G0_OK
L_G1_B:
    s_mov_b32 s59, 0
L_G1_R:
    buffer_load_dwordx4 v[208:211], v10, s[40:43], s17 offen offset:1024 sc1
    buffer_load_dwordx4 v[212:215], v10, s[40:43], s18 offen offset:1024 sc1
    buffer_load_dwordx4 v[216:219], v10, s[40:43], s19 offen offset:1024 sc1
    buffer_load_dwordx4 v[220:223], v10, s[40:43], s20 offen offset:1024 sc1
    buffer_load_dwordx4 v[224:227], v10, s[40:43], s21 offen offset:1024 sc1
    buffer_load_dwordx4 v[228:231], v10, s[40:43], s22 offen offset:1024 sc1
L_G1_C:
    s_waitcnt vmcnt(0)
    v_max3_u32 v31, v209, v213, v217
    v_max3_u32 v31, v221, v225, v31
    v_max_u32 v31, v229, v31
    v_cmp_le_u32 vcc, 0xffc00000, v31
    s_add_u32 s59, s59, 1
    s_cmp_gt_u32 s59, 4096
    s_cbranch_scc1 L_G1_OK
    s_cbranch_vccnz L_G1_R
    s_branch L_G1_OK
L_G2_B:
    s_mov_b32 s59, 0
L_G2_R:
    buffer_load_dwordx4 v[232:235], v10, s[40:43], s17 offen offset:2048 sc1
    buffer_load_dwordx4 v[236:239], v10, s[40:43], s18 offen offset:2048 sc1
    buffer_load_dwordx4 v[240:243], v10, s[40:43], s19 offen offset:2048 sc1
    buffer_load_dwordx4 v[244:247], v10, s[40:43], s20 offen offset:2048 sc1
    buffer_load_dwordx4 v[248:251], v10, s[40:43], s21 offen offset:2048 sc1
    buffer_load_dwordx4 v[252:255], v10, s[40:43], s22 offen offset:2048 sc1
L_G2_C:
    s_waitcnt vmcnt(0)
    v_max3_u32 v31, v233, v237, v241
    v_max3_u32 v31, v245, v249, v31
    v_max_u32 v31, v253, v31
    v_cmp_le_u32 vcc, 0xffc00000, v31
    s_add_u32 s59, s59, 1
    s_cmp_gt_u32 s59, 4096
    s_cbranch_scc1 L_G2_OK
    s_cbranch_vccnz L_G2_R
    s_branch L_G2_OK
L_G3_B:
    s_mov_b32 s59, 0
L_G3_R:
    buffer_load_dwordx4 v[136:139], v10, s[40:43], s27 offen sc1
    buffer_load_dwordx4 v[140:143], v10, s[40:43], s34 offen sc1
    buffer_load_dwordx4 v[144:147], v10, s[40:43], s35 offen sc1
    buffer_load_dwordx4 v[148:151], v10, s[40:43], s36 offen sc1
    buffer_load_dwordx4 v[152:155], v10, s[40:43], s37 offen sc1
    buffer_load_dwordx4 v[156:159], v10, s[40:43], s5 offen sc1
L_G3_C:
    s_waitcnt vmcnt(0)
    v_max3_u32 v31, v137, v141, v145
    v_max3_u32 v31, v149, v153, v31
    v_max_u32 v31, v157, v31
    v_cmp_le_u32 vcc, 0xffc00000, v31
    s_add_u32 s59, s59, 1
    s_cmp_gt_u32 s59, 4096
    s_cbranch_scc1 L_G3_OK
    s_cbranch_vccnz L_G3_R
    s_branch L_G3_OK
L_AUX:
    s_waitcnt lgkmcnt(0)
    s_mov_b32 s40, s36
    s_mov_b32 s41, s37
    s_mov_b32 s44, s4
    s_mov_b32 s45, s5
    buffer_load_dword v20, off, s[40:43], 0 sc1
    s_lshl_b32 s63, s57, 4
    s_lshr_b32 s62, s56, 1
    s_add_u32 s63, s63, s62
    s_mul_i32 s63, s63, 2176
    s_and_b32 s62, s56, 1
    s_lshl_b32 s62, s62, 6
    s_add_u32 s63, s63, s62
    s_add_u32 s63, s63, 1572864
    s_mov_b64 exec, 1
    buffer_load_dword v51, off, s[40:43], s63 sc1
    s_mov_b64 exec, -1
    buffer_load_dwordx4 v[2:5], v59, s[44:47], s71 offen
    buffer_load_dwordx4 v[6:9], v59, s[44:47], s71 offen offset:896
    s_lshl_b32 s53, s57, 2
    s_add_u32 s53, s53, s56
    s_sub_u32 s53, s53, 28
    v_and_b32 v1, 63, v0
    s_cmp_ge_u32 s53, 28
    s_cbranch_scc1 L_AUX_ST
    s_mov_b32 s64, s24
    s_mov_b32 s65, s25
    s_mov_b32 s66, 1605632
    s_mov_b32 s67, 0x20000
    s_mov_b32 s48, s30
    s_mov_b32 s49, s31
    s_mov_b32 s50, 802816
    s_mov_b32 s51, 0x20000
    v_lshrrev_b32 v28, 3, v1
    s_mul_i32 s59, s3, 112
    v_add_u32 v28, s59, v28
    v_mul_u32_u24 v28, 3584, v28
    v_bfe_u32 v29, v1, 4, 1
    v_lshlrev_b32 v29, 2, v29
    v_and_b32 v30, 7, v1
    v_xor_b32 v29, v29, v30
    v_lshl_add_u32 v28, v29, 4, v28
    s_lshl_b32 s62, s53, 7
    s_mul_i32 s63, s3, 14336
    v_lshlrev_b32 v52, 12, v1
    s_lshl_b32 s59, s53, 7
    s_add_u32 s59, s59, 147456
    s_mov_b64 exec, 3
    buffer_load_dword v51, v52, s[40:43], s59 offen sc1
    s_mov_b64 exec, -1
    s_mov_b32 m0, s63
    s_add_u32 s63, s63, 1024
    buffer_load_dwordx4 v28, s[64:67], s62 offen lds
    s_add_u32 s62, s62, 28672
    s_mov_b32 m0, s63
    s_add_u32 s63, s63, 1024
    buffer_load_dwordx4 v28, s[64:67], s62 offen lds
    s_add_u32 s62, s62, 28672
    s_mov_b32 m0, s63
    s_add_u32 s63, s63, 1024
    buffer_load_dwordx4 v28, s[64:67], s62 offen lds
    s_add_u32 s62, s62, 28672
    s_mov_b32 m0, s63
    s_add_u32 s63, s63, 1024
    buffer_load_dwordx4 v28, s[64:67], s62 offen lds
    s_add_u32 s62, s62, 28672
    v_bfe_u32 v32, v1, 2, 2
    v_lshrrev_b32 v33, 5, v1
    v_lshl_add_u32 v33, v33, 3, v32
    v_lshlrev_b32 v33, 7, v33
    v_bfe_u32 v34, v1, 4, 1
    v_lshlrev_b32 v34, 1, v34
    v_bfe_u32 v35, v1, 1, 1
    v_add_u32 v34, v34, v35
    v_bfe_u32 v35, v1, 3, 1
    v_lshlrev_b32 v35, 2, v35
    v_xor_b32 v34, v34, v35
    v_lshl_add_u32 v33, v34, 4, v33
    v_and_b32 v35, 1, v1
    v_lshl_add_u32 v33, v35, 3, v33
    s_mul_i32 s59, s3, 14336
    v_add_u32 v33, s59, v33
    v_xor_b32 v34, 64, v33
    v_lshlrev_b32 v29, 4, v1
    s_mul_i32 s68, s53, 57344
    s_mul_i32 s59, s3, 7168
    s_add_u32 s68, s68, s59
    s_add_u32 s68, s68, 2883584
    s_add_u32 s71, s68, 28672
    s_waitcnt vmcnt(5)
    v_readfirstlane_b32 s52, v20
    s_nop 0
    s_add_u32 s52, s52, 1
    s_or_b32 s52, s52, 0xffc00000
    v_dot2_f32_bf16 v30, v2, s58, 0
    v_dot2_f32_bf16 v31, v2, v2, 0
    v_dot2_f32_bf16 v36, v6, s58, 0
    v_dot2_f32_bf16 v37, v6, v6, 0
    v_dot2_f32_bf16 v30, v3, s58, v30
    v_dot2_f32_bf16 v31, v3, v3, v31
    v_dot2_f32_bf16 v36, v7, s58, v36
    v_dot2_f32_bf16 v37, v7, v7, v37
    v_dot2_f32_bf16 v30, v4, s58, v30
    v_dot2_f32_bf16 v31, v4, v4, v31
    v_dot2_f32_bf16 v36, v8, s58, v36
    v_dot2_f32_bf16 v37, v8, v8, v37
    v_dot2_f32_bf16 v30, v5, s58, v30
    v_dot2_f32_bf16 v31, v5, v5, v31
    v_dot2_f32_bf16 v36, v9, s58, v36
    v_dot2_f32_bf16 v37, v9, v9, v37
    s_nop 1
    v_permlane32_swap_b32 v30, v36
    v_permlane32_swap_b32 v31, v37
    v_add_f32 v30, v30, v36
    v_add_f32 v31, v31, v37
    s_nop 0
    v_add_f32_dpp v30, v30, v30 row_shr:1 row_mask:0xf bank_mask:0xf bound_ctrl:0
    v_add_f32_dpp v31, v31, v31 row_shr:1 row_mask:0xf bank_mask:0xf bound_ctrl:0
    s_nop 0
    v_add_f32_dpp v30, v30, v30 row_shr:2 row_mask:0xf bank_mask:0xf bound_ctrl:0
    v_add_f32_dpp v31, v31, v31 row_shr:2 row_mask:0xf bank_mask:0xf bound_ctrl:0
    s_nop 0
    v_add_f32_dpp v30, v30, v30 row_shr:4 row_mask:0xf bank_mask:0xf bound_ctrl:0
    v_add_f32_dpp v31, v31, v31 row_shr:4 row_mask:0xf bank_mask:0xf bound_ctrl:0
    s_nop 0
    v_add_f32_dpp v30, v30, v30 row_shr:8 row_mask:0xf bank_mask:0xf bound_ctrl:0
    v_add_f32_dpp v31, v31, v31 row_shr:8 row_mask:0xf bank_mask:0xf bound_ctrl:0
    s_nop 0
    v_add_f32_dpp v30, v30, v30 row_bcast:15 row_mask:0xa bank_mask:0xf
    v_add_f32_dpp v31, v31, v31 row_bcast:15 row_mask:0xa bank_mask:0xf
    v_mul_f32 v30, 0x3b124925, v30
    v_mul_f32 v31, 0x3b124925, v31
    v_fma_f32 v31, -v30, v30, v31
    v_max_f32 v31, 0, v31
    v_cvt_pk_bf16_f32 v31, v31, v31
    v_and_b32 v31, 0xffff0000, v31
    v_add_f32 v31, 0x3727c5ac, v31
    v_cvt_pk_bf16_f32 v31, v31, v31
    v_and_b32 v31, 0xffff0000, v31
    v_sqrt_f32 v31, v31
    v_lshrrev_b32 v20, 5, v0
    v_lshlrev_b32 v20, 3, v20
    v_cvt_pk_bf16_f32 v36, v30, v31
    v_mov_b32 v37, s52
    s_lshl_b32 s59, s57, 4
    s_lshr_b32 s69, s56, 1
    s_add_u32 s59, s59, s69
    s_mul_i32 s59, s59, 2176
    s_and_b32 s69, s56, 1
    s_lshl_b32 s69, s69, 6
    s_add_u32 s59, s59, s69
    s_add_u32 s59, s59, 1572864
    s_mov_b32 exec_lo, 0x80000000
    s_mov_b32 exec_hi, 0x80000000
    buffer_store_dwordx2 v[36:37], v20, s[40:43], s59 offen sc1
    s_mov_b64 exec, -1
    s_mov_b32 m0, s63
    s_add_u32 s63, s63, 1024
    buffer_load_dwordx4 v28, s[64:67], s62 offen lds
    s_add_u32 s62, s62, 28672
    s_mov_b32 m0, s63
    s_add_u32 s63, s63, 1024
    buffer_load_dwordx4 v28, s[64:67], s62 offen lds
    s_add_u32 s62, s62, 28672
    s_mov_b32 m0, s63
    s_add_u32 s63, s63, 1024
    buffer_load_dwordx4 v28, s[64:67], s62 offen lds
    s_add_u32 s62, s62, 28672
    s_mov_b32 m0, s63
    s_add_u32 s63, s63, 1024
    buffer_load_dwordx4 v28, s[64:67], s62 offen lds
    s_add_u32 s62, s62, 28672
    s_mov_b32 m0, s63
    s_add_u32 s63, s63, 1024
    buffer_load_dwordx4 v28, s[64:67], s62 offen lds
    s_add_u32 s62, s62, 28672
    s_mov_b32 m0, s63
    s_add_u32 s63, s63, 1024
    buffer_load_dwordx4 v28, s[64:67], s62 offen lds
    s_add_u32 s62, s62, 28672
    s_mov_b32 m0, s63
    s_add_u32 s63, s63, 1024
    buffer_load_dwordx4 v28, s[64:67], s62 offen lds
    s_add_u32 s62, s62, 28672
    s_mov_b32 m0, s63
    s_add_u32 s63, s63, 1024
    buffer_load_dwordx4 v28, s[64:67], s62 offen lds
    s_add_u32 s62, s62, 28672
    s_mov_b32 m0, s63
    s_add_u32 s63, s63, 1024
    buffer_load_dwordx4 v28, s[64:67], s62 offen lds
    s_add_u32 s62, s62, 28672
    s_mov_b32 m0, s63
    s_add_u32 s63, s63, 1024
    buffer_load_dwordx4 v28, s[64:67], s62 offen lds
    s_add_u32 s62, s62, 28672
    s_waitcnt vmcnt(13)
    ds_read_b64_tr_b16 v[40:41], v33 offset:0
    ds_read_b64_tr_b16 v[42:43], v33 offset:512
    ds_read_b64_tr_b16 v[44:45], v34 offset:0
    ds_read_b64_tr_b16 v[46:47], v34 offset:512
    s_waitcnt lgkmcnt(0)
    buffer_store_dwordx4 v[40:43], v29, s[40:43], s68 offen offset:0 sc1
    buffer_store_dwordx4 v[44:47], v29, s[40:43], s71 offen offset:0 sc1
    v_dot2_f32_bf16 v30, v40, s58, 0
    v_dot2_f32_bf16 v31, v44, s58, 0
    v_dot2_f32_bf16 v30, v41, s58, v30
    v_dot2_f32_bf16 v31, v45, s58, v31
    v_dot2_f32_bf16 v30, v42, s58, v30
    v_dot2_f32_bf16 v31, v46, s58, v31
    v_dot2_f32_bf16 v30, v43, s58, v30
    v_dot2_f32_bf16 v31, v47, s58, v31
    s_waitcnt vmcnt(13)
    ds_read_b64_tr_b16 v[48:49], v33 offset:2048
    ds_read_b64_tr_b16 v[50:51], v33 offset:2560
    ds_read_b64_tr_b16 v[52:53], v34 offset:2048
    ds_read_b64_tr_b16 v[54:55], v34 offset:2560
    s_waitcnt lgkmcnt(0)
    buffer_store_dwordx4 v[48:51], v29, s[40:43], s68 offen offset:1024 sc1
    buffer_store_dwordx4 v[52:55], v29, s[40:43], s71 offen offset:1024 sc1
    v_dot2_f32_bf16 v30, v48, s58, v30
    v_dot2_f32_bf16 v31, v52, s58, v31
    v_dot2_f32_bf16 v30, v49, s58, v30
    v_dot2_f32_bf16 v31, v53, s58, v31
    v_dot2_f32_bf16 v30, v50, s58, v30
    v_dot2_f32_bf16 v31, v54, s58, v31
    v_dot2_f32_bf16 v30, v51, s58, v30
    v_dot2_f32_bf16 v31, v55, s58, v31
    s_waitcnt vmcnt(12)
    ds_read_b64_tr_b16 v[56:57], v33 offset:4096
    ds_read_b64_tr_b16 v[58:59], v33 offset:4608
    ds_read_b64_tr_b16 v[60:61], v34 offset:4096
    ds_read_b64_tr_b16 v[62:63], v34 offset:4608
    s_waitcnt lgkmcnt(0)
    buffer_store_dwordx4 v[56:59], v29, s[40:43], s68 offen offset:2048 sc1
    buffer_store_dwordx4 v[60:63], v29, s[40:43], s71 offen offset:2048 sc1
    v_dot2_f32_bf16 v30, v56, s58, v30
    v_dot2_f32_bf16 v31, v60, s58, v31
    v_dot2_f32_bf16 v30, v57, s58, v30
    v_dot2_f32_bf16 v31, v61, s58, v31
    v_dot2_f32_bf16 v30, v58, s58, v30
    v_dot2_f32_bf16 v31, v62, s58, v31
    v_dot2_f32_bf16 v30, v59, s58, v30
    v_dot2_f32_bf16 v31, v63, s58, v31
    s_waitcnt vmcnt(12)
    ds_read_b64_tr_b16 v[64:65], v33 offset:6144
    ds_read_b64_tr_b16 v[66:67], v33 offset:6656
    ds_read_b64_tr_b16 v[68:69], v34 offset:6144
    ds_read_b64_tr_b16 v[70:71], v34 offset:6656
    s_waitcnt lgkmcnt(0)
    buffer_store_dwordx4 v[64:67], v29, s[40:43], s68 offen offset:3072 sc1
    buffer_store_dwordx4 v[68:71], v29, s[40:43], s71 offen offset:3072 sc1
    s_add_u32 s68, s68, 4096
    s_add_u32 s71, s71, 4096
    v_dot2_f32_bf16 v30, v64, s58, v30
    v_dot2_f32_bf16 v31, v68, s58, v31
    v_dot2_f32_bf16 v30, v65, s58, v30
    v_dot2_f32_bf16 v31, v69, s58, v31
    v_dot2_f32_bf16 v30, v66, s58, v30
    v_dot2_f32_bf16 v31, v70, s58, v31
    v_dot2_f32_bf16 v30, v67, s58, v30
    v_dot2_f32_bf16 v31, v71, s58, v31
    s_waitcnt vmcnt(12)
    ds_read_b64_tr_b16 v[72:73], v33 offset:8192
    ds_read_b64_tr_b16 v[74:75], v33 offset:8704
    ds_read_b64_tr_b16 v[76:77], v34 offset:8192
    ds_read_b64_tr_b16 v[78:79], v34 offset:8704
    s_waitcnt lgkmcnt(0)
    buffer_store_dwordx4 v[72:75], v29, s[40:43], s68 offen offset:0 sc1
    buffer_store_dwordx4 v[76:79], v29, s[40:43], s71 offen offset:0 sc1
    v_dot2_f32_bf16 v30, v72, s58, v30
    v_dot2_f32_bf16 v31, v76, s58, v31
    v_dot2_f32_bf16 v30, v73, s58, v30
    v_dot2_f32_bf16 v31, v77, s58, v31
    v_dot2_f32_bf16 v30, v74, s58, v30
    v_dot2_f32_bf16 v31, v78, s58, v31
    v_dot2_f32_bf16 v30, v75, s58, v30
    v_dot2_f32_bf16 v31, v79, s58, v31
    s_waitcnt vmcnt(12)
    ds_read_b64_tr_b16 v[80:81], v33 offset:10240
    ds_read_b64_tr_b16 v[82:83], v33 offset:10752
    ds_read_b64_tr_b16 v[84:85], v34 offset:10240
    ds_read_b64_tr_b16 v[86:87], v34 offset:10752
    s_waitcnt lgkmcnt(0)
    buffer_store_dwordx4 v[80:83], v29, s[40:43], s68 offen offset:1024 sc1
    buffer_store_dwordx4 v[84:87], v29, s[40:43], s71 offen offset:1024 sc1
    v_dot2_f32_bf16 v30, v80, s58, v30
    v_dot2_f32_bf16 v31, v84, s58, v31
    v_dot2_f32_bf16 v30, v81, s58, v30
    v_dot2_f32_bf16 v31, v85, s58, v31
    v_dot2_f32_bf16 v30, v82, s58, v30
    v_dot2_f32_bf16 v31, v86, s58, v31
    v_dot2_f32_bf16 v30, v83, s58, v30
    v_dot2_f32_bf16 v31, v87, s58, v31
    s_waitcnt vmcnt(12)
    ds_read_b64_tr_b16 v[88:89], v33 offset:12288
    ds_read_b64_tr_b16 v[90:91], v33 offset:12800
    ds_read_b64_tr_b16 v[92:93], v34 offset:12288
    ds_read_b64_tr_b16 v[94:95], v34 offset:12800
    s_waitcnt lgkmcnt(0)
    buffer_store_dwordx4 v[88:91], v29, s[40:43], s68 offen offset:2048 sc1
    buffer_store_dwordx4 v[92:95], v29, s[40:43], s71 offen offset:2048 sc1
    v_dot2_f32_bf16 v30, v88, s58, v30
    v_dot2_f32_bf16 v31, v92, s58, v31
    v_dot2_f32_bf16 v30, v89, s58, v30
    v_dot2_f32_bf16 v31, v93, s58, v31
    v_dot2_f32_bf16 v30, v90, s58, v30
    v_dot2_f32_bf16 v31, v94, s58, v31
    v_dot2_f32_bf16 v30, v91, s58, v30
    v_dot2_f32_bf16 v31, v95, s58, v31
    s_nop 2
    v_permlane32_swap_b32 v30, v31
    v_add_f32 v30, v30, v31
    v_lshlrev_b32 v31, 2, v0
    v_add_u32 v31, 90112, v31
    ds_write_b32 v31, v30
    v_lshlrev_b32 v31, 2, v1
    v_add_u32 v32, 90112, v31
    v_lshrrev_b32 v24, 2, v1
    v_mul_u32_u24 v24, 896, v24
    v_and_b32 v25, 3, v1
    v_lshl_add_u32 v24, v25, 4, v24
    v_add_u32 v24, 57344, v24
    s_waitcnt lgkmcnt(0)
    s_barrier
    s_cmp_lg_u32 s3, 0
    s_cbranch_scc1 L_AUX_NOCS
    ds_read_b32 v36, v32 offset:256
    ds_read_b32 v37, v32 offset:512
    ds_read_b32 v38, v32 offset:768
    s_lshl_b32 s59, s53, 8
    s_add_u32 s59, s59, 671744
    s_waitcnt lgkmcnt(0)
    v_add_f32 v30, v30, v36
    v_add_f32 v37, v37, v38
    v_add_f32 v30, v30, v37
    buffer_store_dword v30, v31, s[40:43], s59 offen sc1
L_AUX_NOCS:
    s_mul_i32 s62, s53, 28672
    s_mul_i32 s63, s3, 7168
    s_add_u32 s62, s62, s63
    s_add_u32 s63, s63, 57344
    s_mov_b32 m0, s63
    s_add_u32 s63, s63, 1024
    buffer_load_dwordx4 v29, s[48:51], s62 offen lds
    s_add_u32 s62, s62, 1024
    s_mov_b32 m0, s63
    s_add_u32 s63, s63, 1024
    buffer_load_dwordx4 v29, s[48:51], s62 offen lds
    s_add_u32 s62, s62, 1024
    s_mov_b32 m0, s63
    s_add_u32 s63, s63, 1024
    buffer_load_dwordx4 v29, s[48:51], s62 offen lds
    s_add_u32 s62, s62, 1024
    s_mov_b32 m0, s63
    s_add_u32 s63, s63, 1024
    buffer_load_dwordx4 v29, s[48:51], s62 offen lds
    s_add_u32 s62, s62, 1024
    s_mov_b32 m0, s63
    s_add_u32 s63, s63, 1024
    buffer_load_dwordx4 v29, s[48:51], s62 offen lds
    s_add_u32 s62, s62, 1024
    s_mov_b32 m0, s63
    s_add_u32 s63, s63, 1024
    buffer_load_dwordx4 v29, s[48:51], s62 offen lds
    s_add_u32 s62, s62, 1024
    s_mov_b32 m0, s63
    s_add_u32 s63, s63, 1024
    buffer_load_dwordx4 v29, s[48:51], s62 offen lds
    s_add_u32 s62, s62, 1024
    s_lshl_b32 s63, s53, 7
    s_add_u32 s63, s63, 147456
    s_waitcnt vmcnt(7)
    s_barrier
    s_cmp_lg_u32 s3, 0
    s_cbranch_scc1 L_AUX_NF1
    v_mov_b32 v30, s52
    s_mov_b64 exec, 1
    buffer_store_dword v30, off, s[40:43], s63 sc1
    s_mov_b64 exec, -1
L_AUX_NF1:
    s_waitcnt vmcnt(0)
    s_barrier
    s_mul_i32 s59, s3, 7
    s_add_u32 s59, s59, 0
    s_lshr_b32 s62, s59, 1
    s_lshl_b32 s62, s62, 6
    s_and_b32 s59, s59, 1
    s_lshl_b32 s59, s59, 3
    s_add_u32 s59, s59, s62
    v_add_u32 v25, s59, v24
    ds_read_b64_tr_b16 v[100:101], v25 offset:0
    ds_read_b64_tr_b16 v[102:103], v25 offset:14336
    s_mul_i32 s59, s3, 7
    s_add_u32 s59, s59, 1
    s_lshr_b32 s62, s59, 1
    s_lshl_b32 s62, s62, 6
    s_and_b32 s59, s59, 1
    s_lshl_b32 s59, s59, 3
    s_add_u32 s59, s59, s62
    v_add_u32 v25, s59, v24
    ds_read_b64_tr_b16 v[104:105], v25 offset:0
    ds_read_b64_tr_b16 v[106:107], v25 offset:14336
    s_mul_i32 s59, s3, 7
    s_add_u32 s59, s59, 2
    s_lshr_b32 s62, s59, 1
    s_lshl_b32 s62, s62, 6
    s_and_b32 s59, s59, 1
    s_lshl_b32 s59, s59, 3
    s_add_u32 s59, s59, s62
    v_add_u32 v25, s59, v24
    ds_read_b64_tr_b16 v[108:109], v25 offset:0
    ds_read_b64_tr_b16 v[110:111], v25 offset:14336
    s_mul_i32 s59, s3, 7
    s_add_u32 s59, s59, 3
    s_lshr_b32 s62, s59, 1
    s_lshl_b32 s62, s62, 6
    s_and_b32 s59, s59, 1
    s_lshl_b32 s59, s59, 3
    s_add_u32 s59, s59, s62
    v_add_u32 v25, s59, v24
    ds_read_b64_tr_b16 v[112:113], v25 offset:0
    ds_read_b64_tr_b16 v[114:115], v25 offset:14336
    s_mul_i32 s59, s3, 7
    s_add_u32 s59, s59, 4
    s_lshr_b32 s62, s59, 1
    s_lshl_b32 s62, s62, 6
    s_and_b32 s59, s59, 1
    s_lshl_b32 s59, s59, 3
    s_add_u32 s59, s59, s62
    v_add_u32 v25, s59, v24
    ds_read_b64_tr_b16 v[116:117], v25 offset:0
    ds_read_b64_tr_b16 v[118:119], v25 offset:14336
    s_mul_i32 s59, s3, 7
    s_add_u32 s59, s59, 5
    s_lshr_b32 s62, s59, 1
    s_lshl_b32 s62, s62, 6
    s_and_b32 s59, s59, 1
    s_lshl_b32 s59, s59, 3
    s_add_u32 s59, s59, s62
    v_add_u32 v25, s59, v24
    ds_read_b64_tr_b16 v[120:121], v25 offset:0
    ds_read_b64_tr_b16 v[122:123], v25 offset:14336
    s_mul_i32 s59, s3, 7
    s_add_u32 s59, s59, 6
    s_lshr_b32 s62, s59, 1
    s_lshl_b32 s62, s62, 6
    s_and_b32 s59, s59, 1
    s_lshl_b32 s59, s59, 3
    s_add_u32 s59, s59, s62
    v_add_u32 v25, s59, v24
    ds_read_b64_tr_b16 v[124:125], v25 offset:0
    ds_read_b64_tr_b16 v[126:127], v25 offset:14336
    s_waitcnt lgkmcnt(0)
    s_mul_i32 s59, s3, 7
    s_add_u32 s59, s59, 0
    s_lshr_b32 s62, s59, 2
    s_and_b32 s59, s59, 3
    s_mul_i32 s62, s62, 28
    s_add_u32 s62, s62, s53
    s_lshl_b32 s62, s62, 2
    s_add_u32 s62, s62, s59
    s_lshl_b32 s62, s62, 10
    s_add_u32 s62, s62, 4521984
    buffer_store_dwordx4 v[100:103], v29, s[40:43], s62 offen sc1
    s_mul_i32 s59, s3, 7
    s_add_u32 s59, s59, 1
    s_lshr_b32 s62, s59, 2
    s_and_b32 s59, s59, 3
    s_mul_i32 s62, s62, 28
    s_add_u32 s62, s62, s53
    s_lshl_b32 s62, s62, 2
    s_add_u32 s62, s62, s59
    s_lshl_b32 s62, s62, 10
    s_add_u32 s62, s62, 4521984
    buffer_store_dwordx4 v[104:107], v29, s[40:43], s62 offen sc1
    s_mul_i32 s59, s3, 7
    s_add_u32 s59, s59, 2
    s_lshr_b32 s62, s59, 2
    s_and_b32 s59, s59, 3
    s_mul_i32 s62, s62, 28
    s_add_u32 s62, s62, s53
    s_lshl_b32 s62, s62, 2
    s_add_u32 s62, s62, s59
    s_lshl_b32 s62, s62, 10
    s_add_u32 s62, s62, 4521984
    buffer_store_dwordx4 v[108:111], v29, s[40:43], s62 offen sc1
    s_mul_i32 s59, s3, 7
    s_add_u32 s59, s59, 3
    s_lshr_b32 s62, s59, 2
    s_and_b32 s59, s59, 3
    s_mul_i32 s62, s62, 28
    s_add_u32 s62, s62, s53
    s_lshl_b32 s62, s62, 2
    s_add_u32 s62, s62, s59
    s_lshl_b32 s62, s62, 10
    s_add_u32 s62, s62, 4521984
    buffer_store_dwordx4 v[112:115], v29, s[40:43], s62 offen sc1
    s_mul_i32 s59, s3, 7
    s_add_u32 s59, s59, 4
    s_lshr_b32 s62, s59, 2
    s_and_b32 s59, s59, 3
    s_mul_i32 s62, s62, 28
    s_add_u32 s62, s62, s53
    s_lshl_b32 s62, s62, 2
    s_add_u32 s62, s62, s59
    s_lshl_b32 s62, s62, 10
    s_add_u32 s62, s62, 4521984
    buffer_store_dwordx4 v[116:119], v29, s[40:43], s62 offen sc1
    s_mul_i32 s59, s3, 7
    s_add_u32 s59, s59, 5
    s_lshr_b32 s62, s59, 2
    s_and_b32 s59, s59, 3
    s_mul_i32 s62, s62, 28
    s_add_u32 s62, s62, s53
    s_lshl_b32 s62, s62, 2
    s_add_u32 s62, s62, s59
    s_lshl_b32 s62, s62, 10
    s_add_u32 s62, s62, 4521984
    buffer_store_dwordx4 v[120:123], v29, s[40:43], s62 offen sc1
    s_mul_i32 s59, s3, 7
    s_add_u32 s59, s59, 6
    s_lshr_b32 s62, s59, 2
    s_and_b32 s59, s59, 3
    s_mul_i32 s62, s62, 28
    s_add_u32 s62, s62, s53
    s_lshl_b32 s62, s62, 2
    s_add_u32 s62, s62, s59
    s_lshl_b32 s62, s62, 10
    s_add_u32 s62, s62, 4521984
    buffer_store_dwordx4 v[124:127], v29, s[40:43], s62 offen sc1
    s_add_u32 s63, s63, 4096
    s_waitcnt vmcnt(0)
    s_barrier
    s_cmp_lg_u32 s3, 0
    s_cbranch_scc1 L_RELAY
    v_mov_b32 v30, s52
    s_mov_b64 exec, 1
    buffer_store_dword v30, off, s[40:43], s63 sc1
    s_mov_b64 exec, -1
    s_branch L_RELAY
L_AUX_ST:
    s_waitcnt vmcnt(0)
    v_readfirstlane_b32 s52, v20
    s_nop 0
    s_add_u32 s52, s52, 1
    s_or_b32 s52, s52, 0xffc00000
    v_dot2_f32_bf16 v30, v2, s58, 0
    v_dot2_f32_bf16 v31, v2, v2, 0
    v_dot2_f32_bf16 v36, v6, s58, 0
    v_dot2_f32_bf16 v37, v6, v6, 0
    v_dot2_f32_bf16 v30, v3, s58, v30
    v_dot2_f32_bf16 v31, v3, v3, v31
    v_dot2_f32_bf16 v36, v7, s58, v36
    v_dot2_f32_bf16 v37, v7, v7, v37
    v_dot2_f32_bf16 v30, v4, s58, v30
    v_dot2_f32_bf16 v31, v4, v4, v31
    v_dot2_f32_bf16 v36, v8, s58, v36
    v_dot2_f32_bf16 v37, v8, v8, v37
    v_dot2_f32_bf16 v30, v5, s58, v30
    v_dot2_f32_bf16 v31, v5, v5, v31
    v_dot2_f32_bf16 v36, v9, s58, v36
    v_dot2_f32_bf16 v37, v9, v9, v37
    s_nop 1
    v_permlane32_swap_b32 v30, v36
    v_permlane32_swap_b32 v31, v37
    v_add_f32 v30, v30, v36
    v_add_f32 v31, v31, v37
    s_nop 0
    v_add_f32_dpp v30, v30, v30 row_shr:1 row_mask:0xf bank_mask:0xf bound_ctrl:0
    v_add_f32_dpp v31, v31, v31 row_shr:1 row_mask:0xf bank_mask:0xf bound_ctrl:0
    s_nop 0
    v_add_f32_dpp v30, v30, v30 row_shr:2 row_mask:0xf bank_mask:0xf bound_ctrl:0
    v_add_f32_dpp v31, v31, v31 row_shr:2 row_mask:0xf bank_mask:0xf bound_ctrl:0
    s_nop 0
    v_add_f32_dpp v30, v30, v30 row_shr:4 row_mask:0xf bank_mask:0xf bound_ctrl:0
    v_add_f32_dpp v31, v31, v31 row_shr:4 row_mask:0xf bank_mask:0xf bound_ctrl:0
    s_nop 0
    v_add_f32_dpp v30, v30, v30 row_shr:8 row_mask:0xf bank_mask:0xf bound_ctrl:0
    v_add_f32_dpp v31, v31, v31 row_shr:8 row_mask:0xf bank_mask:0xf bound_ctrl:0
    s_nop 0
    v_add_f32_dpp v30, v30, v30 row_bcast:15 row_mask:0xa bank_mask:0xf
    v_add_f32_dpp v31, v31, v31 row_bcast:15 row_mask:0xa bank_mask:0xf
    v_mul_f32 v30, 0x3b124925, v30
    v_mul_f32 v31, 0x3b124925, v31
    v_fma_f32 v31, -v30, v30, v31
    v_max_f32 v31, 0, v31
    v_cvt_pk_bf16_f32 v31, v31, v31
    v_and_b32 v31, 0xffff0000, v31
    v_add_f32 v31, 0x3727c5ac, v31
    v_cvt_pk_bf16_f32 v31, v31, v31
    v_and_b32 v31, 0xffff0000, v31
    v_sqrt_f32 v31, v31
    v_lshrrev_b32 v20, 5, v0
    v_lshlrev_b32 v20, 3, v20
    v_cvt_pk_bf16_f32 v36, v30, v31
    v_mov_b32 v37, s52
    s_lshl_b32 s59, s57, 4
    s_lshr_b32 s69, s56, 1
    s_add_u32 s59, s59, s69
    s_mul_i32 s59, s59, 2176
    s_and_b32 s69, s56, 1
    s_lshl_b32 s69, s69, 6
    s_add_u32 s59, s59, s69
    s_add_u32 s59, s59, 1572864
    s_mov_b32 exec_lo, 0x80000000
    s_mov_b32 exec_hi, 0x80000000
    buffer_store_dwordx2 v[36:37], v20, s[40:43], s59 offen sc1
    s_mov_b64 exec, -1
    v_mov_b32 v20, 151552
    s_mov_b32 s59, 0
L_APW:
    buffer_load_dword v21, v20, s[40:43], 0 offen sc1
    s_add_u32 s59, s59, 1
    s_waitcnt vmcnt(0)
    v_cmpx_ne_u32 vcc, s52, v21
    s_cmp_gt_u32 s59, 65536
    s_cbranch_scc1 L_APW_y
    s_cbranch_vccnz L_APW
L_APW_y:
    s_mov_b64 exec, -1
L_APW_x:
L_RELAY:
    s_mov_b32 s44, s26
    s_mov_b32 s45, s27
    s_mov_b32 s46, 8388608
    v_lshrrev_b32 v20, 3, v1
    v_lshlrev_b32 v20, 12, v20
    v_and_b32 v21, 7, v1
    v_lshl_add_u32 v20, v21, 7, v20
    s_lshr_b32 s59, s57, 1
    s_lshl_b32 s59, s59, 2
    s_add_u32 s59, s59, s56
    s_sub_u32 s59, s59, 28
    s_lshl_b32 s59, s59, 19
    s_lshl_b32 s62, s3, 10
    s_add_u32 s59, s59, s62
    s_add_u32 s62, s3, 2
    s_and_b32 s62, s62, 3
    s_lshl_b32 s62, s62, 16
    s_add_u32 s62, s62, s59
    s_add_u32 s64, s62, 0
    buffer_load_dword v22, v20, s[44:47], s64 offen
    s_add_u32 s64, s62, 32768
    buffer_load_dword v23, v20, s[44:47], s64 offen
    s_add_u32 s64, s62, 262144
    buffer_load_dword v24, v20, s[44:47], s64 offen
    s_add_u32 s64, s62, 294912
    buffer_load_dword v25, v20, s[44:47], s64 offen
    s_add_u32 s62, s3, 3
    s_and_b32 s62, s62, 3
    s_lshl_b32 s62, s62, 16
    s_add_u32 s62, s62, s59
    s_add_u32 s64, s62, 0
    buffer_load_dword v26, v20, s[44:47], s64 offen
    s_add_u32 s64, s62, 32768
    buffer_load_dword v27, v20, s[44:47], s64 offen
    s_add_u32 s64, s62, 262144
    buffer_load_dword v28, v20, s[44:47], s64 offen
    s_add_u32 s64, s62, 294912
    buffer_load_dword v29, v20, s[44:47], s64 offen
    v_min_u32 v21, 27, v1
    v_lshlrev_b32 v21, 7, v21
    v_add_u32 v21, 151552, v21
    s_mov_b32 s59, 0
L_APO:
    buffer_load_dword v30, v21, s[40:43], 0 offen sc1
    s_add_u32 s59, s59, 1
    s_waitcnt vmcnt(0)
    v_cmpx_ne_u32 vcc, s52, v30
    s_cmp_gt_u32 s59, 65536
    s_cbranch_scc1 L_APO_y
    s_cbranch_vccnz L_APO
L_APO_y:
    s_mov_b64 exec, -1
L_APO_x:
    s_and_b32 s59, s57, 1
    s_lshl_b32 s59, s59, 2
    s_add_u32 s59, s59, s3
    s_cmp_eq_u32 s3, 3
    s_cselect_b32 s59, 3, s59
    s_mul_i32 s59, s59, 114688
    s_sub_u32 s62, s56, 28
    s_mul_i32 s62, s62, 28672
    s_add_u32 s59, s59, s62
    s_add_u32 s59, s59, 4521984
    v_min_u32 v21, 55, v1
    v_lshlrev_b32_e64 v21, 7, v21
    buffer_load_dword v32, v21, s[40:43], s59 offen sc1
    s_add_u32 s59, s59, 7168
    buffer_load_dword v33, v21, s[40:43], s59 offen sc1
    s_add_u32 s59, s59, 7168
    buffer_load_dword v34, v21, s[40:43], s59 offen sc1
    s_add_u32 s59, s59, 7168
    buffer_load_dword v35, v21, s[40:43], s59 offen sc1
    s_add_u32 s59, s59, 7168
    s_waitcnt vmcnt(0)
    s_branch L_FIN
.p2align 8
L_TBL:
.long 8704,8704,8704,8704,8636,8636,8636,8636
.long 8568,8568,8568,8568,8500,8500,8500,8500
.long 8432,8432,8432,8432,8364,8364,8364,8364
.long 8296,8296,8296,8296,8228,8228,8228,8228
.long 8160,8160,8160,8160,8092,8092,8092,8092
.long 8024,8024,8024,8024,7956,7956,7956,7956
.long 7888,7888,7888,7888,7820,7820,7820,7820
.long 7752,7752,7752,7752,7684,7684,7684,7684
.long 7616,7616,7616,7616,7548,7548,7548,7548
.long 7480,7480,7480,7480,7412,7412,7412,7412
.long 7344,7344,7344,7344,7276,7276,7276,7276
.long 7208,7208,7208,7208,7140,7140,7140,7140
.long 7072,7072,7072,7072,7004,7004,7004,7004
.long 6936,6936,6936,6936,6868,6868,6868,6868
.long 6800,6800,6800,6800,6732,6732,6732,6732
.long 6664,6664,6664,6664,6596,6596,6596,6596
.long 6528,6528,6528,6528,6460,6460,6460,6460
.long 6392,6392,6392,6392,6324,6324,6324,6324
.long 6256,6256,6256,6256,6188,6188,6188,6188
.long 6120,6120,6120,6120,6052,6052,6052,6052
.long 5984,5984,5984,5984,5916,5916,5916,5916
.long 5848,5848,5848,5848,5780,5780,5780,5780
.long 5712,5712,5712,5712,5644,5644,5644,5644
.long 5576,5576,5576,5576,5508,5508,5508,5508
.long 5440,5440,5440,5440,5372,5372,5372,5372
.long 5304,5304,5304,5304,5236,5236,5236,5236
.long 5168,5168,5168,5168,5100,5100,5100,5100
.long 5032,5032,5032,5032,4964,4964,4964,4964
.long 4896,4896,4896,4896,4828,4828,4828,4828
.long 4760,4760,4760,4760,4692,4692,4692,4692
.long 4624,4624,4624,4624,4556,4556,4556,4556
.long 4488,4488,4488,4488,4420,4420,4420,4420
.long 4352,4352,4332,4332,4284,4284,4264,4264
.long 4216,4216,4196,4196,4148,4148,4128,4128
.long 4080,4080,4060,4060,4012,4012,3992,3992
.long 3944,3944,3924,3924,3876,3876,3856,3856
.long 3808,3808,3788,3788,3740,3740,3720,3720
.long 3672,3672,3652,3652,3604,3604,3584,3584
.long 3536,3536,3516,3516,3468,3468,3448,3448
.long 3400,3400,3380,3380,3332,3332,3312,3312
.long 3264,3264,3244,3244,3196,3196,3176,3176
.long 3128,3128,3108,3108,3060,3060,3040,3040
.long 2992,2992,2972,2972,2924,2924,2904,2904
.long 2856,2856,2836,2836,2788,2788,2768,2768
.long 2720,2720,2700,2700,2652,2652,2632,2632
.long 2584,2584,2564,2564,2516,2516,2496,2496
.long 2448,2448,2428,2428,2380,2380,2360,2360
.long 2312,2312,2292,2292,2244,2244,2224,2224
.long 2176,2164,2156,2156,2108,2096,2088,2088
.long 2040,2028,2020,2020,1972,1960,1952,1952
.long 1904,1892,1884,1884,1836,1824,1816,1816
.long 1768,1756,1748,1748,1700,1688,1680,1680
.long 1632,1620,1612,1612,1564,1552,1544,1544
.long 1496,1484,1476,1476,1428,1416,1408,1408
.long 1360,1348,1340,1340,1292,1280,1272,1272
.long 1224,1212,1204,1204,1156,1144,1136,1136
.long 1080,1076,1072,1068,1012,1008,1004,1000
.long 944,940,936,932,876,872,868,864
.long 808,804,800,796,740,736,732,728
.long 672,668,664,660,604,600,596,592
.long 536,532,528,524,468,464,460,456
.long 400,396,392,388,332,328,324,320
.long 264,260,256,252,196,192,188,184
.long 128,124,120,116,60,56,52,48
.long 31552,31552,31552,31552,31484,31484,31484,31484
.long 31416,31416,31416,31416,31348,31348,31348,31348
.long 31280,31280,31280,31280,31212,31212,31212,31212
.long 31144,31144,31144,31144,31076,31076,31076,31076
.long 31008,31008,31008,31008,30940,30940,30940,30940
.long 30872,30872,30872,30872,30804,30804,30804,30804
.long 30736,30736,30736,30736,30668,30668,30668,30668
.long 30600,30600,30600,30600,30532,30532,30532,30532
.long 30464,30464,30464,30464,30396,30396,30396,30396
.long 30328,30328,30328,30328,30260,30260,30260,30260
.long 30192,30192,30192,30192,30124,30124,30124,30124
.long 30056,30056,30056,30056,29988,29988,29988,29988
.long 29920,29920,29920,29920,29852,29852,29852,29852
.long 29784,29784,29784,29784,29716,29716,29716,29716
.long 29648,29648,29648,29648,29580,29580,29580,29580
.long 29512,29512,29512,29512,29444,29444,29444,29444
.long 29376,29376,29376,29376,29308,29308,29308,29308
.long 29240,29240,29240,29240,29172,29172,29172,29172
.long 29104,29104,29104,29104,29036,29036,29036,29036
.long 28968,28968,28968,28968,28900,28900,28900,28900
.long 28832,28832,28832,28832,28764,28764,28764,28764
.long 28696,28696,28696,28696,28628,28628,28628,28628
.long 28560,28560,28560,28560,28492,28492,28492,28492
.long 28424,28424,28424,28424,28356,28356,28356,28356
.long 28288,28288,28288,28288,28220,28220,28220,28220
.long 28152,28152,28152,28152,28084,28084,28084,28084
.long 28016,28016,28016,28016,27948,27948,27948,27948
.long 27880,27880,27880,27880,27812,27812,27812,27812
.long 27744,27744,27744,27744,27676,27676,27676,27676
.long 27608,27608,27608,27608,27540,27540,27540,27540
.long 27472,27472,27472,27472,27404,27404,27404,27404
.long 27336,27336,27336,27336,27268,27268,27268,27268
.long 27200,27200,27180,27180,27132,27132,27112,27112
.long 27064,27064,27044,27044,26996,26996,26976,26976
.long 26928,26928,26908,26908,26860,26860,26840,26840
.long 26792,26792,26772,26772,26724,26724,26704,26704
.long 26656,26656,26636,26636,26588,26588,26568,26568
.long 26520,26520,26500,26500,26452,26452,26432,26432
.long 26384,26384,26364,26364,26316,26316,26296,26296
.long 26248,26248,26228,26228,26180,26180,26160,26160
.long 26112,26112,26092,26092,26044,26044,26024,26024
.long 25976,25976,25956,25956,25908,25908,25888,25888
.long 25840,25840,25820,25820,25772,25772,25752,25752
.long 25704,25704,25684,25684,25636,25636,25616,25616
.long 25568,25568,25548,25548,25500,25500,25480,25480
.long 25432,25432,25412,25412,25364,25364,25344,25344
.long 25296,25296,25276,25276,25228,25228,25208,25208
.long 25160,25160,25140,25140,25092,25092,25072,25072
.long 25024,25012,25004,25004,24956,24944,24936,24936
.long 24888,24876,24868,24868,24820,24808,24800,24800
.long 24752,24740,24732,24732,24684,24672,24664,24664
.long 24616,24604,24596,24596,24548,24536,24528,24528
.long 24480,24468,24460,24460,24412,24400,24392,24392
.long 24344,24332,24324,24324,24276,24264,24256,24256
.long 24208,24196,24188,24188,24140,24128,24120,24120
.long 24072,24060,24052,24052,24004,23992,23984,23984
.long 23928,23924,23920,23916,23860,23856,23852,23848
.long 23792,23788,23784,23780,23724,23720,23716,23712
.long 23656,23652,23648,23644,23588,23584,23580,23576
.long 23520,23516,23512,23508,23452,23448,23444,23440
.long 23384,23380,23376,23372,23316,23312,23308,23304
.long 23248,23244,23240,23236,23180,23176,23172,23168
.long 23112,23108,23104,23100,23044,23040,23036,23032
.long 22976,22972,22968,22964,22908,22904,22900,22896
.long 8668,8668,8668,8668,8600,8600,8600,8600
.long 8532,8532,8532,8532,8464,8464,8464,8464
.long 8396,8396,8396,8396,8328,8328,8328,8328
.long 8260,8260,8260,8260,8192,8192,8192,8192
.long 8124,8124,8124,8124,8056,8056,8056,8056
.long 7988,7988,7988,7988,7920,7920,7920,7920
.long 7852,7852,7852,7852,7784,7784,7784,7784
.long 7716,7716,7716,7716,7648,7648,7648,7648
.long 7580,7580,7580,7580,7512,7512,7512,7512
.long 7444,7444,7444,7444,7376,7376,7376,7376
.long 7308,7308,7308,7308,7240,7240,7240,7240
.long 7172,7172,7172,7172,7104,7104,7104,7104
.long 7036,7036,7036,7036,6968,6968,6968,6968
.long 6900,6900,6900,6900,6832,6832,6832,6832
.long 6764,6764,6764,6764,6696,6696,6696,6696
.long 6628,6628,6628,6628,6560,6560,6560,6560
.long 6492,6492,6492,6492,6424,6424,6424,6424
.long 6356,6356,6356,6356,6288,6288,6288,6288
.long 6220,6220,6220,6220,6152,6152,6152,6152
.long 6084,6084,6084,6084,6016,6016,6016,6016
.long 5948,5948,5948,5948,5880,5880,5880,5880
.long 5812,5812,5812,5812,5744,5744,5744,5744
.long 5676,5676,5676,5676,5608,5608,5608,5608
.long 5540,5540,5540,5540,5472,5472,5472,5472
.long 5404,5404,5404,5404,5336,5336,5336,5336
.long 5268,5268,5268,5268,5200,5200,5200,5200
.long 5132,5132,5132,5132,5064,5064,5064,5064
.long 4996,4996,4996,4996,4928,4928,4928,4928
.long 4860,4860,4860,4860,4792,4792,4792,4792
.long 4724,4724,4724,4724,4656,4656,4656,4656
.long 4588,4588,4588,4588,4520,4520,4520,4520
.long 4452,4452,4452,4452,4384,4384,4384,4384
.long 4332,4316,4316,4316,4264,4248,4248,4248
.long 4196,4180,4180,4180,4128,4112,4112,4112
.long 4060,4044,4044,4044,3992,3976,3976,3976
.long 3924,3908,3908,3908,3856,3840,3840,3840
.long 3788,3772,3772,3772,3720,3704,3704,3704
.long 3652,3636,3636,3636,3584,3568,3568,3568
.long 3516,3500,3500,3500,3448,3432,3432,3432
.long 3380,3364,3364,3364,3312,3296,3296,3296
.long 3244,3228,3228,3228,3176,3160,3160,3160
.long 3108,3092,3092,3092,3040,3024,3024,3024
.long 2972,2956,2956,2956,2904,2888,2888,2888
.long 2836,2820,2820,2820,2768,2752,2752,2752
.long 2700,2684,2684,2684,2632,2616,2616,2616
.long 2564,2548,2548,2548,2496,2480,2480,2480
.long 2428,2412,2412,2412,2360,2344,2344,2344
.long 2292,2276,2276,2276,2224,2208,2208,2208
.long 2156,2148,2140,2140,2088,2080,2072,2072
.long 2020,2012,2004,2004,1952,1944,1936,1936
.long 1884,1876,1868,1868,1816,1808,1800,1800
.long 1748,1740,1732,1732,1680,1672,1664,1664
.long 1612,1604,1596,1596,1544,1536,1528,1528
.long 1476,1468,1460,1460,1408,1400,1392,1392
.long 1340,1332,1324,1324,1272,1264,1256,1256
.long 1204,1196,1188,1188,1136,1128,1120,1120
.long 1064,1060,1056,1052,996,992,988,984
.long 928,924,920,916,860,856,852,848
.long 792,788,784,780,724,720,716,712
.long 656,652,648,644,588,584,580,576
.long 520,516,512,508,452,448,444,440
.long 384,380,376,372,316,312,308,304
.long 248,244,240,236,180,176,172,168
.long 112,108,104,100,44,40,36,32
.long 31516,31516,31516,31516,31448,31448,31448,31448
.long 31380,31380,31380,31380,31312,31312,31312,31312
.long 31244,31244,31244,31244,31176,31176,31176,31176
.long 31108,31108,31108,31108,31040,31040,31040,31040
.long 30972,30972,30972,30972,30904,30904,30904,30904
.long 30836,30836,30836,30836,30768,30768,30768,30768
.long 30700,30700,30700,30700,30632,30632,30632,30632
.long 30564,30564,30564,30564,30496,30496,30496,30496
.long 30428,30428,30428,30428,30360,30360,30360,30360
.long 30292,30292,30292,30292,30224,30224,30224,30224
.long 30156,30156,30156,30156,30088,30088,30088,30088
.long 30020,30020,30020,30020,29952,29952,29952,29952
.long 29884,29884,29884,29884,29816,29816,29816,29816
.long 29748,29748,29748,29748,29680,29680,29680,29680
.long 29612,29612,29612,29612,29544,29544,29544,29544
.long 29476,29476,29476,29476,29408,29408,29408,29408
.long 29340,29340,29340,29340,29272,29272,29272,29272
.long 29204,29204,29204,29204,29136,29136,29136,29136
.long 29068,29068,29068,29068,29000,29000,29000,29000
.long 28932,28932,28932,28932,28864,28864,28864,28864
.long 28796,28796,28796,28796,28728,28728,28728,28728
.long 28660,28660,28660,28660,28592,28592,28592,28592
.long 28524,28524,28524,28524,28456,28456,28456,28456
.long 28388,28388,28388,28388,28320,28320,28320,28320
.long 28252,28252,28252,28252,28184,28184,28184,28184
.long 28116,28116,28116,28116,28048,28048,28048,28048
.long 27980,27980,27980,27980,27912,27912,27912,27912
.long 27844,27844,27844,27844,27776,27776,27776,27776
.long 27708,27708,27708,27708,27640,27640,27640,27640
.long 27572,27572,27572,27572,27504,27504,27504,27504
.long 27436,27436,27436,27436,27368,27368,27368,27368
.long 27300,27300,27300,27300,27232,27232,27232,27232
.long 27180,27164,27164,27164,27112,27096,27096,27096
.long 27044,27028,27028,27028,26976,26960,26960,26960
.long 26908,26892,26892,26892,26840,26824,26824,26824
.long 26772,26756,26756,26756,26704,26688,26688,26688
.long 26636,26620,26620,26620,26568,26552,26552,26552
.long 26500,26484,26484,26484,26432,26416,26416,26416
.long 26364,26348,26348,26348,26296,26280,26280,26280
.long 26228,26212,26212,26212,26160,26144,26144,26144
.long 26092,26076,26076,26076,26024,26008,26008,26008
.long 25956,25940,25940,25940,25888,25872,25872,25872
.long 25820,25804,25804,25804,25752,25736,25736,25736
.long 25684,25668,25668,25668,25616,25600,25600,25600
.long 25548,25532,25532,25532,25480,25464,25464,25464
.long 25412,25396,25396,25396,25344,25328,25328,25328
.long 25276,25260,25260,25260,25208,25192,25192,25192
.long 25140,25124,25124,25124,25072,25056,25056,25056
.long 25004,24996,24988,24988,24936,24928,24920,24920
.long 24868,24860,24852,24852,24800,24792,24784,24784
.long 24732,24724,24716,24716,24664,24656,24648,24648
.long 24596,24588,24580,24580,24528,24520,24512,24512
.long 24460,24452,24444,24444,24392,24384,24376,24376
.long 24324,24316,24308,24308,24256,24248,24240,24240
.long 24188,24180,24172,24172,24120,24112,24104,24104
.long 24052,24044,24036,24036,23984,23976,23968,23968
.long 23912,23908,23904,23900,23844,23840,23836,23832
.long 23776,23772,23768,23764,23708,23704,23700,23696
.long 23640,23636,23632,23628,23572,23568,23564,23560
.long 23504,23500,23496,23492,23436,23432,23428,23424
.long 23368,23364,23360,23356,23300,23296,23292,23288
.long 23232,23228,23224,23220,23164,23160,23156,23152
.long 23096,23092,23088,23084,23028,23024,23020,23016
.long 22960,22956,22952,22948,22892,22888,22884,22880
.long 8668,8668,8668,8636,8600,8600,8600,8568
.long 8532,8532,8532,8500,8464,8464,8464,8432
.long 8396,8396,8396,8364,8328,8328,8328,8296
.long 8260,8260,8260,8228,8192,8192,8192,8160
.long 8124,8124,8124,8092,8056,8056,8056,8024
.long 7988,7988,7988,7956,7920,7920,7920,7888
.long 7852,7852,7852,7820,7784,7784,7784,7752
.long 7716,7716,7716,7684,7648,7648,7648,7616
.long 7580,7580,7580,7548,7512,7512,7512,7480
.long 7444,7444,7444,7412,7376,7376,7376,7344
.long 7308,7308,7308,7276,7240,7240,7240,7208
.long 7172,7172,7172,7140,7104,7104,7104,7072
.long 7036,7036,7036,7004,6968,6968,6968,6936
.long 6900,6900,6900,6868,6832,6832,6832,6800
.long 6764,6764,6764,6732,6696,6696,6696,6664
.long 6628,6628,6628,6596,6560,6560,6560,6528
.long 6492,6492,6492,6460,6424,6424,6424,6392
.long 6356,6356,6356,6324,6288,6288,6288,6256
.long 6220,6220,6220,6188,6152,6152,6152,6120
.long 6084,6084,6084,6052,6016,6016,6016,5984
.long 5948,5948,5948,5916,5880,5880,5880,5848
.long 5812,5812,5812,5780,5744,5744,5744,5712
.long 5676,5676,5676,5644,5608,5608,5608,5576
.long 5540,5540,5540,5508,5472,5472,5472,5440
.long 5404,5404,5404,5372,5336,5336,5336,5304
.long 5268,5268,5268,5236,5200,5200,5200,5168
.long 5132,5132,5132,5100,5064,5064,5064,5032
.long 4996,4996,4996,4964,4928,4928,4928,4896
.long 4860,4860,4860,4828,4792,4792,4792,4760
.long 4724,4724,4724,4692,4656,4656,4656,4624
.long 4588,4588,4588,4556,4520,4520,4520,4488
.long 4452,4452,4452,4420,4384,4384,4384,4352
.long 4316,4316,4300,4300,4248,4248,4232,4232
.long 4180,4180,4164,4164,4112,4112,4096,4096
.long 4044,4044,4028,4028,3976,3976,3960,3960
.long 3908,3908,3892,3892,3840,3840,3824,3824
.long 3772,3772,3756,3756,3704,3704,3688,3688
.long 3636,3636,3620,3620,3568,3568,3552,3552
.long 3500,3500,3484,3484,3432,3432,3416,3416
.long 3364,3364,3348,3348,3296,3296,3280,3280
.long 3228,3228,3212,3212,3160,3160,3144,3144
.long 3092,3092,3076,3076,3024,3024,3008,3008
.long 2956,2956,2940,2940,2888,2888,2872,2872
.long 2820,2820,2804,2804,2752,2752,2736,2736
.long 2684,2684,2668,2668,2616,2616,2600,2600
.long 2548,2548,2532,2532,2480,2480,2464,2464
.long 2412,2412,2396,2396,2344,2344,2328,2328
.long 2276,2276,2260,2260,2208,2208,2192,2192
.long 2140,2132,2124,2124,2072,2064,2056,2056
.long 2004,1996,1988,1988,1936,1928,1920,1920
.long 1868,1860,1852,1852,1800,1792,1784,1784
.long 1732,1724,1716,1716,1664,1656,1648,1648
.long 1596,1588,1580,1580,1528,1520,1512,1512
.long 1460,1452,1444,1444,1392,1384,1376,1376
.long 1324,1316,1308,1308,1256,1248,1240,1240
.long 1188,1180,1172,1172,1120,1112,1104,1104
.long 1048,1044,1040,1036,980,976,972,968
.long 912,908,904,900,844,840,836,832
.long 776,772,768,764,708,704,700,696
.long 640,636,632,628,572,568,564,560
.long 504,500,496,492,436,432,428,424
.long 368,364,360,356,300,296,292,288
.long 232,228,224,220,164,160,156,152
.long 96,92,88,84,28,24,20,16
.long 31516,31516,31516,31484,31448,31448,31448,31416
.long 31380,31380,31380,31348,31312,31312,31312,31280
.long 31244,31244,31244,31212,31176,31176,31176,31144
.long 31108,31108,31108,31076,31040,31040,31040,31008
.long 30972,30972,30972,30940,30904,30904,30904,30872
.long 30836,30836,30836,30804,30768,30768,30768,30736
.long 30700,30700,30700,30668,30632,30632,30632,30600
.long 30564,30564,30564,30532,30496,30496,30496,30464
.long 30428,30428,30428,30396,30360,30360,30360,30328
.long 30292,30292,30292,30260,30224,30224,30224,30192
.long 30156,30156,30156,30124,30088,30088,30088,30056
.long 30020,30020,30020,29988,29952,29952,29952,29920
.long 29884,29884,29884,29852,29816,29816,29816,29784
.long 29748,29748,29748,29716,29680,29680,29680,29648
.long 29612,29612,29612,29580,29544,29544,29544,29512
.long 29476,29476,29476,29444,29408,29408,29408,29376
.long 29340,29340,29340,29308,29272,29272,29272,29240
.long 29204,29204,29204,29172,29136,29136,29136,29104
.long 29068,29068,29068,29036,29000,29000,29000,28968
.long 28932,28932,28932,28900,28864,28864,28864,28832
.long 28796,28796,28796,28764,28728,28728,28728,28696
.long 28660,28660,28660,28628,28592,28592,28592,28560
.long 28524,28524,28524,28492,28456,28456,28456,28424
.long 28388,28388,28388,28356,28320,28320,28320,28288
.long 28252,28252,28252,28220,28184,28184,28184,28152
.long 28116,28116,28116,28084,28048,28048,28048,28016
.long 27980,27980,27980,27948,27912,27912,27912,27880
.long 27844,27844,27844,27812,27776,27776,27776,27744
.long 27708,27708,27708,27676,27640,27640,27640,27608
.long 27572,27572,27572,27540,27504,27504,27504,27472
.long 27436,27436,27436,27404,27368,27368,27368,27336
.long 27300,27300,27300,27268,27232,27232,27232,27200
.long 27164,27164,27148,27148,27096,27096,27080,27080
.long 27028,27028,27012,27012,26960,26960,26944,26944
.long 26892,26892,26876,26876,26824,26824,26808,26808
.long 26756,26756,26740,26740,26688,26688,26672,26672
.long 26620,26620,26604,26604,26552,26552,26536,26536
.long 26484,26484,26468,26468,26416,26416,26400,26400
.long 26348,26348,26332,26332,26280,26280,26264,26264
.long 26212,26212,26196,26196,26144,26144,26128,26128
.long 26076,26076,26060,26060,26008,26008,25992,25992
.long 25940,25940,25924,25924,25872,25872,25856,25856
.long 25804,25804,25788,25788,25736,25736,25720,25720
.long 25668,25668,25652,25652,25600,25600,25584,25584
.long 25532,25532,25516,25516,25464,25464,25448,25448
.long 25396,25396,25380,25380,25328,25328,25312,25312
.long 25260,25260,25244,25244,25192,25192,25176,25176
.long 25124,25124,25108,25108,25056,25056,25040,25040
.long 24988,24980,24972,24972,24920,24912,24904,24904
.long 24852,24844,24836,24836,24784,24776,24768,24768
.long 24716,24708,24700,24700,24648,24640,24632,24632
.long 24580,24572,24564,24564,24512,24504,24496,24496
.long 24444,24436,24428,24428,24376,24368,24360,24360
.long 24308,24300,24292,24292,24240,24232,24224,24224
.long 24172,24164,24156,24156,24104,24096,24088,24088
.long 24036,24028,24020,24020,23968,23960,23952,23952
.long 23896,23892,23888,23884,23828,23824,23820,23816
.long 23760,23756,23752,23748,23692,23688,23684,23680
.long 23624,23620,23616,23612,23556,23552,23548,23544
.long 23488,23484,23480,23476,23420,23416,23412,23408
.long 23352,23348,23344,23340,23284,23280,23276,23272
.long 23216,23212,23208,23204,23148,23144,23140,23136
.long 23080,23076,23072,23068,23012,23008,23004,23000
.long 22944,22940,22936,22932,22876,22872,22868,22864
.long 8636,8636,8636,8636,8568,8568,8568,8568
.long 8500,8500,8500,8500,8432,8432,8432,8432
.long 8364,8364,8364,8364,8296,8296,8296,8296
.long 8228,8228,8228,8228,8160,8160,8160,8160
.long 8092,8092,8092,8092,8024,8024,8024,8024
.long 7956,7956,7956,7956,7888,7888,7888,7888
.long 7820,7820,7820,7820,7752,7752,7752,7752
.long 7684,7684,7684,7684,7616,7616,7616,7616
.long 7548,7548,7548,7548,7480,7480,7480,7480
.long 7412,7412,7412,7412,7344,7344,7344,7344
.long 7276,7276,7276,7276,7208,7208,7208,7208
.long 7140,7140,7140,7140,7072,7072,7072,7072
.long 7004,7004,7004,7004,6936,6936,6936,6936
.long 6868,6868,6868,6868,6800,6800,6800,6800
.long 6732,6732,6732,6732,6664,6664,6664,6664
.long 6596,6596,6596,6596,6528,6528,6528,6528
.long 6460,6460,6460,6460,6392,6392,6392,6392
.long 6324,6324,6324,6324,6256,6256,6256,6256
.long 6188,6188,6188,6188,6120,6120,6120,6120
.long 6052,6052,6052,6052,5984,5984,5984,5984
.long 5916,5916,5916,5916,5848,5848,5848,5848
.long 5780,5780,5780,5780,5712,5712,5712,5712
.long 5644,5644,5644,5644,5576,5576,5576,5576
.long 5508,5508,5508,5508,5440,5440,5440,5440
.long 5372,5372,5372,5372,5304,5304,5304,5304
.long 5236,5236,5236,5236,5168,5168,5168,5168
.long 5100,5100,5100,5100,5032,5032,5032,5032
.long 4964,4964,4964,4964,4896,4896,4896,4896
.long 4828,4828,4828,4828,4760,4760,4760,4760
.long 4692,4692,4692,4692,4624,4624,4624,4624
.long 4556,4556,4556,4556,4488,4488,4488,4488
.long 4420,4420,4420,4420,4352,4352,4352,4352
.long 4300,4284,4284,4284,4232,4216,4216,4216
.long 4164,4148,4148,4148,4096,4080,4080,4080
.long 4028,4012,4012,4012,3960,3944,3944,3944
.long 3892,3876,3876,3876,3824,3808,3808,3808
.long 3756,3740,3740,3740,3688,3672,3672,3672
.long 3620,3604,3604,3604,3552,3536,3536,3536
.long 3484,3468,3468,3468,3416,3400,3400,3400
.long 3348,3332,3332,3332,3280,3264,3264,3264
.long 3212,3196,3196,3196,3144,3128,3128,3128
.long 3076,3060,3060,3060,3008,2992,2992,2992
.long 2940,2924,2924,2924,2872,2856,2856,2856
.long 2804,2788,2788,2788,2736,2720,2720,2720
.long 2668,2652,2652,2652,2600,2584,2584,2584
.long 2532,2516,2516,2516,2464,2448,2448,2448
.long 2396,2380,2380,2380,2328,2312,2312,2312
.long 2260,2244,2244,2244,2192,2176,2176,2176
.long 2124,2116,2108,2108,2056,2048,2040,2040
.long 1988,1980,1972,1972,1920,1912,1904,1904
.long 1852,1844,1836,1836,1784,1776,1768,1768
.long 1716,1708,1700,1700,1648,1640,1632,1632
.long 1580,1572,1564,1564,1512,1504,1496,1496
.long 1444,1436,1428,1428,1376,1368,1360,1360
.long 1308,1300,1292,1292,1240,1232,1224,1224
.long 1172,1164,1156,1156,1104,1096,1088,1088
.long 1032,1028,1024,1020,964,960,956,952
.long 896,892,888,884,828,824,820,816
.long 760,756,752,748,692,688,684,680
.long 624,620,616,612,556,552,548,544
.long 488,484,480,476,420,416,412,408
.long 352,348,344,340,284,280,276,272
.long 216,212,208,204,148,144,140,136
.long 80,76,72,68,12,8,4,0
.long 31484,31484,31484,31484,31416,31416,31416,31416
.long 31348,31348,31348,31348,31280,31280,31280,31280
.long 31212,31212,31212,31212,31144,31144,31144,31144
.long 31076,31076,31076,31076,31008,31008,31008,31008
.long 30940,30940,30940,30940,30872,30872,30872,30872
.long 30804,30804,30804,30804,30736,30736,30736,30736
.long 30668,30668,30668,30668,30600,30600,30600,30600
.long 30532,30532,30532,30532,30464,30464,30464,30464
.long 30396,30396,30396,30396,30328,30328,30328,30328
.long 30260,30260,30260,30260,30192,30192,30192,30192
.long 30124,30124,30124,30124,30056,30056,30056,30056
.long 29988,29988,29988,29988,29920,29920,29920,29920
.long 29852,29852,29852,29852,29784,29784,29784,29784
.long 29716,29716,29716,29716,29648,29648,29648,29648
.long 29580,29580,29580,29580,29512,29512,29512,29512
.long 29444,29444,29444,29444,29376,29376,29376,29376
.long 29308,29308,29308,29308,29240,29240,29240,29240
.long 29172,29172,29172,29172,29104,29104,29104,29104
.long 29036,29036,29036,29036,28968,28968,28968,28968
.long 28900,28900,28900,28900,28832,28832,28832,28832
.long 28764,28764,28764,28764,28696,28696,28696,28696
.long 28628,28628,28628,28628,28560,28560,28560,28560
.long 28492,28492,28492,28492,28424,28424,28424,28424
.long 28356,28356,28356,28356,28288,28288,28288,28288
.long 28220,28220,28220,28220,28152,28152,28152,28152
.long 28084,28084,28084,28084,28016,28016,28016,28016
.long 27948,27948,27948,27948,27880,27880,27880,27880
.long 27812,27812,27812,27812,27744,27744,27744,27744
.long 27676,27676,27676,27676,27608,27608,27608,27608
.long 27540,27540,27540,27540,27472,27472,27472,27472
.long 27404,27404,27404,27404,27336,27336,27336,27336
.long 27268,27268,27268,27268,27200,27200,27200,27200
.long 27148,27132,27132,27132,27080,27064,27064,27064
.long 27012,26996,26996,26996,26944,26928,26928,26928
.long 26876,26860,26860,26860,26808,26792,26792,26792
.long 26740,26724,26724,26724,26672,26656,26656,26656
.long 26604,26588,26588,26588,26536,26520,26520,26520
.long 26468,26452,26452,26452,26400,26384,26384,26384
.long 26332,26316,26316,26316,26264,26248,26248,26248
.long 26196,26180,26180,26180,26128,26112,26112,26112
.long 26060,26044,26044,26044,25992,25976,25976,25976
.long 25924,25908,25908,25908,25856,25840,25840,25840
.long 25788,25772,25772,25772,25720,25704,25704,25704
.long 25652,25636,25636,25636,25584,25568,25568,25568
.long 25516,25500,25500,25500,25448,25432,25432,25432
.long 25380,25364,25364,25364,25312,25296,25296,25296
.long 25244,25228,25228,25228,25176,25160,25160,25160
.long 25108,25092,25092,25092,25040,25024,25024,25024
.long 24972,24964,24956,24956,24904,24896,24888,24888
.long 24836,24828,24820,24820,24768,24760,24752,24752
.long 24700,24692,24684,24684,24632,24624,24616,24616
.long 24564,24556,24548,24548,24496,24488,24480,24480
.long 24428,24420,24412,24412,24360,24352,24344,24344
.long 24292,24284,24276,24276,24224,24216,24208,24208
.long 24156,24148,24140,24140,24088,24080,24072,24072
.long 24020,24012,24004,24004,23952,23944,23936,23936
.long 23880,23876,23872,23868,23812,23808,23804,23800
.long 23744,23740,23736,23732,23676,23672,23668,23664
.long 23608,23604,23600,23596,23540,23536,23532,23528
.long 23472,23468,23464,23460,23404,23400,23396,23392
.long 23336,23332,23328,23324,23268,23264,23260,23256
.long 23200,23196,23192,23188,23132,23128,23124,23120
.long 23064,23060,23056,23052,22996,22992,22988,22984
.long 22928,22924,22920,22916,22860,22856,22852,22848
.long 8636,8636,8636,0,8568,8568,8568,32
.long 8500,8500,8500,68,8432,8432,8432,100
.long 8364,8364,8364,136,8296,8296,8296,168
.long 8228,8228,8228,204,8160,8160,8160,236
.long 8092,8092,8092,272,8024,8024,8024,304
.long 7956,7956,7956,340,7888,7888,7888,372
.long 7820,7820,7820,408,7752,7752,7752,440
.long 7684,7684,7684,476,7616,7616,7616,508
.long 7548,7548,7548,544,7480,7480,7480,576
.long 7412,7412,7412,612,7344,7344,7344,644
.long 7276,7276,7276,680,7208,7208,7208,712
.long 7140,7140,7140,748,7072,7072,7072,780
.long 7004,7004,7004,816,6936,6936,6936,848
.long 6868,6868,6868,884,6800,6800,6800,916
.long 6732,6732,6732,952,6664,6664,6664,984
.long 6596,6596,6596,1020,6528,6528,6528,1052
.long 6460,6460,6460,16,6392,6392,6392,48
.long 6324,6324,6324,84,6256,6256,6256,116
.long 6188,6188,6188,152,6120,6120,6120,184
.long 6052,6052,6052,220,5984,5984,5984,252
.long 5916,5916,5916,288,5848,5848,5848,320
.long 5780,5780,5780,356,5712,5712,5712,388
.long 5644,5644,5644,424,5576,5576,5576,456
.long 5508,5508,5508,492,5440,5440,5440,524
.long 5372,5372,5372,560,5304,5304,5304,592
.long 5236,5236,5236,628,5168,5168,5168,660
.long 5100,5100,5100,696,5032,5032,5032,728
.long 4964,4964,4964,764,4896,4896,4896,796
.long 4828,4828,4828,832,4760,4760,4760,864
.long 4692,4692,4692,900,4624,4624,4624,932
.long 4556,4556,4556,968,4488,4488,4488,1000
.long 4420,4420,4420,1036,4352,4352,4332,1068
.long 4284,4284,4264,11520,4216,4216,4196,11552
.long 4148,4148,4128,11588,4080,4080,4060,11620
.long 4012,4012,3992,11656,3944,3944,3924,11688
.long 3876,3876,3856,11724,3808,3808,3788,11756
.long 3740,3740,3720,11792,3672,3672,3652,11824
.long 3604,3604,3584,11860,3536,3536,3516,11892
.long 3468,3468,3448,11928,3400,3400,3380,11960
.long 3332,3332,3312,11996,3264,3264,3244,12028
.long 3196,3196,3176,12064,3128,3128,3108,12096
.long 3060,3060,3040,12132,2992,2992,2972,12164
.long 2924,2924,2904,12200,2856,2856,2836,12232
.long 2788,2788,2768,12268,2720,2720,2700,12300
.long 2652,2652,2632,12336,2584,2584,2564,12368
.long 2516,2516,2496,12404,2448,2448,2428,12436
.long 2380,2380,2360,12472,2312,2312,2292,12504
.long 2244,2244,2224,12540,2176,2164,2156,12572
.long 2108,2096,2088,11536,2040,2028,2020,11568
.long 1972,1960,1952,11604,1904,1892,1884,11636
.long 1836,1824,1816,11672,1768,1756,1748,11704
.long 1700,1688,1680,11740,1632,1620,1612,11772
.long 1564,1552,1544,11808,1496,1484,1476,11840
.long 1428,1416,1408,11876,1360,1348,1340,11908
.long 1292,1280,1272,11944,1224,1212,1204,11976
.long 1156,1144,1136,12012,1080,1076,1072,12044
.long 1012,1008,1004,12080,944,940,936,12112
.long 876,872,868,12148,808,804,800,12180
.long 740,736,732,12216,672,668,664,12248
.long 604,600,596,12284,536,532,528,12316
.long 468,464,460,12352,400,396,392,12384
.long 332,328,324,12420,264,260,256,12452
.long 196,192,188,12488,128,124,120,12520
.long 60,56,52,12556,9776,9776,9776,12588
.long 31484,31484,31484,22848,31416,31416,31416,22880
.long 31348,31348,31348,22916,31280,31280,31280,22948
.long 31212,31212,31212,22984,31144,31144,31144,23016
.long 31076,31076,31076,23052,31008,31008,31008,23084
.long 30940,30940,30940,23120,30872,30872,30872,23152
.long 30804,30804,30804,23188,30736,30736,30736,23220
.long 30668,30668,30668,23256,30600,30600,30600,23288
.long 30532,30532,30532,23324,30464,30464,30464,23356
.long 30396,30396,30396,23392,30328,30328,30328,23424
.long 30260,30260,30260,23460,30192,30192,30192,23492
.long 30124,30124,30124,23528,30056,30056,30056,23560
.long 29988,29988,29988,23596,29920,29920,29920,23628
.long 29852,29852,29852,23664,29784,29784,29784,23696
.long 29716,29716,29716,23732,29648,29648,29648,23764
.long 29580,29580,29580,23800,29512,29512,29512,23832
.long 29444,29444,29444,23868,29376,29376,29376,23900
.long 29308,29308,29308,22864,29240,29240,29240,22896
.long 29172,29172,29172,22932,29104,29104,29104,22964
.long 29036,29036,29036,23000,28968,28968,28968,23032
.long 28900,28900,28900,23068,28832,28832,28832,23100
.long 28764,28764,28764,23136,28696,28696,28696,23168
.long 28628,28628,28628,23204,28560,28560,28560,23236
.long 28492,28492,28492,23272,28424,28424,28424,23304
.long 28356,28356,28356,23340,28288,28288,28288,23372
.long 28220,28220,28220,23408,28152,28152,28152,23440
.long 28084,28084,28084,23476,28016,28016,28016,23508
.long 27948,27948,27948,23544,27880,27880,27880,23576
.long 27812,27812,27812,23612,27744,27744,27744,23644
.long 27676,27676,27676,23680,27608,27608,27608,23712
.long 27540,27540,27540,23748,27472,27472,27472,23780
.long 27404,27404,27404,23816,27336,27336,27336,23848
.long 27268,27268,27268,23884,27200,27200,27180,23916
.long 27132,27132,27112,34368,27064,27064,27044,34400
.long 26996,26996,26976,34436,26928,26928,26908,34468
.long 26860,26860,26840,34504,26792,26792,26772,34536
.long 26724,26724,26704,34572,26656,26656,26636,34604
.long 26588,26588,26568,34640,26520,26520,26500,34672
.long 26452,26452,26432,34708,26384,26384,26364,34740
.long 26316,26316,26296,34776,26248,26248,26228,34808
.long 26180,26180,26160,34844,26112,26112,26092,34876
.long 26044,26044,26024,34912,25976,25976,25956,34944
.long 25908,25908,25888,34980,25840,25840,25820,35012
.long 25772,25772,25752,35048,25704,25704,25684,35080
.long 25636,25636,25616,35116,25568,25568,25548,35148
.long 25500,25500,25480,35184,25432,25432,25412,35216
.long 25364,25364,25344,35252,25296,25296,25276,35284
.long 25228,25228,25208,35320,25160,25160,25140,35352
.long 25092,25092,25072,35388,25024,25012,25004,35420
.long 24956,24944,24936,34384,24888,24876,24868,34416
.long 24820,24808,24800,34452,24752,24740,24732,34484
.long 24684,24672,24664,34520,24616,24604,24596,34552
.long 24548,24536,24528,34588,24480,24468,24460,34620
.long 24412,24400,24392,34656,24344,24332,24324,34688
.long 24276,24264,24256,34724,24208,24196,24188,34756
.long 24140,24128,24120,34792,24072,24060,24052,34824
.long 24004,23992,23984,34860,23928,23924,23920,34892
.long 23860,23856,23852,34928,23792,23788,23784,34960
.long 23724,23720,23716,34996,23656,23652,23648,35028
.long 23588,23584,23580,35064,23520,23516,23512,35096
.long 23452,23448,23444,35132,23384,23380,23376,35164
.long 23316,23312,23308,35200,23248,23244,23240,35232
.long 23180,23176,23172,35268,23112,23108,23104,35300
.long 23044,23040,23036,35336,22976,22972,22968,35368
.long 22908,22904,22900,35404,32624,32624,32624,35436
.long 1088,1096,1104,1112,1120,1128,1136,1144
.long 1156,1164,1172,1180,1188,1196,1204,1212
.long 1224,1232,1240,1248,1256,1264,1272,1280
.long 1292,1300,1308,1316,1324,1332,1340,1348
.long 1360,1368,1376,1384,1392,1400,1408,1416
.long 1428,1436,1444,1452,1460,1468,1476,1484
.long 1496,1504,1512,1520,1528,1536,1544,1552
.long 1564,1572,1580,1588,1596,1604,1612,1620
.long 1632,1640,1648,1656,1664,1672,1680,1688
.long 1700,1708,1716,1724,1732,1740,1748,1756
.long 1768,1776,1784,1792,1800,1808,1816,1824
.long 1836,1844,1852,1860,1868,1876,1884,1892
.long 1904,1912,1920,1928,1936,1944,1952,1960
.long 1972,1980,1988,1996,2004,2012,2020,2028
.long 2040,2048,2056,2064,2072,2080,2088,2096
.long 2108,2116,2124,2132,2140,2148,2156,2164
.long 2176,2192,3264,3280,2208,2224,3296,3312
.long 2244,2260,3332,3348,2276,2292,3364,3380
.long 2312,2328,3400,3416,2344,2360,3432,3448
.long 2380,2396,3468,3484,2412,2428,3500,3516
.long 2448,2464,3536,3552,2480,2496,3568,3584
.long 2516,2532,3604,3620,2548,2564,3636,3652
.long 2584,2600,3672,3688,2616,2632,3704,3720
.long 2652,2668,3740,3756,2684,2700,3772,3788
.long 2720,2736,3808,3824,2752,2768,3840,3856
.long 2788,2804,3876,3892,2820,2836,3908,3924
.long 2856,2872,3944,3960,2888,2904,3976,3992
.long 2924,2940,4012,4028,2956,2972,4044,4060
.long 2992,3008,4080,4096,3024,3040,4112,4128
.long 3060,3076,4148,4164,3092,3108,4180,4196
.long 3128,3144,4216,4232,3160,3176,4248,4264
.long 3196,3212,4284,4300,3228,3244,4316,4332
.long 12608,12616,12624,12632,12640,12648,12656,12664
.long 12676,12684,12692,12700,12708,12716,12724,12732
.long 12744,12752,12760,12768,12776,12784,12792,12800
.long 12812,12820,12828,12836,12844,12852,12860,12868
.long 12880,12888,12896,12904,12912,12920,12928,12936
.long 12948,12956,12964,12972,12980,12988,12996,13004
.long 13016,13024,13032,13040,13048,13056,13064,13072
.long 13084,13092,13100,13108,13116,13124,13132,13140
.long 13152,13160,13168,13176,13184,13192,13200,13208
.long 13220,13228,13236,13244,13252,13260,13268,13276
.long 13288,13296,13304,13312,13320,13328,13336,13344
.long 13356,13364,13372,13380,13388,13396,13404,13412
.long 13424,13432,13440,13448,13456,13464,13472,13480
.long 13492,13500,13508,13516,13524,13532,13540,13548
.long 13560,13568,13576,13584,13592,13600,13608,13616
.long 13628,13636,13644,13652,13660,13668,13676,13684
.long 13696,13712,14784,14800,13728,13744,14816,14832
.long 13764,13780,14852,14868,13796,13812,14884,14900
.long 13832,13848,14920,14936,13864,13880,14952,14968
.long 13900,13916,14988,15004,13932,13948,15020,15036
.long 13968,13984,15056,15072,14000,14016,15088,15104
.long 14036,14052,15124,15140,14068,14084,15156,15172
.long 14104,14120,15192,15208,14136,14152,15224,15240
.long 14172,14188,15260,15276,14204,14220,15292,15308
.long 14240,14256,15328,15344,14272,14288,15360,15376
.long 14308,14324,15396,15412,14340,14356,15428,15444
.long 14376,14392,15464,15480,14408,14424,15496,15512
.long 14444,14460,15532,15548,14476,14492,15564,15580
.long 14512,14528,15600,15616,14544,14560,15632,15648
.long 14580,14596,15668,15684,14612,14628,15700,15716
.long 14648,14664,15736,15752,14680,14696,15768,15784
.long 14716,14732,15804,15820,14748,14764,15836,15852
.long 23936,23944,23952,23960,23968,23976,23984,23992
.long 24004,24012,24020,24028,24036,24044,24052,24060
.long 24072,24080,24088,24096,24104,24112,24120,24128
.long 24140,24148,24156,24164,24172,24180,24188,24196
.long 24208,24216,24224,24232,24240,24248,24256,24264
.long 24276,24284,24292,24300,24308,24316,24324,24332
.long 24344,24352,24360,24368,24376,24384,24392,24400
.long 24412,24420,24428,24436,24444,24452,24460,24468
.long 24480,24488,24496,24504,24512,24520,24528,24536
.long 24548,24556,24564,24572,24580,24588,24596,24604
.long 24616,24624,24632,24640,24648,24656,24664,24672
.long 24684,24692,24700,24708,24716,24724,24732,24740
.long 24752,24760,24768,24776,24784,24792,24800,24808
.long 24820,24828,24836,24844,24852,24860,24868,24876
.long 24888,24896,24904,24912,24920,24928,24936,24944
.long 24956,24964,24972,24980,24988,24996,25004,25012
.long 25024,25040,26112,26128,25056,25072,26144,26160
.long 25092,25108,26180,26196,25124,25140,26212,26228
.long 25160,25176,26248,26264,25192,25208,26280,26296
.long 25228,25244,26316,26332,25260,25276,26348,26364
.long 25296,25312,26384,26400,25328,25344,26416,26432
.long 25364,25380,26452,26468,25396,25412,26484,26500
.long 25432,25448,26520,26536,25464,25480,26552,26568
.long 25500,25516,26588,26604,25532,25548,26620,26636
.long 25568,25584,26656,26672,25600,25616,26688,26704
.long 25636,25652,26724,26740,25668,25684,26756,26772
.long 25704,25720,26792,26808,25736,25752,26824,26840
.long 25772,25788,26860,26876,25804,25820,26892,26908
.long 25840,25856,26928,26944,25872,25888,26960,26976
.long 25908,25924,26996,27012,25940,25956,27028,27044
.long 25976,25992,27064,27080,26008,26024,27096,27112
.long 26044,26060,27132,27148,26076,26092,27164,27180
.long 35456,35464,35472,35480,35488,35496,35504,35512
.long 35524,35532,35540,35548,35556,35564,35572,35580
.long 35592,35600,35608,35616,35624,35632,35640,35648
.long 35660,35668,35676,35684,35692,35700,35708,35716
.long 35728,35736,35744,35752,35760,35768,35776,35784
.long 35796,35804,35812,35820,35828,35836,35844,35852
.long 35864,35872,35880,35888,35896,35904,35912,35920
.long 35932,35940,35948,35956,35964,35972,35980,35988
.long 36000,36008,36016,36024,36032,36040,36048,36056
.long 36068,36076,36084,36092,36100,36108,36116,36124
.long 36136,36144,36152,36160,36168,36176,36184,36192
.long 36204,36212,36220,36228,36236,36244,36252,36260
.long 36272,36280,36288,36296,36304,36312,36320,36328
.long 36340,36348,36356,36364,36372,36380,36388,36396
.long 36408,36416,36424,36432,36440,36448,36456,36464
.long 36476,36484,36492,36500,36508,36516,36524,36532
.long 36544,36560,37632,37648,36576,36592,37664,37680
.long 36612,36628,37700,37716,36644,36660,37732,37748
.long 36680,36696,37768,37784,36712,36728,37800,37816
.long 36748,36764,37836,37852,36780,36796,37868,37884
.long 36816,36832,37904,37920,36848,36864,37936,37952
.long 36884,36900,37972,37988,36916,36932,38004,38020
.long 36952,36968,38040,38056,36984,37000,38072,38088
.long 37020,37036,38108,38124,37052,37068,38140,38156
.long 37088,37104,38176,38192,37120,37136,38208,38224
.long 37156,37172,38244,38260,37188,37204,38276,38292
.long 37224,37240,38312,38328,37256,37272,38344,38360
.long 37292,37308,38380,38396,37324,37340,38412,38428
.long 37360,37376,38448,38464,37392,37408,38480,38496
.long 37428,37444,38516,38532,37460,37476,38548,38564
.long 37496,37512,38584,38600,37528,37544,38616,38632
.long 37564,37580,38652,38668,37596,37612,38684,38700
.long 4352,5440,6528,7616,4384,5472,6560,7648
.long 4420,5508,6596,7684,4452,5540,6628,7716
.long 4488,5576,6664,7752,4520,5608,6696,7784
.long 4556,5644,6732,7820,4588,5676,6764,7852
.long 4624,5712,6800,7888,4656,5744,6832,7920
.long 4692,5780,6868,7956,4724,5812,6900,7988
.long 4760,5848,6936,8024,4792,5880,6968,8056
.long 4828,5916,7004,8092,4860,5948,7036,8124
.long 4896,5984,7072,8160,4928,6016,7104,8192
.long 4964,6052,7140,8228,4996,6084,7172,8260
.long 5032,6120,7208,8296,5064,6152,7240,8328
.long 5100,6188,7276,8364,5132,6220,7308,8396
.long 5168,6256,7344,8432,5200,6288,7376,8464
.long 5236,6324,7412,8500,5268,6356,7444,8532
.long 5304,6392,7480,8568,5336,6424,7512,8600
.long 5372,6460,7548,8636,5404,6492,7580,8668
.long 8704,9792,9792,9792,8736,9824,9824,9824
.long 8772,9860,9860,9860,8804,9892,9892,9892
.long 8840,9928,9928,9928,8872,9960,9960,9960
.long 8908,9996,9996,9996,8940,10028,10028,10028
.long 8976,10064,10064,10064,9008,10096,10096,10096
.long 9044,10132,10132,10132,9076,10164,10164,10164
.long 9112,10200,10200,10200,9144,10232,10232,10232
.long 9180,10268,10268,10268,9212,10300,10300,10300
.long 9248,10336,10336,10336,9280,10368,10368,10368
.long 9316,10404,10404,10404,9348,10436,10436,10436
.long 9384,10472,10472,10472,9416,10504,10504,10504
.long 9452,10540,10540,10540,9484,10572,10572,10572
.long 9520,10608,10608,10608,9552,10640,10640,10640
.long 9588,10676,10676,10676,9620,10708,10708,10708
.long 9656,10744,10744,10744,9688,10776,10776,10776
.long 9724,10812,10812,10812,9756,10844,10844,10844
.long 15872,16960,18048,19136,15904,16992,18080,19168
.long 15940,17028,18116,19204,15972,17060,18148,19236
.long 16008,17096,18184,19272,16040,17128,18216,19304
.long 16076,17164,18252,19340,16108,17196,18284,19372
.long 16144,17232,18320,19408,16176,17264,18352,19440
.long 16212,17300,18388,19476,16244,17332,18420,19508
.long 16280,17368,18456,19544,16312,17400,18488,19576
.long 16348,17436,18524,19612,16380,17468,18556,19644
.long 16416,17504,18592,19680,16448,17536,18624,19712
.long 16484,17572,18660,19748,16516,17604,18692,19780
.long 16552,17640,18728,19816,16584,17672,18760,19848
.long 16620,17708,18796,19884,16652,17740,18828,19916
.long 16688,17776,18864,19952,16720,17808,18896,19984
.long 16756,17844,18932,20020,16788,17876,18964,20052
.long 16824,17912,19000,20088,16856,17944,19032,20120
.long 16892,17980,19068,20156,16924,18012,19100,20188
.long 20224,21312,21312,21312,20256,21344,21344,21344
.long 20292,21380,21380,21380,20324,21412,21412,21412
.long 20360,21448,21448,21448,20392,21480,21480,21480
.long 20428,21516,21516,21516,20460,21548,21548,21548
.long 20496,21584,21584,21584,20528,21616,21616,21616
.long 20564,21652,21652,21652,20596,21684,21684,21684
.long 20632,21720,21720,21720,20664,21752,21752,21752
.long 20700,21788,21788,21788,20732,21820,21820,21820
.long 20768,21856,21856,21856,20800,21888,21888,21888
.long 20836,21924,21924,21924,20868,21956,21956,21956
.long 20904,21992,21992,21992,20936,22024,22024,22024
.long 20972,22060,22060,22060,21004,22092,22092,22092
.long 21040,22128,22128,22128,21072,22160,22160,22160
.long 21108,22196,22196,22196,21140,22228,22228,22228
.long 21176,22264,22264,22264,21208,22296,22296,22296
.long 21244,22332,22332,22332,21276,22364,22364,22364
.long 27200,28288,29376,30464,27232,28320,29408,30496
.long 27268,28356,29444,30532,27300,28388,29476,30564
.long 27336,28424,29512,30600,27368,28456,29544,30632
.long 27404,28492,29580,30668,27436,28524,29612,30700
.long 27472,28560,29648,30736,27504,28592,29680,30768
.long 27540,28628,29716,30804,27572,28660,29748,30836
.long 27608,28696,29784,30872,27640,28728,29816,30904
.long 27676,28764,29852,30940,27708,28796,29884,30972
.long 27744,28832,29920,31008,27776,28864,29952,31040
.long 27812,28900,29988,31076,27844,28932,30020,31108
.long 27880,28968,30056,31144,27912,29000,30088,31176
.long 27948,29036,30124,31212,27980,29068,30156,31244
.long 28016,29104,30192,31280,28048,29136,30224,31312
.long 28084,29172,30260,31348,28116,29204,30292,31380
.long 28152,29240,30328,31416,28184,29272,30360,31448
.long 28220,29308,30396,31484,28252,29340,30428,31516
.long 31552,32640,32640,32640,31584,32672,32672,32672
.long 31620,32708,32708,32708,31652,32740,32740,32740
.long 31688,32776,32776,32776,31720,32808,32808,32808
.long 31756,32844,32844,32844,31788,32876,32876,32876
.long 31824,32912,32912,32912,31856,32944,32944,32944
.long 31892,32980,32980,32980,31924,33012,33012,33012
.long 31960,33048,33048,33048,31992,33080,33080,33080
.long 32028,33116,33116,33116,32060,33148,33148,33148
.long 32096,33184,33184,33184,32128,33216,33216,33216
.long 32164,33252,33252,33252,32196,33284,33284,33284
.long 32232,33320,33320,33320,32264,33352,33352,33352
.long 32300,33388,33388,33388,32332,33420,33420,33420
.long 32368,33456,33456,33456,32400,33488,33488,33488
.long 32436,33524,33524,33524,32468,33556,33556,33556
.long 32504,33592,33592,33592,32536,33624,33624,33624
.long 32572,33660,33660,33660,32604,33692,33692,33692
.long 38720,39808,40896,41984,38752,39840,40928,42016
.long 38788,39876,40964,42052,38820,39908,40996,42084
.long 38856,39944,41032,42120,38888,39976,41064,42152
.long 38924,40012,41100,42188,38956,40044,41132,42220
.long 38992,40080,41168,42256,39024,40112,41200,42288
.long 39060,40148,41236,42324,39092,40180,41268,42356
.long 39128,40216,41304,42392,39160,40248,41336,42424
.long 39196,40284,41372,42460,39228,40316,41404,42492
.long 39264,40352,41440,42528,39296,40384,41472,42560
.long 39332,40420,41508,42596,39364,40452,41540,42628
.long 39400,40488,41576,42664,39432,40520,41608,42696
.long 39468,40556,41644,42732,39500,40588,41676,42764
.long 39536,40624,41712,42800,39568,40656,41744,42832
.long 39604,40692,41780,42868,39636,40724,41812,42900
.long 39672,40760,41848,42936,39704,40792,41880,42968
.long 39740,40828,41916,43004,39772,40860,41948,43036
.long 43072,44160,44160,44160,43104,44192,44192,44192
.long 43140,44228,44228,44228,43172,44260,44260,44260
.long 43208,44296,44296,44296,43240,44328,44328,44328
.long 43276,44364,44364,44364,43308,44396,44396,44396
.long 43344,44432,44432,44432,43376,44464,44464,44464
.long 43412,44500,44500,44500,43444,44532,44532,44532
.long 43480,44568,44568,44568,43512,44600,44600,44600
.long 43548,44636,44636,44636,43580,44668,44668,44668
.long 43616,44704,44704,44704,43648,44736,44736,44736
.long 43684,44772,44772,44772,43716,44804,44804,44804
.long 43752,44840,44840,44840,43784,44872,44872,44872
.long 43820,44908,44908,44908,43852,44940,44940,44940
.long 43888,44976,44976,44976,43920,45008,45008,45008
.long 43956,45044,45044,45044,43988,45076,45076,45076
.long 44024,45112,45112,45112,44056,45144,45144,45144
.long 44092,45180,45180,45180,44124,45212,45212,45212
.section .rodata,"a"
.p2align 6
.amdhsa_kernel sequential_preLN__ssm_conv_s4__mixer_gmlp__prompt_kernel
  .amdhsa_next_free_vgpr 512
  .amdhsa_next_free_sgpr 102
  .amdhsa_accum_offset 256
  .amdhsa_group_segment_fixed_size 0
  .amdhsa_kernarg_size 136
  .amdhsa_user_sgpr_count 2
  .amdhsa_user_sgpr_kernarg_segment_ptr 1
  .amdhsa_system_sgpr_workgroup_id_x 1
  .amdhsa_float_denorm_mode_32 3
.end_amdhsa_kernel
```
